```python
import torch

def _softmax(x, axis=-1):
    return torch.softmax(x, dim=axis)
def _gelu(x):
    return torch.nn.functional.gelu(x, approximate="tanh")
def _silu(x):
    return torch.nn.functional.silu(x)
def _sigmoid(x):
    return torch.sigmoid(x)
def _layernorm(x, axis=-1, eps=1e-5):
    m = x.mean(dim=axis, keepdim=True)
    v = x.var(dim=axis, keepdim=True, unbiased=False)
    return (x - m) / torch.sqrt(v + eps)
def _scatter_add(tgt, idx, src, axis=0):
    return tgt.clone().index_add_(axis, idx, src)
def _segment_sum(src, seg, n):
    out = torch.zeros((n,) + src.shape[1:], dtype=src.dtype)
    return out.index_add_(0, seg, src)
def _pad(x, pw):
    flat = tuple(v for pair in reversed(pw) for v in pair)
    return torch.nn.functional.pad(x, flat)

kernel_name = 'concat_heads__sliding_local_dilated__linear_attn_block__prompt'

def setup_inputs():

    _w = (lambda a: (lambda t: t.to(torch.bfloat16) if t.is_floating_point() else t)(torch.as_tensor(a)))
    def _A_setup():
        B, S, D = 1, 2048, 576
        return {
            "x": _w((lambda *s: torch.randn(*s, dtype=torch.bfloat16) * 0.2)(B, S, D)),
            "wqkv": _w((lambda *s: torch.randn(*s, dtype=torch.bfloat16) * 0.2)(D, 3 * D)),
            "wo": _w((lambda *s: torch.randn(*s, dtype=torch.bfloat16) * 0.05)(D, D)),
        }
    _A_in = _A_setup()

    def _B_setup():
        B, S, D = 1, 2048, 576
        return {
            "x": _w((lambda *s: torch.randn(*s, dtype=torch.bfloat16) * 0.05)(B, S, D)),
            "wqkv": _w((lambda *s: torch.randn(*s, dtype=torch.bfloat16) * 0.8)(D, 3 * D)),
            "wo": _w((lambda *s: torch.randn(*s, dtype=torch.bfloat16) * 0.8)(D, D)),
        }
    _B_in = _B_setup()

    return {
        "A_x": _A_in["x"],
        "A_wqkv": _A_in["wqkv"],
        "A_wo": _A_in["wo"],
        "B_x": _B_in["x"],
        "B_wqkv": _B_in["wqkv"],
        "B_wo": _B_in["wo"],
    }

def reference(A_x, A_wqkv, A_wo, B_x, B_wqkv, B_wo):
    def _A_ref(x, wqkv, wo):
        B, S, D = x.shape
        H = 32; Dh = D // H
        W, dil = 8, 2
        qkv = (lambda x, *d: x.permute(*d))((x @ wqkv).reshape(B, S, 3, H, Dh), 2, 0, 3, 1, 4)
        q, k, v = qkv[0], qkv[1], qkv[2]
        scale = Dh ** -0.5
        pos = torch.arange(S)
        off = torch.arange(W) * dil
        idx = pos[:, None] - off[None, :]
        mask = idx >= 0
        idx_c = torch.where(mask, idx, 0).reshape(-1)
        kg = k[:, :, idx_c, :].reshape(B, H, S, W, Dh)
        vg = v[:, :, idx_c, :].reshape(B, H, S, W, Dh)
        logits = torch.einsum("bhsd,bhswd->bhsw", q, kg) * scale
        logits = torch.where(mask[None, None, :, :], logits, -1e9)
        attn = _softmax(logits, axis=-1)
        o = torch.einsum("bhsw,bhswd->bhsd", attn, vg)
        return (lambda x, *d: x.permute(*d))(o, 0, 2, 1, 3).reshape(B, S, D) @ wo

    def _B_ref(x, wqkv, wo):
        B, S, D = x.shape
        H = 32; Dh = D // H
        qkv = (lambda x, *d: x.permute(*d))((x @ wqkv).reshape(B, S, 3, H, Dh), 2, 0, 3, 1, 4)
        q, k, v = qkv[0], qkv[1], qkv[2]
        phi = lambda t: torch.where(t > 0, t + 1, torch.exp(t)) + 1e-6
        pq, pk = phi(q), phi(k)
        kv = torch.einsum("bhsd,bhse->bhde", pk, v)
        z = torch.einsum("bhsd->bhd", pk)
        num = torch.einsum("bhqd,bhde->bhqe", pq, kv)
        den = torch.einsum("bhqd,bhd->bhq", pq, z)[..., None] + 1e-6
        o = num / den
        return (lambda x, *d: x.permute(*d))(o, 0, 2, 1, 3).reshape(B, S, D) @ wo

    a = _A_ref(A_x, A_wqkv, A_wo)
    b = _B_ref(B_x, B_wqkv, B_wo)
    return torch.concatenate([a, b], axis=-1)
```

```asm
; @launch grid=(256,1,1) block=(512,1,1) lds=163840
.amdgcn_target "amdgcn-amd-amdhsa--gfx950"
.text
.globl concat_heads__sliding_local_dilated__linear_attn_block__prompt_kernel
.p2align 8
.type concat_heads__sliding_local_dilated__linear_attn_block__prompt_kernel,@function
concat_heads__sliding_local_dilated__linear_attn_block__prompt_kernel:
s_cmp_ge_u32 s2, 256
s_cbranch_scc1 L_end
s_and_b32 s7, s2, 7
s_lshr_b32 s6, s7, 2
s_mul_i32 s53, s6, 24
s_load_dwordx4 s[36:39], s[0:1], s53
v_lshrrev_b32 v1, 6, v0
v_and_b32 v0, 63, v0
v_readfirstlane_b32 s3, v1
s_bfe_u32 s4, s2, 0x30003
s_lshr_b32 s5, s2, 6
s_and_b32 s54, s7, 3
s_lshl2_add_u32 s5, s54, s5
s_cmp_lt_u32 s3, 4
s_cbranch_scc1 L_cons
s_setprio 2
s_and_b32 s51, s3, 1
s_add_u32 s90, s5, s4
s_and_b32 s90, s90, 7
s_lshl_b32 s91, s90, 7
s_mul_i32 s90, s90, 221184
s_cmp_lt_u32 s3, 6
s_cbranch_scc1 L_W0
s_cmp_eq_u32 s6, 0
s_cselect_b32 s53, 1, 0
s_lshl_b32 s54, 1152, s53
v_lshrrev_b32 v1, 3, v0
v_mul_u32_u24 v1, s54, v1
v_lshrrev_b32 v2, 4, v0
v_lshl_add_u32 v2, s51, 2, v2
v_and_b32 v3, 7, v0
v_xor_b32 v2, v2, v3
v_lshl_add_u32 v1, v2, 4, v1
s_mul_i32 s7, s5, 147456
v_add_u32 v1, s7, v1
s_lshl_b32 s43, s54, 4
s_mul_i32 s7, s51, s54
s_lshl_b32 s7, s7, 3
v_add_u32 v16, s7, v1
s_mul_i32 s54, s51, 1152
s_add_u32 s54, s54, 17280
v_subrev_u32 v24, s54, v1
s_sub_u32 s54, 19584, s7
s_add_u32 s7, s7, 73728
s_cmp_eq_u32 s6, 0
s_cselect_b32 s7, s54, s7
v_add_u32 v20, s7, v1
s_movk_i32 s7, 25600
s_cselect_b32 s7, s7, 0
s_lshl_b32 s42, s51, 10
s_add_u32 s7, s7, s42
s_add_u32 m0, s7, 51360
v_add_u32 v17, s43, v16
v_add_u32 v21, s43, v20
v_add_u32 v18, s43, v17
v_add_u32 v22, s43, v21
v_add_u32 v19, s43, v18
v_add_u32 v23, s43, v22
s_mov_b32 s54, 0
s_waitcnt lgkmcnt(0)
s_mov_b32 s8, s36
s_mov_b32 s9, s37
s_mov_b32 s10, 2359296
s_mov_b32 s11, 0x20000
L_X0l:
buffer_load_dwordx4 v16, s[8:11], s91 offen offset:0 lds
s_addk_i32 m0, 2048
s_nop 0
buffer_load_dwordx4 v17, s[8:11], s91 offen offset:0 lds
s_addk_i32 m0, 2048
s_nop 0
buffer_load_dwordx4 v18, s[8:11], s91 offen offset:0 lds
s_addk_i32 m0, 2048
s_nop 0
buffer_load_dwordx4 v19, s[8:11], s91 offen offset:0 lds
s_addk_i32 m0, 2048
s_nop 0
buffer_load_dwordx4 v20, s[8:11], s91 offen offset:0 lds
s_addk_i32 m0, 2048
s_nop 0
buffer_load_dwordx4 v21, s[8:11], s91 offen offset:0 lds
s_addk_i32 m0, 2048
s_nop 0
buffer_load_dwordx4 v22, s[8:11], s91 offen offset:0 lds
s_addk_i32 m0, 2048
s_nop 0
buffer_load_dwordx4 v23, s[8:11], s91 offen offset:0 lds
s_addk_i32 m0, 2048
s_cmp_eq_u32 s6, 0
s_cbranch_scc0 L_X0b
buffer_load_dwordx4 v24, s[8:11], s91 offen offset:0 lds
s_addk_i32 m0, 2048
s_nop 0
L_X0b:
s_cmp_lg_u32 s54, 0
s_cbranch_scc1 L_X0x
s_mov_b32 s54, 1
s_addk_i32 s91, 128
s_cmpk_eq_u32 s91, 1152
s_cselect_b32 s91, 0, s91
s_branch L_X0l
L_X0x:
s_cmp_eq_u32 s6, 0
s_cbranch_scc1 L_AX1
s_branch L_BX1
L_cons:
s_getpc_b64 s[42:43]
L_pc:
s_lshr_b32 s7, s2, 3
s_lshl2_add_u32 s7, s7, s3
s_lshl_b32 s7, s7, 9
v_and_b32 v1, 3, v0
v_lshl_add_u32 v1, v1, 7, s7
v_min_u32 v1, L_last-L_pc, v1
global_load_dword v27, v1, s[42:43]
s_mul_i32 s7, s6, 24
s_add_u32 s7, s7, 16
s_load_dwordx2 s[40:41], s[0:1], s7
s_load_dwordx4 s[44:47], s[0:1], 48
s_load_dwordx2 s[48:49], s[0:1], 64
s_cmp_eq_u32 s6, 0
s_cbranch_scc1 L_AC
s_branch L_BC
L_end:
s_endpgm
L_W0:
s_mul_i32 s7, s51, 55296
s_mul_i32 s53, s4, 144
s_add_u32 s7, s7, s53
s_mul_i32 s53, s6, 1152
s_add_u32 s7, s7, s53
v_add_u32 v1, 0, v0
v_mul_u32_u24 v2, 6554, v1
v_lshrrev_b32 v2, 16, v2
v_mad_i32_i24 v1, v2, -10, v1
v_bfe_u32 v3, v2, 2, 1
v_bfe_u32 v4, v2, 3, 1
v_sub_u32 v3, v3, v4
v_lshl_add_u32 v2, v3, 2, v2
v_mul_u32_u24 v2, 3456, v2
v_lshl_add_u32 v2, v1, 4, v2
v_add_u32 v1, 7, v1
v_lshrrev_b32 v1, 4, v1
v_lshl_add_u32 v2, v1, 23, v2
v_add_u32 v16, s7, v2
v_add_u32 v1, 64, v0
v_mul_u32_u24 v2, 6554, v1
v_lshrrev_b32 v2, 16, v2
v_mad_i32_i24 v1, v2, -10, v1
v_bfe_u32 v3, v2, 2, 1
v_bfe_u32 v4, v2, 3, 1
v_sub_u32 v3, v3, v4
v_lshl_add_u32 v2, v3, 2, v2
v_mul_u32_u24 v2, 3456, v2
v_lshl_add_u32 v2, v1, 4, v2
v_add_u32 v1, 7, v1
v_lshrrev_b32 v1, 4, v1
v_lshl_add_u32 v2, v1, 23, v2
v_add_u32 v17, s7, v2
v_add_u32 v1, 128, v0
v_mul_u32_u24 v2, 6554, v1
v_lshrrev_b32 v2, 16, v2
v_mad_i32_i24 v1, v2, -10, v1
v_bfe_u32 v3, v2, 2, 1
v_bfe_u32 v4, v2, 3, 1
v_sub_u32 v3, v3, v4
v_lshl_add_u32 v2, v3, 2, v2
v_mul_u32_u24 v2, 3456, v2
v_lshl_add_u32 v2, v1, 4, v2
v_add_u32 v1, 7, v1
v_lshrrev_b32 v1, 4, v1
v_lshl_add_u32 v2, v1, 23, v2
v_add_u32 v18, s7, v2
s_mul_i32 s42, s51, 2560
s_mov_b32 m0, s42
s_mov_b32 s54, 0
s_waitcnt lgkmcnt(0)
s_mov_b32 s12, s38
s_mov_b32 s13, s39
s_mov_b32 s14, 1990656
s_mov_b32 s15, 0x20000
L_W0l:
buffer_load_dwordx4 v16, s[12:15], s90 offen offset:0 lds
s_addk_i32 m0, 1024
s_nop 0
buffer_load_dwordx4 v17, s[12:15], s90 offen offset:0 lds
s_addk_i32 m0, 2960
s_nop 0
buffer_load_dwordx4 v16, s[12:15], s90 offen offset:1152 lds
s_addk_i32 m0, 1024
s_nop 0
buffer_load_dwordx4 v17, s[12:15], s90 offen offset:1152 lds
s_addk_i32 m0, -2960
s_mov_b32 exec_hi, 0
buffer_load_dwordx4 v18, s[12:15], s90 offen offset:0 lds
s_addk_i32 m0, 3984
s_nop 0
buffer_load_dwordx4 v18, s[12:15], s90 offen offset:1152 lds
s_addk_i32 m0, 3984
s_cmp_lg_u32 s6, 0
s_cbranch_scc1 L_W0b
buffer_load_dwordx4 v18, s[12:15], s90 offen offset:2304 lds
s_addk_i32 m0, -2048
s_mov_b32 exec_hi, -1
buffer_load_dwordx4 v16, s[12:15], s90 offen offset:2304 lds
s_addk_i32 m0, 1024
s_nop 0
buffer_load_dwordx4 v17, s[12:15], s90 offen offset:2304 lds
s_addk_i32 m0, 6144
L_W0b:
s_mov_b32 exec_hi, -1
s_addk_i32 m0, 256
s_cmp_lg_u32 s54, 0
s_cbranch_scc1 L_W0x
s_mov_b32 s54, 1
s_add_u32 s90, s90, 110592
s_branch L_W0l
L_W0x:
s_cmp_eq_u32 s6, 0
s_cbranch_scc1 L_AW1
s_branch L_BW1
L_AW1:
s_add_u32 s90, s90, 110592
s_cmp_eq_u32 s90, 1990656
s_cselect_b32 s90, 0, s90
s_add_u32 m0, s42, 30784
s_nop 0
buffer_load_dwordx4 v16, s[12:15], s90 offen offset:0 lds
s_addk_i32 m0, 1024
s_nop 0
buffer_load_dwordx4 v17, s[12:15], s90 offen offset:0 lds
s_addk_i32 m0, 2960
s_nop 0
buffer_load_dwordx4 v16, s[12:15], s90 offen offset:1152 lds
s_addk_i32 m0, 1024
s_nop 0
buffer_load_dwordx4 v17, s[12:15], s90 offen offset:1152 lds
s_addk_i32 m0, 2960
s_nop 0
buffer_load_dwordx4 v16, s[12:15], s90 offen offset:2304 lds
s_addk_i32 m0, 1024
s_nop 0
buffer_load_dwordx4 v17, s[12:15], s90 offen offset:2304 lds
s_addk_i32 m0, -6944
s_mov_b32 exec_hi, 0
buffer_load_dwordx4 v18, s[12:15], s90 offen offset:0 lds
s_addk_i32 m0, 3984
s_nop 0
buffer_load_dwordx4 v18, s[12:15], s90 offen offset:1152 lds
s_addk_i32 m0, 3984
s_nop 0
buffer_load_dwordx4 v18, s[12:15], s90 offen offset:2304 lds
s_mov_b32 exec_hi, -1
s_mul_i32 s7, s6, 24
s_add_u32 s7, s7, 16
s_load_dwordx2 s[40:41], s[0:1], s7
s_load_dwordx4 s[44:47], s[0:1], 48
s_load_dwordx2 s[48:49], s[0:1], 64
s_mov_b32 s32, 0xffff
s_mov_b32 s33, 0
s_mov_b32 s34, -1
s_mov_b32 s35, 0
s_mov_b32 s59, 0
v_lshrrev_b32 v8, 4, v0
v_bfe_u32 v1, v0, 1, 3
v_xor_b32 v8, v8, v1
v_and_b32 v1, 15, v0
v_lshlrev_b32 v1, 7, v1
v_lshl_add_u32 v8, v8, 4, v1
v_xor_b32 v9, 64, v8
v_lshrrev_b32 v1, 5, v0
v_lshlrev_b32 v1, 4, v1
v_bfe_u32 v2, v0, 4, 1
v_lshl_add_u32 v1, v2, 2, v1
v_bfe_u32 v2, v0, 2, 2
v_add_u32 v1, v1, v2
v_mul_u32_u24 v1, 160, v1
v_and_b32 v2, 3, v0
v_lshl_add_u32 v10, v2, 3, v1
v_bfe_u32 v2, v0, 1, 1
v_mul_u32_u24 v2, 5120, v2
v_add_u32 v2, 128, v2
v_add_u32 v12, v2, v10
v_add_u32 v8, 93344, v8
v_add_u32 v9, 93344, v9
s_lshl_b32 s7, s51, 6
s_add_u32 s7, s7, 5136
v_add_u32 v10, s7, v10
v_add_u32 v13, 61568, v10
v_add_u32 v15, 61568, v12
s_waitcnt vmcnt(18)
s_barrier
ds_read_b128 v[40:43], v8 offset:0
ds_read_b64_tr_b16 v[44:45], v10 offset:0
ds_read_b64_tr_b16 v[46:47], v10 offset:1280
ds_read_b64_tr_b16 v[48:49], v10 offset:32
ds_read_b64_tr_b16 v[50:51], v10 offset:1312
s_cmp_eq_u32 s51, 0
s_cbranch_scc0 L_AW_r0
ds_read_b64_tr_b16 v[52:53], v12 offset:0
ds_read_b64_tr_b16 v[54:55], v12 offset:1280
L_AW_r0:
s_add_u32 s90, s90, 110592
s_cmp_eq_u32 s90, 1990656
s_cselect_b32 s90, 0, s90
s_addk_i32 m0, 5376
s_nop 0
buffer_load_dwordx4 v16, s[12:15], s90 offen offset:0 lds
s_addk_i32 m0, 1024
s_nop 0
buffer_load_dwordx4 v17, s[12:15], s90 offen offset:0 lds
s_addk_i32 m0, 2960
s_nop 0
buffer_load_dwordx4 v16, s[12:15], s90 offen offset:1152 lds
s_addk_i32 m0, 1024
s_nop 0
buffer_load_dwordx4 v17, s[12:15], s90 offen offset:1152 lds
s_addk_i32 m0, 2960
s_nop 0
buffer_load_dwordx4 v16, s[12:15], s90 offen offset:2304 lds
s_addk_i32 m0, 1024
s_nop 0
buffer_load_dwordx4 v17, s[12:15], s90 offen offset:2304 lds
s_addk_i32 m0, -6944
s_mov_b32 exec_hi, 0
buffer_load_dwordx4 v18, s[12:15], s90 offen offset:0 lds
s_addk_i32 m0, 3984
s_nop 0
buffer_load_dwordx4 v18, s[12:15], s90 offen offset:1152 lds
s_addk_i32 m0, 3984
s_nop 0
buffer_load_dwordx4 v18, s[12:15], s90 offen offset:2304 lds
s_mov_b32 exec_hi, -1
s_waitcnt lgkmcnt(0)
v_mfma_f32_16x16x32_bf16 v[60:63], v[44:47], v[40:43], 0
v_mfma_f32_16x16x32_bf16 v[64:67], v[48:51], v[40:43], 0
s_cmp_eq_u32 s51, 0
s_cbranch_scc0 L_AW_m0
v_mfma_f32_16x16x32_bf16 v[68:71], v[52:55], v[40:43], 0
L_AW_m0:
s_waitcnt vmcnt(18)
s_barrier
ds_read_b128 v[40:43], v9 offset:0
ds_read_b64_tr_b16 v[44:45], v10 offset:15392
ds_read_b64_tr_b16 v[46:47], v10 offset:16672
ds_read_b64_tr_b16 v[48:49], v10 offset:15424
ds_read_b64_tr_b16 v[50:51], v10 offset:16704
s_cmp_eq_u32 s51, 0
s_cbranch_scc0 L_AW_r1
ds_read_b64_tr_b16 v[52:53], v12 offset:15392
ds_read_b64_tr_b16 v[54:55], v12 offset:16672
L_AW_r1:
s_add_u32 s90, s90, 110592
s_cmp_eq_u32 s90, 1990656
s_cselect_b32 s90, 0, s90
s_addk_i32 m0, 5376
s_nop 0
buffer_load_dwordx4 v16, s[12:15], s90 offen offset:0 lds
s_addk_i32 m0, 1024
s_nop 0
buffer_load_dwordx4 v17, s[12:15], s90 offen offset:0 lds
s_addk_i32 m0, 2960
s_nop 0
buffer_load_dwordx4 v16, s[12:15], s90 offen offset:1152 lds
s_addk_i32 m0, 1024
s_nop 0
buffer_load_dwordx4 v17, s[12:15], s90 offen offset:1152 lds
s_addk_i32 m0, 2960
s_nop 0
buffer_load_dwordx4 v16, s[12:15], s90 offen offset:2304 lds
s_addk_i32 m0, 1024
s_nop 0
buffer_load_dwordx4 v17, s[12:15], s90 offen offset:2304 lds
s_addk_i32 m0, -6944
s_mov_b32 exec_hi, 0
buffer_load_dwordx4 v18, s[12:15], s90 offen offset:0 lds
s_addk_i32 m0, 3984
s_nop 0
buffer_load_dwordx4 v18, s[12:15], s90 offen offset:1152 lds
s_addk_i32 m0, 3984
s_nop 0
buffer_load_dwordx4 v18, s[12:15], s90 offen offset:2304 lds
s_mov_b32 exec_hi, -1
s_waitcnt lgkmcnt(0)
v_mfma_f32_16x16x32_bf16 v[60:63], v[44:47], v[40:43], v[60:63]
v_mfma_f32_16x16x32_bf16 v[64:67], v[48:51], v[40:43], v[64:67]
s_cmp_eq_u32 s51, 0
s_cbranch_scc0 L_AW_m1
v_mfma_f32_16x16x32_bf16 v[68:71], v[52:55], v[40:43], v[68:71]
L_AW_m1:
s_waitcnt vmcnt(18)
s_barrier
ds_read_b128 v[40:43], v8 offset:18432
ds_read_b64_tr_b16 v[44:45], v10 offset:30784
ds_read_b64_tr_b16 v[46:47], v10 offset:32064
ds_read_b64_tr_b16 v[48:49], v10 offset:30816
ds_read_b64_tr_b16 v[50:51], v10 offset:32096
s_cmp_eq_u32 s51, 0
s_cbranch_scc0 L_AW_r2
ds_read_b64_tr_b16 v[52:53], v12 offset:30784
ds_read_b64_tr_b16 v[54:55], v12 offset:32064
L_AW_r2:
s_add_u32 s90, s90, 110592
s_cmp_eq_u32 s90, 1990656
s_cselect_b32 s90, 0, s90
s_add_u32 m0, s42, 0
s_nop 0
buffer_load_dwordx4 v16, s[12:15], s90 offen offset:0 lds
s_addk_i32 m0, 1024
s_nop 0
buffer_load_dwordx4 v17, s[12:15], s90 offen offset:0 lds
s_addk_i32 m0, 2960
s_nop 0
buffer_load_dwordx4 v16, s[12:15], s90 offen offset:1152 lds
s_addk_i32 m0, 1024
s_nop 0
buffer_load_dwordx4 v17, s[12:15], s90 offen offset:1152 lds
s_addk_i32 m0, 2960
s_nop 0
buffer_load_dwordx4 v16, s[12:15], s90 offen offset:2304 lds
s_addk_i32 m0, 1024
s_nop 0
buffer_load_dwordx4 v17, s[12:15], s90 offen offset:2304 lds
s_addk_i32 m0, -6944
s_mov_b32 exec_hi, 0
buffer_load_dwordx4 v18, s[12:15], s90 offen offset:0 lds
s_addk_i32 m0, 3984
s_nop 0
buffer_load_dwordx4 v18, s[12:15], s90 offen offset:1152 lds
s_addk_i32 m0, 3984
s_nop 0
buffer_load_dwordx4 v18, s[12:15], s90 offen offset:2304 lds
s_mov_b32 exec_hi, -1
s_waitcnt lgkmcnt(0)
v_mfma_f32_16x16x32_bf16 v[60:63], v[44:47], v[40:43], v[60:63]
v_mfma_f32_16x16x32_bf16 v[64:67], v[48:51], v[40:43], v[64:67]
s_cmp_eq_u32 s51, 0
s_cbranch_scc0 L_AW_m2
v_mfma_f32_16x16x32_bf16 v[68:71], v[52:55], v[40:43], v[68:71]
L_AW_m2:
s_cmp_eq_u32 s59, 1
s_mov_b32 s24, s40
s_mov_b32 s25, s41
s_mov_b32 s26, 663552
s_mov_b32 s27, 0x20000
s_mov_b32 s28, s44
s_mov_b32 s29, s45
s_mov_b32 s30, 4718592
s_mov_b32 s31, 0x20000
s_mov_b32 s20, s46
s_mov_b32 s21, s47
s_mov_b32 s22, 256
s_mov_b32 s23, 0x20000
s_mov_b32 s16, s48
s_mov_b32 s17, s49
s_mov_b32 s18, 7340032
s_mov_b32 s19, 0x20000
s_lshl_b32 s7, s6, 4
s_add_u32 s7, s7, s5
s_lshl_b32 s53, s7, 8
s_add_u32 s53, s53, 5505024
s_add_u32 s92, s16, s53
s_addc_u32 s93, s17, 0
s_cselect_b32 s59, 1, 0
s_waitcnt vmcnt(18)
s_barrier
ds_read_b128 v[40:43], v9 offset:18432
ds_read_b64_tr_b16 v[44:45], v10 offset:46176
ds_read_b64_tr_b16 v[46:47], v10 offset:47456
ds_read_b64_tr_b16 v[48:49], v10 offset:46208
ds_read_b64_tr_b16 v[50:51], v10 offset:47488
s_cmp_eq_u32 s51, 0
s_cbranch_scc0 L_AW_r3
ds_read_b64_tr_b16 v[52:53], v12 offset:46176
ds_read_b64_tr_b16 v[54:55], v12 offset:47456
L_AW_r3:
s_add_u32 s90, s90, 110592
s_cmp_eq_u32 s90, 1990656
s_cselect_b32 s90, 0, s90
s_addk_i32 m0, 5376
s_nop 0
buffer_load_dwordx4 v16, s[12:15], s90 offen offset:0 lds
s_addk_i32 m0, 1024
s_nop 0
buffer_load_dwordx4 v17, s[12:15], s90 offen offset:0 lds
s_addk_i32 m0, 2960
s_nop 0
buffer_load_dwordx4 v16, s[12:15], s90 offen offset:1152 lds
s_addk_i32 m0, 1024
s_nop 0
buffer_load_dwordx4 v17, s[12:15], s90 offen offset:1152 lds
s_addk_i32 m0, 2960
s_nop 0
buffer_load_dwordx4 v16, s[12:15], s90 offen offset:2304 lds
s_addk_i32 m0, 1024
s_nop 0
buffer_load_dwordx4 v17, s[12:15], s90 offen offset:2304 lds
s_addk_i32 m0, -6944
s_mov_b32 exec_hi, 0
buffer_load_dwordx4 v18, s[12:15], s90 offen offset:0 lds
s_addk_i32 m0, 3984
s_nop 0
buffer_load_dwordx4 v18, s[12:15], s90 offen offset:1152 lds
s_addk_i32 m0, 3984
s_nop 0
buffer_load_dwordx4 v18, s[12:15], s90 offen offset:2304 lds
s_mov_b32 exec_hi, -1
s_waitcnt lgkmcnt(0)
v_mfma_f32_16x16x32_bf16 v[60:63], v[44:47], v[40:43], v[60:63]
v_mfma_f32_16x16x32_bf16 v[64:67], v[48:51], v[40:43], v[64:67]
s_cmp_eq_u32 s51, 0
s_cbranch_scc0 L_AW_m3
v_mfma_f32_16x16x32_bf16 v[68:71], v[52:55], v[40:43], v[68:71]
L_AW_m3:
s_cmp_eq_u32 s59, 1
s_lshl_b32 s7, s7, 2
s_add_u32 s98, s7, 32
s_lshl_b32 s99, s4, 2
s_mul_i32 s53, s4, 8192
s_add_u32 s53, s53, 5249024
s_add_u32 s94, s16, s53
s_addc_u32 s95, s17, 0
s_and_b32 s7, s4, 3
s_lshl_b32 s53, s7, 3
s_lshr_b32 s52, 0x07050200, s53
s_and_b32 s52, s52, 0xff
s_lshr_b32 s53, s4, 2
s_mul_i32 s53, s53, 9
s_add_u32 s52, s52, s53
s_lshl_b32 s52, s52, 6
s_cmp_eq_u32 s7, 1
s_cselect_b32 s55, 64, 0
s_cmp_lt_u32 s7, 2
s_cselect_b32 s56, 12, 8
v_add_u32 v1, 0, v0
v_mul_u32_u24 v2, 5462, v1
v_lshrrev_b32 v2, 16, v2
s_cselect_b32 s59, 1, 0
s_waitcnt vmcnt(18)
s_barrier
ds_read_b128 v[40:43], v8 offset:36864
ds_read_b64_tr_b16 v[44:45], v13 offset:0
ds_read_b64_tr_b16 v[46:47], v13 offset:1280
ds_read_b64_tr_b16 v[48:49], v13 offset:32
ds_read_b64_tr_b16 v[50:51], v13 offset:1312
s_cmp_eq_u32 s51, 0
s_cbranch_scc0 L_AW_r4
ds_read_b64_tr_b16 v[52:53], v15 offset:0
ds_read_b64_tr_b16 v[54:55], v15 offset:1280
L_AW_r4:
s_add_u32 s90, s90, 110592
s_cmp_eq_u32 s90, 1990656
s_cselect_b32 s90, 0, s90
s_addk_i32 m0, 5376
s_nop 0
buffer_load_dwordx4 v16, s[12:15], s90 offen offset:0 lds
s_addk_i32 m0, 1024
s_nop 0
buffer_load_dwordx4 v17, s[12:15], s90 offen offset:0 lds
s_addk_i32 m0, 2960
s_nop 0
buffer_load_dwordx4 v16, s[12:15], s90 offen offset:1152 lds
s_addk_i32 m0, 1024
s_nop 0
buffer_load_dwordx4 v17, s[12:15], s90 offen offset:1152 lds
s_addk_i32 m0, 2960
s_nop 0
buffer_load_dwordx4 v16, s[12:15], s90 offen offset:2304 lds
s_addk_i32 m0, 1024
s_nop 0
buffer_load_dwordx4 v17, s[12:15], s90 offen offset:2304 lds
s_addk_i32 m0, -6944
s_mov_b32 exec_hi, 0
buffer_load_dwordx4 v18, s[12:15], s90 offen offset:0 lds
s_addk_i32 m0, 3984
s_nop 0
buffer_load_dwordx4 v18, s[12:15], s90 offen offset:1152 lds
s_addk_i32 m0, 3984
s_nop 0
buffer_load_dwordx4 v18, s[12:15], s90 offen offset:2304 lds
s_mov_b32 exec_hi, -1
s_waitcnt lgkmcnt(0)
v_mfma_f32_16x16x32_bf16 v[60:63], v[44:47], v[40:43], v[60:63]
v_mfma_f32_16x16x32_bf16 v[64:67], v[48:51], v[40:43], v[64:67]
s_cmp_eq_u32 s51, 0
s_cbranch_scc0 L_AW_m4
v_mfma_f32_16x16x32_bf16 v[68:71], v[52:55], v[40:43], v[68:71]
L_AW_m4:
s_cmp_eq_u32 s59, 1
v_mad_i32_i24 v1, v2, -12, v1
v_bfe_u32 v3, v2, 2, 1
v_lshlrev_b32 v4, 1, v3
v_xor_b32 v1, v1, v4
v_cmp_gt_u32 vcc, s56, v1
v_lshl_add_u32 v1, v1, 4, s52
v_mov_b32 v4, 8388608
v_cndmask_b32 v1, v4, v1, vcc
v_and_b32 v4, 3, v2
v_lshl_add_u32 v5, v3, 2, v4
v_mul_u32_u24 v3, 72, v3
v_add_u32 v4, v3, v4
v_bfe_u32 v3, v2, 3, 1
v_lshl_add_u32 v5, v3, 4, v5
v_lshl_add_u32 v4, v3, 2, v4
v_bfe_u32 v3, v2, 4, 1
v_lshl_add_u32 v5, v3, 3, v5
v_mul_u32_u24 v3, 144, v3
v_add_u32 v4, v3, v4
v_mul_u32_u24 v5, 1152, v5
v_add_u32 v26, v5, v1
v_mul_u32_u24 v4, 1152, v4
s_cselect_b32 s59, 1, 0
s_waitcnt vmcnt(18)
s_barrier
ds_read_b128 v[40:43], v9 offset:36864
ds_read_b64_tr_b16 v[44:45], v10 offset:0
ds_read_b64_tr_b16 v[46:47], v10 offset:1280
ds_read_b64_tr_b16 v[48:49], v10 offset:32
ds_read_b64_tr_b16 v[50:51], v10 offset:1312
s_cmp_eq_u32 s51, 0
s_cbranch_scc0 L_AW_r5
ds_read_b64_tr_b16 v[52:53], v12 offset:0
ds_read_b64_tr_b16 v[54:55], v12 offset:1280
L_AW_r5:
s_add_u32 s90, s90, 110592
s_cmp_eq_u32 s90, 1990656
s_cselect_b32 s90, 0, s90
s_addk_i32 m0, 5376
s_nop 0
buffer_load_dwordx4 v16, s[12:15], s90 offen offset:0 lds
s_addk_i32 m0, 1024
s_nop 0
buffer_load_dwordx4 v17, s[12:15], s90 offen offset:0 lds
s_addk_i32 m0, 2960
s_nop 0
buffer_load_dwordx4 v16, s[12:15], s90 offen offset:1152 lds
s_addk_i32 m0, 1024
s_nop 0
buffer_load_dwordx4 v17, s[12:15], s90 offen offset:1152 lds
s_addk_i32 m0, 2960
s_nop 0
buffer_load_dwordx4 v16, s[12:15], s90 offen offset:2304 lds
s_addk_i32 m0, 1024
s_nop 0
buffer_load_dwordx4 v17, s[12:15], s90 offen offset:2304 lds
s_addk_i32 m0, -6944
s_mov_b32 exec_hi, 0
buffer_load_dwordx4 v18, s[12:15], s90 offen offset:0 lds
s_addk_i32 m0, 3984
s_nop 0
buffer_load_dwordx4 v18, s[12:15], s90 offen offset:1152 lds
s_addk_i32 m0, 3984
s_nop 0
buffer_load_dwordx4 v18, s[12:15], s90 offen offset:2304 lds
s_mov_b32 exec_hi, -1
s_waitcnt lgkmcnt(0)
v_mfma_f32_16x16x32_bf16 v[60:63], v[44:47], v[40:43], v[60:63]
v_mfma_f32_16x16x32_bf16 v[64:67], v[48:51], v[40:43], v[64:67]
s_cmp_eq_u32 s51, 0
s_cbranch_scc0 L_AW_m5
v_mfma_f32_16x16x32_bf16 v[68:71], v[52:55], v[40:43], v[68:71]
L_AW_m5:
s_cmp_eq_u32 s59, 1
v_add_u32 v32, v4, v1
v_add_u32 v1, 64, v0
v_mul_u32_u24 v2, 5462, v1
v_lshrrev_b32 v2, 16, v2
v_mad_i32_i24 v1, v2, -12, v1
v_bfe_u32 v3, v2, 2, 1
v_lshlrev_b32 v4, 1, v3
v_xor_b32 v1, v1, v4
v_cmp_gt_u32 vcc, s56, v1
v_lshl_add_u32 v1, v1, 4, s52
v_mov_b32 v4, 8388608
v_cndmask_b32 v1, v4, v1, vcc
v_and_b32 v4, 3, v2
v_lshl_add_u32 v5, v3, 2, v4
v_mul_u32_u24 v3, 72, v3
v_add_u32 v4, v3, v4
v_bfe_u32 v3, v2, 3, 1
v_lshl_add_u32 v5, v3, 4, v5
v_lshl_add_u32 v4, v3, 2, v4
v_bfe_u32 v3, v2, 4, 1
v_lshl_add_u32 v5, v3, 3, v5
v_mul_u32_u24 v3, 144, v3
s_cselect_b32 s59, 1, 0
s_waitcnt vmcnt(18)
s_barrier
ds_read_b128 v[40:43], v8 offset:0
ds_read_b64_tr_b16 v[44:45], v10 offset:15392
ds_read_b64_tr_b16 v[46:47], v10 offset:16672
ds_read_b64_tr_b16 v[48:49], v10 offset:15424
ds_read_b64_tr_b16 v[50:51], v10 offset:16704
s_cmp_eq_u32 s51, 0
s_cbranch_scc0 L_AW_r6
ds_read_b64_tr_b16 v[52:53], v12 offset:15392
ds_read_b64_tr_b16 v[54:55], v12 offset:16672
L_AW_r6:
s_add_u32 s90, s90, 110592
s_cmp_eq_u32 s90, 1990656
s_cselect_b32 s90, 0, s90
s_addk_i32 m0, 5376
s_nop 0
buffer_load_dwordx4 v16, s[12:15], s90 offen offset:0 lds
s_addk_i32 m0, 1024
s_nop 0
buffer_load_dwordx4 v17, s[12:15], s90 offen offset:0 lds
s_addk_i32 m0, 2960
s_nop 0
buffer_load_dwordx4 v16, s[12:15], s90 offen offset:1152 lds
s_addk_i32 m0, 1024
s_nop 0
buffer_load_dwordx4 v17, s[12:15], s90 offen offset:1152 lds
s_addk_i32 m0, 2960
s_nop 0
buffer_load_dwordx4 v16, s[12:15], s90 offen offset:2304 lds
s_addk_i32 m0, 1024
s_nop 0
buffer_load_dwordx4 v17, s[12:15], s90 offen offset:2304 lds
s_addk_i32 m0, -6944
s_mov_b32 exec_hi, 0
buffer_load_dwordx4 v18, s[12:15], s90 offen offset:0 lds
s_addk_i32 m0, 3984
s_nop 0
buffer_load_dwordx4 v18, s[12:15], s90 offen offset:1152 lds
s_addk_i32 m0, 3984
s_nop 0
buffer_load_dwordx4 v18, s[12:15], s90 offen offset:2304 lds
s_mov_b32 exec_hi, -1
s_waitcnt lgkmcnt(0)
v_mfma_f32_16x16x32_bf16 v[60:63], v[44:47], v[40:43], v[60:63]
v_mfma_f32_16x16x32_bf16 v[64:67], v[48:51], v[40:43], v[64:67]
s_cmp_eq_u32 s51, 0
s_cbranch_scc0 L_AW_m6
v_mfma_f32_16x16x32_bf16 v[68:71], v[52:55], v[40:43], v[68:71]
L_AW_m6:
s_cmp_eq_u32 s59, 1
v_add_u32 v4, v3, v4
v_mul_u32_u24 v5, 1152, v5
v_add_u32 v27, v5, v1
v_mul_u32_u24 v4, 1152, v4
v_add_u32 v33, v4, v1
v_add_u32 v1, 128, v0
v_mul_u32_u24 v2, 5462, v1
v_lshrrev_b32 v2, 16, v2
v_mad_i32_i24 v1, v2, -12, v1
v_bfe_u32 v3, v2, 2, 1
v_lshlrev_b32 v4, 1, v3
v_xor_b32 v1, v1, v4
v_cmp_gt_u32 vcc, s56, v1
v_lshl_add_u32 v1, v1, 4, s52
v_mov_b32 v4, 8388608
v_cndmask_b32 v1, v4, v1, vcc
v_and_b32 v4, 3, v2
v_lshl_add_u32 v5, v3, 2, v4
v_mul_u32_u24 v3, 72, v3
v_add_u32 v4, v3, v4
v_bfe_u32 v3, v2, 3, 1
v_lshl_add_u32 v5, v3, 4, v5
s_cselect_b32 s59, 1, 0
s_waitcnt vmcnt(18)
s_barrier
ds_read_b128 v[40:43], v9 offset:0
ds_read_b64_tr_b16 v[44:45], v10 offset:30784
ds_read_b64_tr_b16 v[46:47], v10 offset:32064
ds_read_b64_tr_b16 v[48:49], v10 offset:30816
ds_read_b64_tr_b16 v[50:51], v10 offset:32096
s_cmp_eq_u32 s51, 0
s_cbranch_scc0 L_AW_r7
ds_read_b64_tr_b16 v[52:53], v12 offset:30784
ds_read_b64_tr_b16 v[54:55], v12 offset:32064
L_AW_r7:
s_add_u32 s90, s90, 110592
s_cmp_eq_u32 s90, 1990656
s_cselect_b32 s90, 0, s90
s_add_u32 m0, s42, 0
s_nop 0
buffer_load_dwordx4 v16, s[12:15], s90 offen offset:0 lds
s_addk_i32 m0, 1024
s_nop 0
buffer_load_dwordx4 v17, s[12:15], s90 offen offset:0 lds
s_addk_i32 m0, 2960
s_nop 0
buffer_load_dwordx4 v16, s[12:15], s90 offen offset:1152 lds
s_addk_i32 m0, 1024
s_nop 0
buffer_load_dwordx4 v17, s[12:15], s90 offen offset:1152 lds
s_addk_i32 m0, 2960
s_nop 0
buffer_load_dwordx4 v16, s[12:15], s90 offen offset:2304 lds
s_addk_i32 m0, 1024
s_nop 0
buffer_load_dwordx4 v17, s[12:15], s90 offen offset:2304 lds
s_addk_i32 m0, -6944
s_mov_b32 exec_hi, 0
buffer_load_dwordx4 v18, s[12:15], s90 offen offset:0 lds
s_addk_i32 m0, 3984
s_nop 0
buffer_load_dwordx4 v18, s[12:15], s90 offen offset:1152 lds
s_addk_i32 m0, 3984
s_nop 0
buffer_load_dwordx4 v18, s[12:15], s90 offen offset:2304 lds
s_mov_b32 exec_hi, -1
s_waitcnt lgkmcnt(0)
v_mfma_f32_16x16x32_bf16 v[60:63], v[44:47], v[40:43], v[60:63]
v_mfma_f32_16x16x32_bf16 v[64:67], v[48:51], v[40:43], v[64:67]
s_cmp_eq_u32 s51, 0
s_cbranch_scc0 L_AW_m7
v_mfma_f32_16x16x32_bf16 v[68:71], v[52:55], v[40:43], v[68:71]
L_AW_m7:
s_cmp_eq_u32 s59, 1
v_lshl_add_u32 v4, v3, 2, v4
v_bfe_u32 v3, v2, 4, 1
v_lshl_add_u32 v5, v3, 3, v5
v_mul_u32_u24 v3, 144, v3
v_add_u32 v4, v3, v4
v_mul_u32_u24 v5, 1152, v5
v_add_u32 v28, v5, v1
v_mul_u32_u24 v4, 1152, v4
v_add_u32 v34, v4, v1
v_add_u32 v1, 192, v0
v_mul_u32_u24 v2, 5462, v1
v_lshrrev_b32 v2, 16, v2
v_mad_i32_i24 v1, v2, -12, v1
v_bfe_u32 v3, v2, 2, 1
v_lshlrev_b32 v4, 1, v3
v_xor_b32 v1, v1, v4
v_cmp_gt_u32 vcc, s56, v1
v_lshl_add_u32 v1, v1, 4, s52
v_mov_b32 v4, 8388608
v_cndmask_b32 v1, v4, v1, vcc
v_and_b32 v4, 3, v2
v_lshl_add_u32 v5, v3, 2, v4
s_cselect_b32 s59, 1, 0
s_waitcnt vmcnt(18)
s_barrier
ds_read_b128 v[40:43], v8 offset:18432
ds_read_b64_tr_b16 v[44:45], v10 offset:46176
ds_read_b64_tr_b16 v[46:47], v10 offset:47456
ds_read_b64_tr_b16 v[48:49], v10 offset:46208
ds_read_b64_tr_b16 v[50:51], v10 offset:47488
s_cmp_eq_u32 s51, 0
s_cbranch_scc0 L_AW_r8
ds_read_b64_tr_b16 v[52:53], v12 offset:46176
ds_read_b64_tr_b16 v[54:55], v12 offset:47456
L_AW_r8:
s_add_u32 s90, s90, 110592
s_cmp_eq_u32 s90, 1990656
s_cselect_b32 s90, 0, s90
s_addk_i32 m0, 5376
s_nop 0
buffer_load_dwordx4 v16, s[12:15], s90 offen offset:0 lds
s_addk_i32 m0, 1024
s_nop 0
buffer_load_dwordx4 v17, s[12:15], s90 offen offset:0 lds
s_addk_i32 m0, 2960
s_nop 0
buffer_load_dwordx4 v16, s[12:15], s90 offen offset:1152 lds
s_addk_i32 m0, 1024
s_nop 0
buffer_load_dwordx4 v17, s[12:15], s90 offen offset:1152 lds
s_addk_i32 m0, 2960
s_nop 0
buffer_load_dwordx4 v16, s[12:15], s90 offen offset:2304 lds
s_addk_i32 m0, 1024
s_nop 0
buffer_load_dwordx4 v17, s[12:15], s90 offen offset:2304 lds
s_addk_i32 m0, -6944
s_mov_b32 exec_hi, 0
buffer_load_dwordx4 v18, s[12:15], s90 offen offset:0 lds
s_addk_i32 m0, 3984
s_nop 0
buffer_load_dwordx4 v18, s[12:15], s90 offen offset:1152 lds
s_addk_i32 m0, 3984
s_nop 0
buffer_load_dwordx4 v18, s[12:15], s90 offen offset:2304 lds
s_mov_b32 exec_hi, -1
s_waitcnt lgkmcnt(0)
v_mfma_f32_16x16x32_bf16 v[60:63], v[44:47], v[40:43], v[60:63]
v_mfma_f32_16x16x32_bf16 v[64:67], v[48:51], v[40:43], v[64:67]
s_cmp_eq_u32 s51, 0
s_cbranch_scc0 L_AW_m8
v_mfma_f32_16x16x32_bf16 v[68:71], v[52:55], v[40:43], v[68:71]
L_AW_m8:
s_cmp_eq_u32 s59, 1
v_mul_u32_u24 v3, 72, v3
v_add_u32 v4, v3, v4
v_bfe_u32 v3, v2, 3, 1
v_lshl_add_u32 v5, v3, 4, v5
v_lshl_add_u32 v4, v3, 2, v4
v_bfe_u32 v3, v2, 4, 1
v_lshl_add_u32 v5, v3, 3, v5
v_mul_u32_u24 v3, 144, v3
v_add_u32 v4, v3, v4
v_mul_u32_u24 v5, 1152, v5
v_add_u32 v29, v5, v1
v_mul_u32_u24 v4, 1152, v4
v_add_u32 v35, v4, v1
v_add_u32 v1, 256, v0
v_mul_u32_u24 v2, 5462, v1
v_lshrrev_b32 v2, 16, v2
v_mad_i32_i24 v1, v2, -12, v1
v_bfe_u32 v3, v2, 2, 1
v_lshlrev_b32 v4, 1, v3
v_xor_b32 v1, v1, v4
v_cmp_gt_u32 vcc, s56, v1
v_lshl_add_u32 v1, v1, 4, s52
s_cselect_b32 s59, 1, 0
s_waitcnt vmcnt(18)
s_barrier
ds_read_b128 v[40:43], v9 offset:18432
ds_read_b64_tr_b16 v[44:45], v13 offset:0
ds_read_b64_tr_b16 v[46:47], v13 offset:1280
ds_read_b64_tr_b16 v[48:49], v13 offset:32
ds_read_b64_tr_b16 v[50:51], v13 offset:1312
s_cmp_eq_u32 s51, 0
s_cbranch_scc0 L_AW_r9
ds_read_b64_tr_b16 v[52:53], v15 offset:0
ds_read_b64_tr_b16 v[54:55], v15 offset:1280
L_AW_r9:
s_add_u32 s90, s90, 110592
s_cmp_eq_u32 s90, 1990656
s_cselect_b32 s90, 0, s90
s_addk_i32 m0, 5376
s_nop 0
buffer_load_dwordx4 v16, s[12:15], s90 offen offset:0 lds
s_addk_i32 m0, 1024
s_nop 0
buffer_load_dwordx4 v17, s[12:15], s90 offen offset:0 lds
s_addk_i32 m0, 2960
s_nop 0
buffer_load_dwordx4 v16, s[12:15], s90 offen offset:1152 lds
s_addk_i32 m0, 1024
s_nop 0
buffer_load_dwordx4 v17, s[12:15], s90 offen offset:1152 lds
s_addk_i32 m0, 2960
s_nop 0
buffer_load_dwordx4 v16, s[12:15], s90 offen offset:2304 lds
s_addk_i32 m0, 1024
s_nop 0
buffer_load_dwordx4 v17, s[12:15], s90 offen offset:2304 lds
s_addk_i32 m0, -6944
s_mov_b32 exec_hi, 0
buffer_load_dwordx4 v18, s[12:15], s90 offen offset:0 lds
s_addk_i32 m0, 3984
s_nop 0
buffer_load_dwordx4 v18, s[12:15], s90 offen offset:1152 lds
s_addk_i32 m0, 3984
s_nop 0
buffer_load_dwordx4 v18, s[12:15], s90 offen offset:2304 lds
s_mov_b32 exec_hi, -1
s_waitcnt lgkmcnt(0)
v_mfma_f32_16x16x32_bf16 v[60:63], v[44:47], v[40:43], v[60:63]
v_mfma_f32_16x16x32_bf16 v[64:67], v[48:51], v[40:43], v[64:67]
s_cmp_eq_u32 s51, 0
s_cbranch_scc0 L_AW_m9
v_mfma_f32_16x16x32_bf16 v[68:71], v[52:55], v[40:43], v[68:71]
L_AW_m9:
s_cmp_eq_u32 s59, 1
v_mov_b32 v4, 8388608
v_cndmask_b32 v1, v4, v1, vcc
v_and_b32 v4, 3, v2
v_lshl_add_u32 v5, v3, 2, v4
v_mul_u32_u24 v3, 72, v3
v_add_u32 v4, v3, v4
v_bfe_u32 v3, v2, 3, 1
v_lshl_add_u32 v5, v3, 4, v5
v_lshl_add_u32 v4, v3, 2, v4
v_bfe_u32 v3, v2, 4, 1
v_lshl_add_u32 v5, v3, 3, v5
v_mul_u32_u24 v3, 144, v3
v_add_u32 v4, v3, v4
v_mul_u32_u24 v5, 1152, v5
v_add_u32 v30, v5, v1
v_mul_u32_u24 v4, 1152, v4
v_add_u32 v36, v4, v1
v_add_u32 v1, 320, v0
v_mul_u32_u24 v2, 5462, v1
v_lshrrev_b32 v2, 16, v2
v_mad_i32_i24 v1, v2, -12, v1
v_bfe_u32 v3, v2, 2, 1
s_cselect_b32 s59, 1, 0
s_waitcnt vmcnt(18)
s_barrier
ds_read_b128 v[40:43], v8 offset:36864
ds_read_b64_tr_b16 v[44:45], v10 offset:0
ds_read_b64_tr_b16 v[46:47], v10 offset:1280
ds_read_b64_tr_b16 v[48:49], v10 offset:32
ds_read_b64_tr_b16 v[50:51], v10 offset:1312
s_cmp_eq_u32 s51, 0
s_cbranch_scc0 L_AW_r10
ds_read_b64_tr_b16 v[52:53], v12 offset:0
ds_read_b64_tr_b16 v[54:55], v12 offset:1280
L_AW_r10:
s_add_u32 s90, s90, 110592
s_cmp_eq_u32 s90, 1990656
s_cselect_b32 s90, 0, s90
s_addk_i32 m0, 5376
s_nop 0
buffer_load_dwordx4 v16, s[12:15], s90 offen offset:0 lds
s_addk_i32 m0, 1024
s_nop 0
buffer_load_dwordx4 v17, s[12:15], s90 offen offset:0 lds
s_addk_i32 m0, 2960
s_nop 0
buffer_load_dwordx4 v16, s[12:15], s90 offen offset:1152 lds
s_addk_i32 m0, 1024
s_nop 0
buffer_load_dwordx4 v17, s[12:15], s90 offen offset:1152 lds
s_addk_i32 m0, 2960
s_nop 0
buffer_load_dwordx4 v16, s[12:15], s90 offen offset:2304 lds
s_addk_i32 m0, 1024
s_nop 0
buffer_load_dwordx4 v17, s[12:15], s90 offen offset:2304 lds
s_addk_i32 m0, -6944
s_mov_b32 exec_hi, 0
buffer_load_dwordx4 v18, s[12:15], s90 offen offset:0 lds
s_addk_i32 m0, 3984
s_nop 0
buffer_load_dwordx4 v18, s[12:15], s90 offen offset:1152 lds
s_addk_i32 m0, 3984
s_nop 0
buffer_load_dwordx4 v18, s[12:15], s90 offen offset:2304 lds
s_mov_b32 exec_hi, -1
s_waitcnt lgkmcnt(0)
v_mfma_f32_16x16x32_bf16 v[60:63], v[44:47], v[40:43], v[60:63]
v_mfma_f32_16x16x32_bf16 v[64:67], v[48:51], v[40:43], v[64:67]
s_cmp_eq_u32 s51, 0
s_cbranch_scc0 L_AW_m10
v_mfma_f32_16x16x32_bf16 v[68:71], v[52:55], v[40:43], v[68:71]
L_AW_m10:
s_cmp_eq_u32 s59, 1
v_lshlrev_b32 v4, 1, v3
v_xor_b32 v1, v1, v4
v_cmp_gt_u32 vcc, s56, v1
v_lshl_add_u32 v1, v1, 4, s52
v_mov_b32 v4, 8388608
v_cndmask_b32 v1, v4, v1, vcc
v_and_b32 v4, 3, v2
v_lshl_add_u32 v5, v3, 2, v4
v_mul_u32_u24 v3, 72, v3
v_add_u32 v4, v3, v4
v_bfe_u32 v3, v2, 3, 1
v_lshl_add_u32 v5, v3, 4, v5
v_lshl_add_u32 v4, v3, 2, v4
v_bfe_u32 v3, v2, 4, 1
v_lshl_add_u32 v5, v3, 3, v5
v_mul_u32_u24 v3, 144, v3
v_add_u32 v4, v3, v4
v_mul_u32_u24 v5, 1152, v5
v_add_u32 v31, v5, v1
v_mul_u32_u24 v4, 1152, v4
v_add_u32 v37, v4, v1
s_and_b32 s55, s3, 3
s_cselect_b32 s59, 1, 0
s_waitcnt vmcnt(18)
s_barrier
ds_read_b128 v[40:43], v9 offset:36864
ds_read_b64_tr_b16 v[44:45], v10 offset:15392
ds_read_b64_tr_b16 v[46:47], v10 offset:16672
ds_read_b64_tr_b16 v[48:49], v10 offset:15424
ds_read_b64_tr_b16 v[50:51], v10 offset:16704
s_cmp_eq_u32 s51, 0
s_cbranch_scc0 L_AW_r11
ds_read_b64_tr_b16 v[52:53], v12 offset:15392
ds_read_b64_tr_b16 v[54:55], v12 offset:16672
L_AW_r11:
s_add_u32 s90, s90, 110592
s_cmp_eq_u32 s90, 1990656
s_cselect_b32 s90, 0, s90
s_addk_i32 m0, 5376
s_nop 0
buffer_load_dwordx4 v16, s[12:15], s90 offen offset:0 lds
s_addk_i32 m0, 1024
s_nop 0
buffer_load_dwordx4 v17, s[12:15], s90 offen offset:0 lds
s_addk_i32 m0, 2960
s_nop 0
buffer_load_dwordx4 v16, s[12:15], s90 offen offset:1152 lds
s_addk_i32 m0, 1024
s_nop 0
buffer_load_dwordx4 v17, s[12:15], s90 offen offset:1152 lds
s_addk_i32 m0, 2960
s_nop 0
buffer_load_dwordx4 v16, s[12:15], s90 offen offset:2304 lds
s_addk_i32 m0, 1024
s_nop 0
buffer_load_dwordx4 v17, s[12:15], s90 offen offset:2304 lds
s_addk_i32 m0, -6944
s_mov_b32 exec_hi, 0
buffer_load_dwordx4 v18, s[12:15], s90 offen offset:0 lds
s_addk_i32 m0, 3984
s_nop 0
buffer_load_dwordx4 v18, s[12:15], s90 offen offset:1152 lds
s_addk_i32 m0, 3984
s_nop 0
buffer_load_dwordx4 v18, s[12:15], s90 offen offset:2304 lds
s_mov_b32 exec_hi, -1
s_waitcnt lgkmcnt(0)
v_mfma_f32_16x16x32_bf16 v[60:63], v[44:47], v[40:43], v[60:63]
v_mfma_f32_16x16x32_bf16 v[64:67], v[48:51], v[40:43], v[64:67]
s_cmp_eq_u32 s51, 0
s_cbranch_scc0 L_AW_m11
v_mfma_f32_16x16x32_bf16 v[68:71], v[52:55], v[40:43], v[68:71]
L_AW_m11:
s_cmp_eq_u32 s59, 1
s_lshl_b32 s57, s55, 3
s_and_b32 s7, s5, 3
s_lshl_b32 s7, s7, 3
s_lshr_b32 s7, 0x14100800, s7
s_and_b32 s7, s7, 0xff
s_lshr_b32 s56, 0x7654321, s7
s_sub_u32 s7, 28, s7
s_lshl_b32 s7, 0x7654321, s7
s_or_b32 s56, s56, s7
s_lshl_b32 s56, s56, 4
s_mul_i32 s7, s4, 0x11111111
s_add_u32 s56, s56, s7
s_and_b32 s56, s56, 0x77777777
s_lshr_b32 s7, s55, 1
s_lshl_b32 s7, s7, 2
s_lshr_b32 s56, s56, s7
s_lshl_b32 s7, s51, 10
s_add_u32 s7, s7, 132256
v_lshlrev_b32 v1, 3, v0
v_add_u32 v6, s7, v1
v_add_u32 v7, 134304, v1
s_cselect_b32 s59, 1, 0
s_waitcnt vmcnt(18)
s_barrier
ds_read_b128 v[40:43], v8 offset:0
ds_read_b64_tr_b16 v[44:45], v10 offset:30784
ds_read_b64_tr_b16 v[46:47], v10 offset:32064
ds_read_b64_tr_b16 v[48:49], v10 offset:30816
ds_read_b64_tr_b16 v[50:51], v10 offset:32096
s_cmp_eq_u32 s51, 0
s_cbranch_scc0 L_AW_r12
ds_read_b64_tr_b16 v[52:53], v12 offset:30784
ds_read_b64_tr_b16 v[54:55], v12 offset:32064
L_AW_r12:
s_add_u32 s90, s90, 110592
s_cmp_eq_u32 s90, 1990656
s_cselect_b32 s90, 0, s90
s_add_u32 m0, s42, 0
s_nop 0
buffer_load_dwordx4 v16, s[12:15], s90 offen offset:0 lds
s_addk_i32 m0, 1024
s_nop 0
buffer_load_dwordx4 v17, s[12:15], s90 offen offset:0 lds
s_addk_i32 m0, 2960
s_nop 0
buffer_load_dwordx4 v16, s[12:15], s90 offen offset:1152 lds
s_addk_i32 m0, 1024
s_nop 0
buffer_load_dwordx4 v17, s[12:15], s90 offen offset:1152 lds
s_addk_i32 m0, 2960
s_nop 0
buffer_load_dwordx4 v16, s[12:15], s90 offen offset:2304 lds
s_addk_i32 m0, 1024
s_nop 0
buffer_load_dwordx4 v17, s[12:15], s90 offen offset:2304 lds
s_addk_i32 m0, -6944
s_mov_b32 exec_hi, 0
buffer_load_dwordx4 v18, s[12:15], s90 offen offset:0 lds
s_addk_i32 m0, 3984
s_nop 0
buffer_load_dwordx4 v18, s[12:15], s90 offen offset:1152 lds
s_addk_i32 m0, 3984
s_nop 0
buffer_load_dwordx4 v18, s[12:15], s90 offen offset:2304 lds
s_mov_b32 exec_hi, -1
s_waitcnt lgkmcnt(0)
v_mfma_f32_16x16x32_bf16 v[60:63], v[44:47], v[40:43], v[60:63]
v_mfma_f32_16x16x32_bf16 v[64:67], v[48:51], v[40:43], v[64:67]
s_cmp_eq_u32 s51, 0
s_cbranch_scc0 L_AW_m12
v_mfma_f32_16x16x32_bf16 v[68:71], v[52:55], v[40:43], v[68:71]
L_AW_m12:
s_waitcnt vmcnt(18)
s_barrier
ds_read_b128 v[40:43], v9 offset:0
ds_read_b64_tr_b16 v[44:45], v10 offset:46176
ds_read_b64_tr_b16 v[46:47], v10 offset:47456
ds_read_b64_tr_b16 v[48:49], v10 offset:46208
ds_read_b64_tr_b16 v[50:51], v10 offset:47488
s_cmp_eq_u32 s51, 0
s_cbranch_scc0 L_AW_r13
ds_read_b64_tr_b16 v[52:53], v12 offset:46176
ds_read_b64_tr_b16 v[54:55], v12 offset:47456
L_AW_r13:
s_add_u32 s90, s90, 110592
s_cmp_eq_u32 s90, 1990656
s_cselect_b32 s90, 0, s90
s_addk_i32 m0, 5376
s_nop 0
buffer_load_dwordx4 v16, s[12:15], s90 offen offset:0 lds
s_addk_i32 m0, 1024
s_nop 0
buffer_load_dwordx4 v17, s[12:15], s90 offen offset:0 lds
s_addk_i32 m0, 2960
s_nop 0
buffer_load_dwordx4 v16, s[12:15], s90 offen offset:1152 lds
s_addk_i32 m0, 1024
s_nop 0
buffer_load_dwordx4 v17, s[12:15], s90 offen offset:1152 lds
s_addk_i32 m0, 2960
s_nop 0
buffer_load_dwordx4 v16, s[12:15], s90 offen offset:2304 lds
s_addk_i32 m0, 1024
s_nop 0
buffer_load_dwordx4 v17, s[12:15], s90 offen offset:2304 lds
s_addk_i32 m0, -6944
s_mov_b32 exec_hi, 0
buffer_load_dwordx4 v18, s[12:15], s90 offen offset:0 lds
s_addk_i32 m0, 3984
s_nop 0
buffer_load_dwordx4 v18, s[12:15], s90 offen offset:1152 lds
s_addk_i32 m0, 3984
s_nop 0
buffer_load_dwordx4 v18, s[12:15], s90 offen offset:2304 lds
s_mov_b32 exec_hi, -1
s_waitcnt lgkmcnt(0)
v_mfma_f32_16x16x32_bf16 v[60:63], v[44:47], v[40:43], v[60:63]
v_mfma_f32_16x16x32_bf16 v[64:67], v[48:51], v[40:43], v[64:67]
s_cmp_eq_u32 s51, 0
s_cbranch_scc0 L_AW_m13
v_mfma_f32_16x16x32_bf16 v[68:71], v[52:55], v[40:43], v[68:71]
L_AW_m13:
s_waitcnt vmcnt(18)
s_barrier
ds_read_b128 v[40:43], v8 offset:18432
ds_read_b64_tr_b16 v[44:45], v13 offset:0
ds_read_b64_tr_b16 v[46:47], v13 offset:1280
ds_read_b64_tr_b16 v[48:49], v13 offset:32
ds_read_b64_tr_b16 v[50:51], v13 offset:1312
s_cmp_eq_u32 s51, 0
s_cbranch_scc0 L_AW_r14
ds_read_b64_tr_b16 v[52:53], v15 offset:0
ds_read_b64_tr_b16 v[54:55], v15 offset:1280
L_AW_r14:
s_add_u32 s90, s90, 110592
s_cmp_eq_u32 s90, 1990656
s_cselect_b32 s90, 0, s90
s_addk_i32 m0, 5376
s_nop 0
buffer_load_dwordx4 v16, s[12:15], s90 offen offset:0 lds
s_addk_i32 m0, 1024
s_nop 0
buffer_load_dwordx4 v17, s[12:15], s90 offen offset:0 lds
s_addk_i32 m0, 2960
s_nop 0
buffer_load_dwordx4 v16, s[12:15], s90 offen offset:1152 lds
s_addk_i32 m0, 1024
s_nop 0
buffer_load_dwordx4 v17, s[12:15], s90 offen offset:1152 lds
s_addk_i32 m0, 2960
s_nop 0
buffer_load_dwordx4 v16, s[12:15], s90 offen offset:2304 lds
s_addk_i32 m0, 1024
s_nop 0
buffer_load_dwordx4 v17, s[12:15], s90 offen offset:2304 lds
s_addk_i32 m0, -6944
s_mov_b32 exec_hi, 0
buffer_load_dwordx4 v18, s[12:15], s90 offen offset:0 lds
s_addk_i32 m0, 3984
s_nop 0
buffer_load_dwordx4 v18, s[12:15], s90 offen offset:1152 lds
s_addk_i32 m0, 3984
s_nop 0
buffer_load_dwordx4 v18, s[12:15], s90 offen offset:2304 lds
s_mov_b32 exec_hi, -1
s_waitcnt lgkmcnt(0)
v_mfma_f32_16x16x32_bf16 v[60:63], v[44:47], v[40:43], v[60:63]
v_mfma_f32_16x16x32_bf16 v[64:67], v[48:51], v[40:43], v[64:67]
s_cmp_eq_u32 s51, 0
s_cbranch_scc0 L_AW_m14
v_mfma_f32_16x16x32_bf16 v[68:71], v[52:55], v[40:43], v[68:71]
L_AW_m14:
s_waitcnt vmcnt(18)
s_barrier
ds_read_b128 v[40:43], v9 offset:18432
ds_read_b64_tr_b16 v[44:45], v10 offset:0
ds_read_b64_tr_b16 v[46:47], v10 offset:1280
ds_read_b64_tr_b16 v[48:49], v10 offset:32
ds_read_b64_tr_b16 v[50:51], v10 offset:1312
s_cmp_eq_u32 s51, 0
s_cbranch_scc0 L_AW_r15
ds_read_b64_tr_b16 v[52:53], v12 offset:0
ds_read_b64_tr_b16 v[54:55], v12 offset:1280
L_AW_r15:
s_waitcnt lgkmcnt(0)
v_mfma_f32_16x16x32_bf16 v[60:63], v[44:47], v[40:43], v[60:63]
v_mfma_f32_16x16x32_bf16 v[64:67], v[48:51], v[40:43], v[64:67]
s_cmp_eq_u32 s51, 0
s_cbranch_scc0 L_AW_m15
v_mfma_f32_16x16x32_bf16 v[68:71], v[52:55], v[40:43], v[68:71]
L_AW_m15:
s_mul_i32 s7, s51, 6144
s_add_u32 m0, s7, 148480
s_mul_i32 s50, s51, 331776
s_add_u32 s50, s50, 73728
buffer_load_dwordx4 v32, s[24:27], s50 offen offset:0 lds
s_addk_i32 m0, 1024
s_nop 0
buffer_load_dwordx4 v33, s[24:27], s50 offen offset:0 lds
s_addk_i32 m0, 1024
s_nop 0
buffer_load_dwordx4 v34, s[24:27], s50 offen offset:0 lds
s_addk_i32 m0, 1024
s_nop 0
buffer_load_dwordx4 v35, s[24:27], s50 offen offset:0 lds
s_addk_i32 m0, 1024
s_nop 0
buffer_load_dwordx4 v36, s[24:27], s50 offen offset:0 lds
s_addk_i32 m0, 1024
s_nop 0
buffer_load_dwordx4 v37, s[24:27], s50 offen offset:0 lds
s_waitcnt vmcnt(15)
s_barrier
ds_read_b128 v[40:43], v8 offset:36864
ds_read_b64_tr_b16 v[44:45], v10 offset:15392
ds_read_b64_tr_b16 v[46:47], v10 offset:16672
ds_read_b64_tr_b16 v[48:49], v10 offset:15424
ds_read_b64_tr_b16 v[50:51], v10 offset:16704
s_cmp_eq_u32 s51, 0
s_cbranch_scc0 L_AW_r16
ds_read_b64_tr_b16 v[52:53], v12 offset:15392
ds_read_b64_tr_b16 v[54:55], v12 offset:16672
L_AW_r16:
s_waitcnt lgkmcnt(0)
v_mfma_f32_16x16x32_bf16 v[60:63], v[44:47], v[40:43], v[60:63]
v_mfma_f32_16x16x32_bf16 v[64:67], v[48:51], v[40:43], v[64:67]
s_cmp_eq_u32 s51, 0
s_cbranch_scc0 L_AW_m16
v_mfma_f32_16x16x32_bf16 v[68:71], v[52:55], v[40:43], v[68:71]
L_AW_m16:
s_lshr_b32 s7, 1582846540, s57
s_and_b32 s7, s7, 0xff
s_lshl_b32 m0, s7, 10
s_bfe_u32 s50, s56, 0x30000
s_mul_i32 s50, s50, 82944
s_mul_i32 s7, s51, 36864
s_add_u32 s50, s50, s7
buffer_load_dwordx4 v26, s[24:27], s50 offen offset:0 lds
s_addk_i32 m0, 1024
s_nop 0
buffer_load_dwordx4 v27, s[24:27], s50 offen offset:0 lds
s_addk_i32 m0, 1024
s_nop 0
buffer_load_dwordx4 v28, s[24:27], s50 offen offset:0 lds
s_addk_i32 m0, 1024
s_nop 0
buffer_load_dwordx4 v29, s[24:27], s50 offen offset:0 lds
s_addk_i32 m0, 1024
s_nop 0
buffer_load_dwordx4 v30, s[24:27], s50 offen offset:0 lds
s_addk_i32 m0, 1024
s_nop 0
buffer_load_dwordx4 v31, s[24:27], s50 offen offset:0 lds
s_waitcnt vmcnt(12)
s_barrier
ds_read_b128 v[40:43], v9 offset:36864
ds_read_b64_tr_b16 v[44:45], v10 offset:30784
ds_read_b64_tr_b16 v[46:47], v10 offset:32064
ds_read_b64_tr_b16 v[48:49], v10 offset:30816
ds_read_b64_tr_b16 v[50:51], v10 offset:32096
s_cmp_eq_u32 s51, 0
s_cbranch_scc0 L_AW_r17
ds_read_b64_tr_b16 v[52:53], v12 offset:30784
ds_read_b64_tr_b16 v[54:55], v12 offset:32064
L_AW_r17:
s_waitcnt lgkmcnt(0)
v_mfma_f32_16x16x32_bf16 v[60:63], v[44:47], v[40:43], v[60:63]
v_mfma_f32_16x16x32_bf16 v[64:67], v[48:51], v[40:43], v[64:67]
s_cmp_eq_u32 s51, 0
s_cbranch_scc0 L_AW_m17
v_mfma_f32_16x16x32_bf16 v[68:71], v[52:55], v[40:43], v[68:71]
L_AW_m17:
s_nop 4
v_cvt_pk_bf16_f32 v44, v60, v61
v_cvt_pk_bf16_f32 v45, v62, v63
v_cvt_pk_bf16_f32 v46, v64, v65
v_cvt_pk_bf16_f32 v47, v66, v67
v_cvt_pk_bf16_f32 v48, v68, v69
v_cvt_pk_bf16_f32 v49, v70, v71
v_mov_b32 v50, 0
v_mov_b32 v51, 0
s_nop 0
v_permlane32_swap_b32 v48, v50
v_permlane32_swap_b32 v49, v51
ds_write_b64 v6, v[44:45]
ds_write_b64 v6, v[46:47] offset:512
s_cmp_eq_u32 s51, 0
s_cbranch_scc0 L_A_att
ds_write_b64 v7, v[50:51]
s_branch L_A_att
L_AX1:
s_mul_i32 s7, s6, 24
s_add_u32 s7, s7, 16
s_load_dwordx2 s[40:41], s[0:1], s7
s_load_dwordx4 s[44:47], s[0:1], 48
s_load_dwordx2 s[48:49], s[0:1], 64
s_mov_b32 s32, 0xffff
s_mov_b32 s33, 0
s_mov_b32 s34, -1
s_mov_b32 s35, 0
s_mov_b32 s59, 0
v_lshrrev_b32 v8, 4, v0
v_bfe_u32 v1, v0, 1, 3
v_xor_b32 v8, v8, v1
v_and_b32 v1, 15, v0
v_lshlrev_b32 v1, 7, v1
v_lshl_add_u32 v8, v8, 4, v1
v_xor_b32 v9, 64, v8
v_lshrrev_b32 v1, 5, v0
v_lshlrev_b32 v1, 4, v1
v_bfe_u32 v2, v0, 4, 1
v_lshl_add_u32 v1, v2, 2, v1
v_bfe_u32 v2, v0, 2, 2
v_add_u32 v1, v1, v2
v_mul_u32_u24 v1, 160, v1
v_and_b32 v2, 3, v0
v_lshl_add_u32 v10, v2, 3, v1
v_add_u32 v12, 10400, v10
v_add_u32 v8, 93344, v8
v_add_u32 v9, 93344, v9
s_lshl_b32 s7, s51, 6
s_add_u32 s7, s7, 10272
v_add_u32 v10, s7, v10
v_add_u32 v13, 61568, v10
v_add_u32 v15, 61568, v12
s_waitcnt vmcnt(9)
s_barrier
ds_read_b128 v[40:43], v8 offset:0
ds_read_b64_tr_b16 v[44:45], v10 offset:0
ds_read_b64_tr_b16 v[46:47], v10 offset:1280
ds_read_b64_tr_b16 v[48:49], v10 offset:32
ds_read_b64_tr_b16 v[50:51], v10 offset:1312
s_cmp_eq_u32 s51, 0
s_cbranch_scc0 L_AX_r0
ds_read_b64_tr_b16 v[52:53], v12 offset:0
ds_read_b64_tr_b16 v[54:55], v12 offset:1280
L_AX_r0:
s_addk_i32 s91, 128
s_cmpk_eq_u32 s91, 1152
s_cselect_b32 s91, 0, s91
s_add_u32 m0, s42, 113824
s_nop 0
buffer_load_dwordx4 v16, s[8:11], s91 offen offset:0 lds
s_addk_i32 m0, 2048
s_nop 0
buffer_load_dwordx4 v17, s[8:11], s91 offen offset:0 lds
s_addk_i32 m0, 2048
s_nop 0
buffer_load_dwordx4 v18, s[8:11], s91 offen offset:0 lds
s_addk_i32 m0, 2048
s_nop 0
buffer_load_dwordx4 v19, s[8:11], s91 offen offset:0 lds
s_addk_i32 m0, 2048
s_nop 0
buffer_load_dwordx4 v20, s[8:11], s91 offen offset:0 lds
s_waitcnt lgkmcnt(0)
v_mfma_f32_16x16x32_bf16 v[60:63], v[40:43], v[44:47], 0
v_mfma_f32_16x16x32_bf16 v[64:67], v[40:43], v[48:51], 0
s_cmp_eq_u32 s51, 0
s_cbranch_scc0 L_AX_m0
v_mfma_f32_16x16x32_bf16 v[68:71], v[40:43], v[52:55], 0
L_AX_m0:
s_waitcnt vmcnt(9)
s_barrier
ds_read_b128 v[40:43], v9 offset:0
ds_read_b64_tr_b16 v[44:45], v10 offset:15392
ds_read_b64_tr_b16 v[46:47], v10 offset:16672
ds_read_b64_tr_b16 v[48:49], v10 offset:15424
ds_read_b64_tr_b16 v[50:51], v10 offset:16704
s_cmp_eq_u32 s51, 0
s_cbranch_scc0 L_AX_r1
ds_read_b64_tr_b16 v[52:53], v12 offset:15392
ds_read_b64_tr_b16 v[54:55], v12 offset:16672
L_AX_r1:
s_addk_i32 m0, 2048
s_nop 0
buffer_load_dwordx4 v21, s[8:11], s91 offen offset:0 lds
s_addk_i32 m0, 2048
s_nop 0
buffer_load_dwordx4 v22, s[8:11], s91 offen offset:0 lds
s_addk_i32 m0, 2048
s_nop 0
buffer_load_dwordx4 v23, s[8:11], s91 offen offset:0 lds
s_addk_i32 m0, 2048
s_nop 0
buffer_load_dwordx4 v24, s[8:11], s91 offen offset:0 lds
s_waitcnt lgkmcnt(0)
v_mfma_f32_16x16x32_bf16 v[60:63], v[40:43], v[44:47], v[60:63]
v_mfma_f32_16x16x32_bf16 v[64:67], v[40:43], v[48:51], v[64:67]
s_cmp_eq_u32 s51, 0
s_cbranch_scc0 L_AX_m1
v_mfma_f32_16x16x32_bf16 v[68:71], v[40:43], v[52:55], v[68:71]
L_AX_m1:
s_waitcnt vmcnt(9)
s_barrier
ds_read_b128 v[40:43], v8 offset:18432
ds_read_b64_tr_b16 v[44:45], v10 offset:30784
ds_read_b64_tr_b16 v[46:47], v10 offset:32064
ds_read_b64_tr_b16 v[48:49], v10 offset:30816
ds_read_b64_tr_b16 v[50:51], v10 offset:32096
s_cmp_eq_u32 s51, 0
s_cbranch_scc0 L_AX_r2
ds_read_b64_tr_b16 v[52:53], v12 offset:30784
ds_read_b64_tr_b16 v[54:55], v12 offset:32064
L_AX_r2:
s_addk_i32 s91, 128
s_cmpk_eq_u32 s91, 1152
s_cselect_b32 s91, 0, s91
s_add_u32 m0, s42, 76960
s_nop 0
buffer_load_dwordx4 v16, s[8:11], s91 offen offset:0 lds
s_addk_i32 m0, 2048
s_nop 0
buffer_load_dwordx4 v17, s[8:11], s91 offen offset:0 lds
s_addk_i32 m0, 2048
s_nop 0
buffer_load_dwordx4 v18, s[8:11], s91 offen offset:0 lds
s_addk_i32 m0, 2048
s_nop 0
buffer_load_dwordx4 v19, s[8:11], s91 offen offset:0 lds
s_addk_i32 m0, 2048
s_nop 0
buffer_load_dwordx4 v20, s[8:11], s91 offen offset:0 lds
s_waitcnt lgkmcnt(0)
v_mfma_f32_16x16x32_bf16 v[60:63], v[40:43], v[44:47], v[60:63]
v_mfma_f32_16x16x32_bf16 v[64:67], v[40:43], v[48:51], v[64:67]
s_cmp_eq_u32 s51, 0
s_cbranch_scc0 L_AX_m2
v_mfma_f32_16x16x32_bf16 v[68:71], v[40:43], v[52:55], v[68:71]
L_AX_m2:
s_cmp_eq_u32 s59, 1
s_mov_b32 s24, s40
s_mov_b32 s25, s41
s_mov_b32 s26, 663552
s_mov_b32 s27, 0x20000
s_mov_b32 s28, s44
s_mov_b32 s29, s45
s_mov_b32 s30, 4718592
s_mov_b32 s31, 0x20000
s_mov_b32 s20, s46
s_mov_b32 s21, s47
s_mov_b32 s22, 256
s_mov_b32 s23, 0x20000
s_mov_b32 s16, s48
s_mov_b32 s17, s49
s_mov_b32 s18, 7340032
s_mov_b32 s19, 0x20000
s_lshl_b32 s7, s6, 4
s_add_u32 s7, s7, s5
s_lshl_b32 s53, s7, 8
s_add_u32 s53, s53, 5505024
s_add_u32 s92, s16, s53
s_addc_u32 s93, s17, 0
s_cselect_b32 s59, 1, 0
s_waitcnt vmcnt(9)
s_barrier
ds_read_b128 v[40:43], v9 offset:18432
ds_read_b64_tr_b16 v[44:45], v10 offset:46176
ds_read_b64_tr_b16 v[46:47], v10 offset:47456
ds_read_b64_tr_b16 v[48:49], v10 offset:46208
ds_read_b64_tr_b16 v[50:51], v10 offset:47488
s_cmp_eq_u32 s51, 0
s_cbranch_scc0 L_AX_r3
ds_read_b64_tr_b16 v[52:53], v12 offset:46176
ds_read_b64_tr_b16 v[54:55], v12 offset:47456
L_AX_r3:
s_addk_i32 m0, 2048
s_nop 0
buffer_load_dwordx4 v21, s[8:11], s91 offen offset:0 lds
s_addk_i32 m0, 2048
s_nop 0
buffer_load_dwordx4 v22, s[8:11], s91 offen offset:0 lds
s_addk_i32 m0, 2048
s_nop 0
buffer_load_dwordx4 v23, s[8:11], s91 offen offset:0 lds
s_addk_i32 m0, 2048
s_nop 0
buffer_load_dwordx4 v24, s[8:11], s91 offen offset:0 lds
s_waitcnt lgkmcnt(0)
v_mfma_f32_16x16x32_bf16 v[60:63], v[40:43], v[44:47], v[60:63]
v_mfma_f32_16x16x32_bf16 v[64:67], v[40:43], v[48:51], v[64:67]
s_cmp_eq_u32 s51, 0
s_cbranch_scc0 L_AX_m3
v_mfma_f32_16x16x32_bf16 v[68:71], v[40:43], v[52:55], v[68:71]
L_AX_m3:
s_cmp_eq_u32 s59, 1
s_lshl_b32 s7, s7, 2
s_add_u32 s98, s7, 32
s_lshl_b32 s99, s4, 2
s_mul_i32 s53, s4, 8192
s_add_u32 s53, s53, 5249024
s_add_u32 s94, s16, s53
s_addc_u32 s95, s17, 0
s_and_b32 s7, s4, 3
s_lshl_b32 s53, s7, 3
s_lshr_b32 s52, 0x07050200, s53
s_and_b32 s52, s52, 0xff
s_lshr_b32 s53, s4, 2
s_mul_i32 s53, s53, 9
s_add_u32 s52, s52, s53
s_lshl_b32 s52, s52, 6
s_cmp_eq_u32 s7, 1
s_cselect_b32 s55, 64, 0
s_cmp_lt_u32 s7, 2
s_cselect_b32 s56, 12, 8
v_add_u32 v1, 0, v0
v_mul_u32_u24 v2, 5462, v1
v_lshrrev_b32 v2, 16, v2
s_cselect_b32 s59, 1, 0
s_waitcnt vmcnt(9)
s_barrier
ds_read_b128 v[40:43], v8 offset:36864
ds_read_b64_tr_b16 v[44:45], v13 offset:0
ds_read_b64_tr_b16 v[46:47], v13 offset:1280
ds_read_b64_tr_b16 v[48:49], v13 offset:32
ds_read_b64_tr_b16 v[50:51], v13 offset:1312
s_cmp_eq_u32 s51, 0
s_cbranch_scc0 L_AX_r4
ds_read_b64_tr_b16 v[52:53], v15 offset:0
ds_read_b64_tr_b16 v[54:55], v15 offset:1280
L_AX_r4:
s_addk_i32 s91, 128
s_cmpk_eq_u32 s91, 1152
s_cselect_b32 s91, 0, s91
s_addk_i32 m0, 2048
s_nop 0
buffer_load_dwordx4 v16, s[8:11], s91 offen offset:0 lds
s_addk_i32 m0, 2048
s_nop 0
buffer_load_dwordx4 v17, s[8:11], s91 offen offset:0 lds
s_addk_i32 m0, 2048
s_nop 0
buffer_load_dwordx4 v18, s[8:11], s91 offen offset:0 lds
s_addk_i32 m0, 2048
s_nop 0
buffer_load_dwordx4 v19, s[8:11], s91 offen offset:0 lds
s_addk_i32 m0, 2048
s_nop 0
buffer_load_dwordx4 v20, s[8:11], s91 offen offset:0 lds
s_waitcnt lgkmcnt(0)
v_mfma_f32_16x16x32_bf16 v[60:63], v[40:43], v[44:47], v[60:63]
v_mfma_f32_16x16x32_bf16 v[64:67], v[40:43], v[48:51], v[64:67]
s_cmp_eq_u32 s51, 0
s_cbranch_scc0 L_AX_m4
v_mfma_f32_16x16x32_bf16 v[68:71], v[40:43], v[52:55], v[68:71]
L_AX_m4:
s_cmp_eq_u32 s59, 1
v_mad_i32_i24 v1, v2, -12, v1
v_bfe_u32 v3, v2, 2, 1
v_lshlrev_b32 v4, 1, v3
v_xor_b32 v1, v1, v4
v_cmp_gt_u32 vcc, s56, v1
v_lshl_add_u32 v1, v1, 4, s52
v_mov_b32 v4, 8388608
v_cndmask_b32 v1, v4, v1, vcc
v_and_b32 v4, 3, v2
v_lshl_add_u32 v5, v3, 2, v4
v_mul_u32_u24 v3, 72, v3
v_add_u32 v4, v3, v4
v_bfe_u32 v3, v2, 3, 1
v_lshl_add_u32 v5, v3, 4, v5
v_lshl_add_u32 v4, v3, 2, v4
v_bfe_u32 v3, v2, 4, 1
v_lshl_add_u32 v5, v3, 3, v5
v_mul_u32_u24 v3, 144, v3
v_add_u32 v4, v3, v4
v_mul_u32_u24 v5, 1152, v5
v_add_u32 v26, v5, v1
v_mul_u32_u24 v4, 1152, v4
s_cselect_b32 s59, 1, 0
s_waitcnt vmcnt(9)
s_barrier
ds_read_b128 v[40:43], v9 offset:36864
ds_read_b64_tr_b16 v[44:45], v10 offset:0
ds_read_b64_tr_b16 v[46:47], v10 offset:1280
ds_read_b64_tr_b16 v[48:49], v10 offset:32
ds_read_b64_tr_b16 v[50:51], v10 offset:1312
s_cmp_eq_u32 s51, 0
s_cbranch_scc0 L_AX_r5
ds_read_b64_tr_b16 v[52:53], v12 offset:0
ds_read_b64_tr_b16 v[54:55], v12 offset:1280
L_AX_r5:
s_addk_i32 m0, 2048
s_nop 0
buffer_load_dwordx4 v21, s[8:11], s91 offen offset:0 lds
s_addk_i32 m0, 2048
s_nop 0
buffer_load_dwordx4 v22, s[8:11], s91 offen offset:0 lds
s_addk_i32 m0, 2048
s_nop 0
buffer_load_dwordx4 v23, s[8:11], s91 offen offset:0 lds
s_addk_i32 m0, 2048
s_nop 0
buffer_load_dwordx4 v24, s[8:11], s91 offen offset:0 lds
s_waitcnt lgkmcnt(0)
v_mfma_f32_16x16x32_bf16 v[60:63], v[40:43], v[44:47], v[60:63]
v_mfma_f32_16x16x32_bf16 v[64:67], v[40:43], v[48:51], v[64:67]
s_cmp_eq_u32 s51, 0
s_cbranch_scc0 L_AX_m5
v_mfma_f32_16x16x32_bf16 v[68:71], v[40:43], v[52:55], v[68:71]
L_AX_m5:
s_cmp_eq_u32 s59, 1
v_add_u32 v32, v4, v1
v_add_u32 v1, 64, v0
v_mul_u32_u24 v2, 5462, v1
v_lshrrev_b32 v2, 16, v2
v_mad_i32_i24 v1, v2, -12, v1
v_bfe_u32 v3, v2, 2, 1
v_lshlrev_b32 v4, 1, v3
v_xor_b32 v1, v1, v4
v_cmp_gt_u32 vcc, s56, v1
v_lshl_add_u32 v1, v1, 4, s52
v_mov_b32 v4, 8388608
v_cndmask_b32 v1, v4, v1, vcc
v_and_b32 v4, 3, v2
v_lshl_add_u32 v5, v3, 2, v4
v_mul_u32_u24 v3, 72, v3
v_add_u32 v4, v3, v4
v_bfe_u32 v3, v2, 3, 1
v_lshl_add_u32 v5, v3, 4, v5
v_lshl_add_u32 v4, v3, 2, v4
v_bfe_u32 v3, v2, 4, 1
v_lshl_add_u32 v5, v3, 3, v5
v_mul_u32_u24 v3, 144, v3
s_cselect_b32 s59, 1, 0
s_waitcnt vmcnt(9)
s_barrier
ds_read_b128 v[40:43], v8 offset:0
ds_read_b64_tr_b16 v[44:45], v10 offset:15392
ds_read_b64_tr_b16 v[46:47], v10 offset:16672
ds_read_b64_tr_b16 v[48:49], v10 offset:15424
ds_read_b64_tr_b16 v[50:51], v10 offset:16704
s_cmp_eq_u32 s51, 0
s_cbranch_scc0 L_AX_r6
ds_read_b64_tr_b16 v[52:53], v12 offset:15392
ds_read_b64_tr_b16 v[54:55], v12 offset:16672
L_AX_r6:
s_addk_i32 s91, 128
s_cmpk_eq_u32 s91, 1152
s_cselect_b32 s91, 0, s91
s_addk_i32 m0, 2048
s_nop 0
buffer_load_dwordx4 v16, s[8:11], s91 offen offset:0 lds
s_addk_i32 m0, 2048
s_nop 0
buffer_load_dwordx4 v17, s[8:11], s91 offen offset:0 lds
s_addk_i32 m0, 2048
s_nop 0
buffer_load_dwordx4 v18, s[8:11], s91 offen offset:0 lds
s_addk_i32 m0, 2048
s_nop 0
buffer_load_dwordx4 v19, s[8:11], s91 offen offset:0 lds
s_addk_i32 m0, 2048
s_nop 0
buffer_load_dwordx4 v20, s[8:11], s91 offen offset:0 lds
s_waitcnt lgkmcnt(0)
v_mfma_f32_16x16x32_bf16 v[60:63], v[40:43], v[44:47], v[60:63]
v_mfma_f32_16x16x32_bf16 v[64:67], v[40:43], v[48:51], v[64:67]
s_cmp_eq_u32 s51, 0
s_cbranch_scc0 L_AX_m6
v_mfma_f32_16x16x32_bf16 v[68:71], v[40:43], v[52:55], v[68:71]
L_AX_m6:
s_cmp_eq_u32 s59, 1
v_add_u32 v4, v3, v4
v_mul_u32_u24 v5, 1152, v5
v_add_u32 v27, v5, v1
v_mul_u32_u24 v4, 1152, v4
v_add_u32 v33, v4, v1
v_add_u32 v1, 128, v0
v_mul_u32_u24 v2, 5462, v1
v_lshrrev_b32 v2, 16, v2
v_mad_i32_i24 v1, v2, -12, v1
v_bfe_u32 v3, v2, 2, 1
v_lshlrev_b32 v4, 1, v3
v_xor_b32 v1, v1, v4
v_cmp_gt_u32 vcc, s56, v1
v_lshl_add_u32 v1, v1, 4, s52
v_mov_b32 v4, 8388608
v_cndmask_b32 v1, v4, v1, vcc
v_and_b32 v4, 3, v2
v_lshl_add_u32 v5, v3, 2, v4
v_mul_u32_u24 v3, 72, v3
v_add_u32 v4, v3, v4
v_bfe_u32 v3, v2, 3, 1
v_lshl_add_u32 v5, v3, 4, v5
s_cselect_b32 s59, 1, 0
s_waitcnt vmcnt(9)
s_barrier
ds_read_b128 v[40:43], v9 offset:0
ds_read_b64_tr_b16 v[44:45], v10 offset:30784
ds_read_b64_tr_b16 v[46:47], v10 offset:32064
ds_read_b64_tr_b16 v[48:49], v10 offset:30816
ds_read_b64_tr_b16 v[50:51], v10 offset:32096
s_cmp_eq_u32 s51, 0
s_cbranch_scc0 L_AX_r7
ds_read_b64_tr_b16 v[52:53], v12 offset:30784
ds_read_b64_tr_b16 v[54:55], v12 offset:32064
L_AX_r7:
s_addk_i32 m0, 2048
s_nop 0
buffer_load_dwordx4 v21, s[8:11], s91 offen offset:0 lds
s_addk_i32 m0, 2048
s_nop 0
buffer_load_dwordx4 v22, s[8:11], s91 offen offset:0 lds
s_addk_i32 m0, 2048
s_nop 0
buffer_load_dwordx4 v23, s[8:11], s91 offen offset:0 lds
s_addk_i32 m0, 2048
s_nop 0
buffer_load_dwordx4 v24, s[8:11], s91 offen offset:0 lds
s_waitcnt lgkmcnt(0)
v_mfma_f32_16x16x32_bf16 v[60:63], v[40:43], v[44:47], v[60:63]
v_mfma_f32_16x16x32_bf16 v[64:67], v[40:43], v[48:51], v[64:67]
s_cmp_eq_u32 s51, 0
s_cbranch_scc0 L_AX_m7
v_mfma_f32_16x16x32_bf16 v[68:71], v[40:43], v[52:55], v[68:71]
L_AX_m7:
s_cmp_eq_u32 s59, 1
v_lshl_add_u32 v4, v3, 2, v4
v_bfe_u32 v3, v2, 4, 1
v_lshl_add_u32 v5, v3, 3, v5
v_mul_u32_u24 v3, 144, v3
v_add_u32 v4, v3, v4
v_mul_u32_u24 v5, 1152, v5
v_add_u32 v28, v5, v1
v_mul_u32_u24 v4, 1152, v4
v_add_u32 v34, v4, v1
v_add_u32 v1, 192, v0
v_mul_u32_u24 v2, 5462, v1
v_lshrrev_b32 v2, 16, v2
v_mad_i32_i24 v1, v2, -12, v1
v_bfe_u32 v3, v2, 2, 1
v_lshlrev_b32 v4, 1, v3
v_xor_b32 v1, v1, v4
v_cmp_gt_u32 vcc, s56, v1
v_lshl_add_u32 v1, v1, 4, s52
v_mov_b32 v4, 8388608
v_cndmask_b32 v1, v4, v1, vcc
v_and_b32 v4, 3, v2
v_lshl_add_u32 v5, v3, 2, v4
s_cselect_b32 s59, 1, 0
s_waitcnt vmcnt(9)
s_barrier
ds_read_b128 v[40:43], v8 offset:18432
ds_read_b64_tr_b16 v[44:45], v10 offset:46176
ds_read_b64_tr_b16 v[46:47], v10 offset:47456
ds_read_b64_tr_b16 v[48:49], v10 offset:46208
ds_read_b64_tr_b16 v[50:51], v10 offset:47488
s_cmp_eq_u32 s51, 0
s_cbranch_scc0 L_AX_r8
ds_read_b64_tr_b16 v[52:53], v12 offset:46176
ds_read_b64_tr_b16 v[54:55], v12 offset:47456
L_AX_r8:
s_addk_i32 s91, 128
s_cmpk_eq_u32 s91, 1152
s_cselect_b32 s91, 0, s91
s_add_u32 m0, s42, 76960
s_nop 0
buffer_load_dwordx4 v16, s[8:11], s91 offen offset:0 lds
s_addk_i32 m0, 2048
s_nop 0
buffer_load_dwordx4 v17, s[8:11], s91 offen offset:0 lds
s_addk_i32 m0, 2048
s_nop 0
buffer_load_dwordx4 v18, s[8:11], s91 offen offset:0 lds
s_addk_i32 m0, 2048
s_nop 0
buffer_load_dwordx4 v19, s[8:11], s91 offen offset:0 lds
s_addk_i32 m0, 2048
s_nop 0
buffer_load_dwordx4 v20, s[8:11], s91 offen offset:0 lds
s_waitcnt lgkmcnt(0)
v_mfma_f32_16x16x32_bf16 v[60:63], v[40:43], v[44:47], v[60:63]
v_mfma_f32_16x16x32_bf16 v[64:67], v[40:43], v[48:51], v[64:67]
s_cmp_eq_u32 s51, 0
s_cbranch_scc0 L_AX_m8
v_mfma_f32_16x16x32_bf16 v[68:71], v[40:43], v[52:55], v[68:71]
L_AX_m8:
s_cmp_eq_u32 s59, 1
v_mul_u32_u24 v3, 72, v3
v_add_u32 v4, v3, v4
v_bfe_u32 v3, v2, 3, 1
v_lshl_add_u32 v5, v3, 4, v5
v_lshl_add_u32 v4, v3, 2, v4
v_bfe_u32 v3, v2, 4, 1
v_lshl_add_u32 v5, v3, 3, v5
v_mul_u32_u24 v3, 144, v3
v_add_u32 v4, v3, v4
v_mul_u32_u24 v5, 1152, v5
v_add_u32 v29, v5, v1
v_mul_u32_u24 v4, 1152, v4
v_add_u32 v35, v4, v1
v_add_u32 v1, 256, v0
v_mul_u32_u24 v2, 5462, v1
v_lshrrev_b32 v2, 16, v2
v_mad_i32_i24 v1, v2, -12, v1
v_bfe_u32 v3, v2, 2, 1
v_lshlrev_b32 v4, 1, v3
v_xor_b32 v1, v1, v4
v_cmp_gt_u32 vcc, s56, v1
v_lshl_add_u32 v1, v1, 4, s52
s_cselect_b32 s59, 1, 0
s_waitcnt vmcnt(9)
s_barrier
ds_read_b128 v[40:43], v9 offset:18432
ds_read_b64_tr_b16 v[44:45], v13 offset:0
ds_read_b64_tr_b16 v[46:47], v13 offset:1280
ds_read_b64_tr_b16 v[48:49], v13 offset:32
ds_read_b64_tr_b16 v[50:51], v13 offset:1312
s_cmp_eq_u32 s51, 0
s_cbranch_scc0 L_AX_r9
ds_read_b64_tr_b16 v[52:53], v15 offset:0
ds_read_b64_tr_b16 v[54:55], v15 offset:1280
L_AX_r9:
s_addk_i32 m0, 2048
s_nop 0
buffer_load_dwordx4 v21, s[8:11], s91 offen offset:0 lds
s_addk_i32 m0, 2048
s_nop 0
buffer_load_dwordx4 v22, s[8:11], s91 offen offset:0 lds
s_addk_i32 m0, 2048
s_nop 0
buffer_load_dwordx4 v23, s[8:11], s91 offen offset:0 lds
s_addk_i32 m0, 2048
s_nop 0
buffer_load_dwordx4 v24, s[8:11], s91 offen offset:0 lds
s_waitcnt lgkmcnt(0)
v_mfma_f32_16x16x32_bf16 v[60:63], v[40:43], v[44:47], v[60:63]
v_mfma_f32_16x16x32_bf16 v[64:67], v[40:43], v[48:51], v[64:67]
s_cmp_eq_u32 s51, 0
s_cbranch_scc0 L_AX_m9
v_mfma_f32_16x16x32_bf16 v[68:71], v[40:43], v[52:55], v[68:71]
L_AX_m9:
s_cmp_eq_u32 s59, 1
v_mov_b32 v4, 8388608
v_cndmask_b32 v1, v4, v1, vcc
v_and_b32 v4, 3, v2
v_lshl_add_u32 v5, v3, 2, v4
v_mul_u32_u24 v3, 72, v3
v_add_u32 v4, v3, v4
v_bfe_u32 v3, v2, 3, 1
v_lshl_add_u32 v5, v3, 4, v5
v_lshl_add_u32 v4, v3, 2, v4
v_bfe_u32 v3, v2, 4, 1
v_lshl_add_u32 v5, v3, 3, v5
v_mul_u32_u24 v3, 144, v3
v_add_u32 v4, v3, v4
v_mul_u32_u24 v5, 1152, v5
v_add_u32 v30, v5, v1
v_mul_u32_u24 v4, 1152, v4
v_add_u32 v36, v4, v1
v_add_u32 v1, 320, v0
v_mul_u32_u24 v2, 5462, v1
v_lshrrev_b32 v2, 16, v2
v_mad_i32_i24 v1, v2, -12, v1
v_bfe_u32 v3, v2, 2, 1
s_cselect_b32 s59, 1, 0
s_waitcnt vmcnt(9)
s_barrier
ds_read_b128 v[40:43], v8 offset:36864
ds_read_b64_tr_b16 v[44:45], v10 offset:0
ds_read_b64_tr_b16 v[46:47], v10 offset:1280
ds_read_b64_tr_b16 v[48:49], v10 offset:32
ds_read_b64_tr_b16 v[50:51], v10 offset:1312
s_cmp_eq_u32 s51, 0
s_cbranch_scc0 L_AX_r10
ds_read_b64_tr_b16 v[52:53], v12 offset:0
ds_read_b64_tr_b16 v[54:55], v12 offset:1280
L_AX_r10:
s_addk_i32 s91, 128
s_cmpk_eq_u32 s91, 1152
s_cselect_b32 s91, 0, s91
s_addk_i32 m0, 2048
s_nop 0
buffer_load_dwordx4 v16, s[8:11], s91 offen offset:0 lds
s_addk_i32 m0, 2048
s_nop 0
buffer_load_dwordx4 v17, s[8:11], s91 offen offset:0 lds
s_addk_i32 m0, 2048
s_nop 0
buffer_load_dwordx4 v18, s[8:11], s91 offen offset:0 lds
s_addk_i32 m0, 2048
s_nop 0
buffer_load_dwordx4 v19, s[8:11], s91 offen offset:0 lds
s_addk_i32 m0, 2048
s_nop 0
buffer_load_dwordx4 v20, s[8:11], s91 offen offset:0 lds
s_waitcnt lgkmcnt(0)
v_mfma_f32_16x16x32_bf16 v[60:63], v[40:43], v[44:47], v[60:63]
v_mfma_f32_16x16x32_bf16 v[64:67], v[40:43], v[48:51], v[64:67]
s_cmp_eq_u32 s51, 0
s_cbranch_scc0 L_AX_m10
v_mfma_f32_16x16x32_bf16 v[68:71], v[40:43], v[52:55], v[68:71]
L_AX_m10:
s_cmp_eq_u32 s59, 1
v_lshlrev_b32 v4, 1, v3
v_xor_b32 v1, v1, v4
v_cmp_gt_u32 vcc, s56, v1
v_lshl_add_u32 v1, v1, 4, s52
v_mov_b32 v4, 8388608
v_cndmask_b32 v1, v4, v1, vcc
v_and_b32 v4, 3, v2
v_lshl_add_u32 v5, v3, 2, v4
v_mul_u32_u24 v3, 72, v3
v_add_u32 v4, v3, v4
v_bfe_u32 v3, v2, 3, 1
v_lshl_add_u32 v5, v3, 4, v5
v_lshl_add_u32 v4, v3, 2, v4
v_bfe_u32 v3, v2, 4, 1
v_lshl_add_u32 v5, v3, 3, v5
v_mul_u32_u24 v3, 144, v3
v_add_u32 v4, v3, v4
v_mul_u32_u24 v5, 1152, v5
v_add_u32 v31, v5, v1
v_mul_u32_u24 v4, 1152, v4
v_add_u32 v37, v4, v1
s_and_b32 s55, s3, 3
s_cselect_b32 s59, 1, 0
s_waitcnt vmcnt(9)
s_barrier
ds_read_b128 v[40:43], v9 offset:36864
ds_read_b64_tr_b16 v[44:45], v10 offset:15392
ds_read_b64_tr_b16 v[46:47], v10 offset:16672
ds_read_b64_tr_b16 v[48:49], v10 offset:15424
ds_read_b64_tr_b16 v[50:51], v10 offset:16704
s_cmp_eq_u32 s51, 0
s_cbranch_scc0 L_AX_r11
ds_read_b64_tr_b16 v[52:53], v12 offset:15392
ds_read_b64_tr_b16 v[54:55], v12 offset:16672
L_AX_r11:
s_addk_i32 m0, 2048
s_nop 0
buffer_load_dwordx4 v21, s[8:11], s91 offen offset:0 lds
s_addk_i32 m0, 2048
s_nop 0
buffer_load_dwordx4 v22, s[8:11], s91 offen offset:0 lds
s_addk_i32 m0, 2048
s_nop 0
buffer_load_dwordx4 v23, s[8:11], s91 offen offset:0 lds
s_addk_i32 m0, 2048
s_nop 0
buffer_load_dwordx4 v24, s[8:11], s91 offen offset:0 lds
s_waitcnt lgkmcnt(0)
v_mfma_f32_16x16x32_bf16 v[60:63], v[40:43], v[44:47], v[60:63]
v_mfma_f32_16x16x32_bf16 v[64:67], v[40:43], v[48:51], v[64:67]
s_cmp_eq_u32 s51, 0
s_cbranch_scc0 L_AX_m11
v_mfma_f32_16x16x32_bf16 v[68:71], v[40:43], v[52:55], v[68:71]
L_AX_m11:
s_cmp_eq_u32 s59, 1
s_lshl_b32 s57, s55, 3
s_and_b32 s7, s5, 3
s_lshl_b32 s7, s7, 3
s_lshr_b32 s7, 0x14100800, s7
s_and_b32 s7, s7, 0xff
s_lshr_b32 s56, 0x7654321, s7
s_sub_u32 s7, 28, s7
s_lshl_b32 s7, 0x7654321, s7
s_or_b32 s56, s56, s7
s_lshl_b32 s56, s56, 4
s_mul_i32 s7, s4, 0x11111111
s_add_u32 s56, s56, s7
s_and_b32 s56, s56, 0x77777777
s_lshr_b32 s7, s55, 1
s_lshl_b32 s7, s7, 2
s_lshr_b32 s56, s56, s7
s_lshl_b32 s7, s51, 10
s_add_u32 s7, s7, 134816
v_lshlrev_b32 v1, 3, v0
v_add_u32 v6, s7, v1
v_add_u32 v7, 136864, v1
s_cselect_b32 s59, 1, 0
s_waitcnt vmcnt(9)
s_barrier
ds_read_b128 v[40:43], v8 offset:0
ds_read_b64_tr_b16 v[44:45], v10 offset:30784
ds_read_b64_tr_b16 v[46:47], v10 offset:32064
ds_read_b64_tr_b16 v[48:49], v10 offset:30816
ds_read_b64_tr_b16 v[50:51], v10 offset:32096
s_cmp_eq_u32 s51, 0
s_cbranch_scc0 L_AX_r12
ds_read_b64_tr_b16 v[52:53], v12 offset:30784
ds_read_b64_tr_b16 v[54:55], v12 offset:32064
L_AX_r12:
s_addk_i32 s91, 128
s_cmpk_eq_u32 s91, 1152
s_cselect_b32 s91, 0, s91
s_addk_i32 m0, 2048
s_nop 0
buffer_load_dwordx4 v16, s[8:11], s91 offen offset:0 lds
s_addk_i32 m0, 2048
s_nop 0
buffer_load_dwordx4 v17, s[8:11], s91 offen offset:0 lds
s_addk_i32 m0, 2048
s_nop 0
buffer_load_dwordx4 v18, s[8:11], s91 offen offset:0 lds
s_addk_i32 m0, 2048
s_nop 0
buffer_load_dwordx4 v19, s[8:11], s91 offen offset:0 lds
s_addk_i32 m0, 2048
s_nop 0
buffer_load_dwordx4 v20, s[8:11], s91 offen offset:0 lds
s_waitcnt lgkmcnt(0)
v_mfma_f32_16x16x32_bf16 v[60:63], v[40:43], v[44:47], v[60:63]
v_mfma_f32_16x16x32_bf16 v[64:67], v[40:43], v[48:51], v[64:67]
s_cmp_eq_u32 s51, 0
s_cbranch_scc0 L_AX_m12
v_mfma_f32_16x16x32_bf16 v[68:71], v[40:43], v[52:55], v[68:71]
L_AX_m12:
s_waitcnt vmcnt(9)
s_barrier
ds_read_b128 v[40:43], v9 offset:0
ds_read_b64_tr_b16 v[44:45], v10 offset:46176
ds_read_b64_tr_b16 v[46:47], v10 offset:47456
ds_read_b64_tr_b16 v[48:49], v10 offset:46208
ds_read_b64_tr_b16 v[50:51], v10 offset:47488
s_cmp_eq_u32 s51, 0
s_cbranch_scc0 L_AX_r13
ds_read_b64_tr_b16 v[52:53], v12 offset:46176
ds_read_b64_tr_b16 v[54:55], v12 offset:47456
L_AX_r13:
s_addk_i32 m0, 2048
s_nop 0
buffer_load_dwordx4 v21, s[8:11], s91 offen offset:0 lds
s_addk_i32 m0, 2048
s_nop 0
buffer_load_dwordx4 v22, s[8:11], s91 offen offset:0 lds
s_addk_i32 m0, 2048
s_nop 0
buffer_load_dwordx4 v23, s[8:11], s91 offen offset:0 lds
s_addk_i32 m0, 2048
s_nop 0
buffer_load_dwordx4 v24, s[8:11], s91 offen offset:0 lds
s_waitcnt lgkmcnt(0)
v_mfma_f32_16x16x32_bf16 v[60:63], v[40:43], v[44:47], v[60:63]
v_mfma_f32_16x16x32_bf16 v[64:67], v[40:43], v[48:51], v[64:67]
s_cmp_eq_u32 s51, 0
s_cbranch_scc0 L_AX_m13
v_mfma_f32_16x16x32_bf16 v[68:71], v[40:43], v[52:55], v[68:71]
L_AX_m13:
s_waitcnt vmcnt(9)
s_barrier
ds_read_b128 v[40:43], v8 offset:18432
ds_read_b64_tr_b16 v[44:45], v13 offset:0
ds_read_b64_tr_b16 v[46:47], v13 offset:1280
ds_read_b64_tr_b16 v[48:49], v13 offset:32
ds_read_b64_tr_b16 v[50:51], v13 offset:1312
s_cmp_eq_u32 s51, 0
s_cbranch_scc0 L_AX_r14
ds_read_b64_tr_b16 v[52:53], v15 offset:0
ds_read_b64_tr_b16 v[54:55], v15 offset:1280
L_AX_r14:
s_waitcnt lgkmcnt(0)
v_mfma_f32_16x16x32_bf16 v[60:63], v[40:43], v[44:47], v[60:63]
v_mfma_f32_16x16x32_bf16 v[64:67], v[40:43], v[48:51], v[64:67]
s_cmp_eq_u32 s51, 0
s_cbranch_scc0 L_AX_m14
v_mfma_f32_16x16x32_bf16 v[68:71], v[40:43], v[52:55], v[68:71]
L_AX_m14:
s_waitcnt vmcnt(4)
s_barrier
ds_read_b128 v[40:43], v9 offset:18432
ds_read_b64_tr_b16 v[44:45], v10 offset:0
ds_read_b64_tr_b16 v[46:47], v10 offset:1280
ds_read_b64_tr_b16 v[48:49], v10 offset:32
ds_read_b64_tr_b16 v[50:51], v10 offset:1312
s_cmp_eq_u32 s51, 0
s_cbranch_scc0 L_AX_r15
ds_read_b64_tr_b16 v[52:53], v12 offset:0
ds_read_b64_tr_b16 v[54:55], v12 offset:1280
L_AX_r15:
s_waitcnt lgkmcnt(0)
v_mfma_f32_16x16x32_bf16 v[60:63], v[40:43], v[44:47], v[60:63]
v_mfma_f32_16x16x32_bf16 v[64:67], v[40:43], v[48:51], v[64:67]
s_cmp_eq_u32 s51, 0
s_cbranch_scc0 L_AX_m15
v_mfma_f32_16x16x32_bf16 v[68:71], v[40:43], v[52:55], v[68:71]
L_AX_m15:
s_waitcnt vmcnt(0)
s_barrier
ds_read_b128 v[40:43], v8 offset:36864
ds_read_b64_tr_b16 v[44:45], v10 offset:15392
ds_read_b64_tr_b16 v[46:47], v10 offset:16672
ds_read_b64_tr_b16 v[48:49], v10 offset:15424
ds_read_b64_tr_b16 v[50:51], v10 offset:16704
s_cmp_eq_u32 s51, 0
s_cbranch_scc0 L_AX_r16
ds_read_b64_tr_b16 v[52:53], v12 offset:15392
ds_read_b64_tr_b16 v[54:55], v12 offset:16672
L_AX_r16:
s_waitcnt lgkmcnt(0)
v_mfma_f32_16x16x32_bf16 v[60:63], v[40:43], v[44:47], v[60:63]
v_mfma_f32_16x16x32_bf16 v[64:67], v[40:43], v[48:51], v[64:67]
s_cmp_eq_u32 s51, 0
s_cbranch_scc0 L_AX_m16
v_mfma_f32_16x16x32_bf16 v[68:71], v[40:43], v[52:55], v[68:71]
L_AX_m16:
s_lshr_b32 s7, 1582846540, s57
s_and_b32 s7, s7, 0xff
s_lshl_b32 m0, s7, 10
s_bfe_u32 s50, s56, 0x30000
s_mul_i32 s50, s50, 82944
s_mul_i32 s7, s51, 36864
s_add_u32 s50, s50, s7
buffer_load_dwordx4 v26, s[24:27], s50 offen offset:0 lds
s_addk_i32 m0, 1024
s_nop 0
buffer_load_dwordx4 v27, s[24:27], s50 offen offset:0 lds
s_addk_i32 m0, 1024
s_nop 0
buffer_load_dwordx4 v28, s[24:27], s50 offen offset:0 lds
s_addk_i32 m0, 1024
s_nop 0
buffer_load_dwordx4 v29, s[24:27], s50 offen offset:0 lds
s_addk_i32 m0, 1024
s_nop 0
buffer_load_dwordx4 v30, s[24:27], s50 offen offset:0 lds
s_addk_i32 m0, 1024
s_nop 0
buffer_load_dwordx4 v31, s[24:27], s50 offen offset:0 lds
s_waitcnt vmcnt(6)
s_barrier
ds_read_b128 v[40:43], v9 offset:36864
ds_read_b64_tr_b16 v[44:45], v10 offset:30784
ds_read_b64_tr_b16 v[46:47], v10 offset:32064
ds_read_b64_tr_b16 v[48:49], v10 offset:30816
ds_read_b64_tr_b16 v[50:51], v10 offset:32096
s_cmp_eq_u32 s51, 0
s_cbranch_scc0 L_AX_r17
ds_read_b64_tr_b16 v[52:53], v12 offset:30784
ds_read_b64_tr_b16 v[54:55], v12 offset:32064
L_AX_r17:
s_waitcnt lgkmcnt(0)
v_mfma_f32_16x16x32_bf16 v[60:63], v[40:43], v[44:47], v[60:63]
v_mfma_f32_16x16x32_bf16 v[64:67], v[40:43], v[48:51], v[64:67]
s_cmp_eq_u32 s51, 0
s_cbranch_scc0 L_AX_m17
v_mfma_f32_16x16x32_bf16 v[68:71], v[40:43], v[52:55], v[68:71]
L_AX_m17:
s_nop 4
v_cvt_pk_bf16_f32 v44, v60, v61
v_cvt_pk_bf16_f32 v45, v62, v63
v_cvt_pk_bf16_f32 v46, v64, v65
v_cvt_pk_bf16_f32 v47, v66, v67
v_cvt_pk_bf16_f32 v48, v68, v69
v_cvt_pk_bf16_f32 v49, v70, v71
ds_write_b64 v6, v[44:45]
ds_write_b64 v6, v[46:47] offset:512
s_cmp_eq_u32 s51, 0
s_cbranch_scc0 L_A_att
ds_write_b64 v7, v[48:49]
L_A_att:
s_waitcnt lgkmcnt(0)
s_barrier
s_load_dword s96, s[20:21], s98
s_lshr_b32 s7, 1987078756, s57
s_and_b32 s7, s7, 0xff
s_lshl_b32 m0, s7, 10
s_bfe_u32 s50, s56, 0x30008
s_mul_i32 s50, s50, 82944
s_mul_i32 s7, s51, 36864
s_add_u32 s50, s50, s7
buffer_load_dwordx4 v26, s[24:27], s50 offen offset:0 lds
s_addk_i32 m0, 1024
s_nop 0
buffer_load_dwordx4 v27, s[24:27], s50 offen offset:0 lds
s_addk_i32 m0, 1024
s_nop 0
buffer_load_dwordx4 v28, s[24:27], s50 offen offset:0 lds
s_addk_i32 m0, 1024
s_nop 0
buffer_load_dwordx4 v29, s[24:27], s50 offen offset:0 lds
s_addk_i32 m0, 1024
s_nop 0
buffer_load_dwordx4 v30, s[24:27], s50 offen offset:0 lds
s_addk_i32 m0, 1024
s_nop 0
buffer_load_dwordx4 v31, s[24:27], s50 offen offset:0 lds
s_lshr_b32 s7, 353306112, s57
s_and_b32 s7, s7, 0xff
s_lshl_b32 m0, s7, 10
s_bfe_u32 s50, s56, 0x30010
s_mul_i32 s50, s50, 82944
s_mul_i32 s7, s51, 36864
s_add_u32 s50, s50, s7
buffer_load_dwordx4 v26, s[24:27], s50 offen offset:0 lds
s_addk_i32 m0, 1024
s_nop 0
buffer_load_dwordx4 v27, s[24:27], s50 offen offset:0 lds
s_addk_i32 m0, 1024
s_nop 0
buffer_load_dwordx4 v28, s[24:27], s50 offen offset:0 lds
s_addk_i32 m0, 1024
s_nop 0
buffer_load_dwordx4 v29, s[24:27], s50 offen offset:0 lds
s_addk_i32 m0, 1024
s_nop 0
buffer_load_dwordx4 v30, s[24:27], s50 offen offset:0 lds
s_addk_i32 m0, 1024
s_nop 0
buffer_load_dwordx4 v31, s[24:27], s50 offen offset:0 lds
s_lshr_b32 s7, 757539099, s57
s_and_b32 s7, s7, 0xff
s_lshl_b32 m0, s7, 10
s_bfe_u32 s50, s56, 0x30018
s_mul_i32 s50, s50, 82944
s_mul_i32 s7, s51, 36864
s_add_u32 s50, s50, s7
buffer_load_dwordx4 v26, s[24:27], s50 offen offset:0 lds
s_addk_i32 m0, 1024
s_nop 0
buffer_load_dwordx4 v27, s[24:27], s50 offen offset:0 lds
s_addk_i32 m0, 1024
s_nop 0
buffer_load_dwordx4 v28, s[24:27], s50 offen offset:0 lds
s_addk_i32 m0, 1024
s_nop 0
buffer_load_dwordx4 v29, s[24:27], s50 offen offset:0 lds
s_addk_i32 m0, 1024
s_nop 0
buffer_load_dwordx4 v30, s[24:27], s50 offen offset:0 lds
s_addk_i32 m0, 1024
s_nop 0
buffer_load_dwordx4 v31, s[24:27], s50 offen offset:0 lds
s_mov_b32 s54, 0x20000
L_A_fo:
s_waitcnt lgkmcnt(0)
s_cmp_lg_u32 s96, 0
s_cbranch_scc1 L_A_fo_x
s_sub_u32 s54, s54, 1
s_cbranch_scc1 L_A_fo_x
s_atomic_add s96, s[20:21], s98 glc
s_branch L_A_fo
L_A_fo_x:
s_waitcnt vmcnt(18)
s_barrier
s_cmp_eq_u32 s3, 6
s_cbranch_scc0 L_A_na
s_mov_b32 s96, 1
s_atomic_add s96, s[92:93], 0 glc
L_A_na:
s_cmp_eq_u32 s3, 6
s_cbranch_scc0 L_A_oc_x
s_waitcnt lgkmcnt(0)
s_cmp_ge_u32 s96, 7
s_cbranch_scc1 L_A_oc_x
s_mov_b32 s54, 0x20000
L_A_oc:
s_mov_b32 s7, 0
s_atomic_add s7, s[92:93], 0 glc
s_waitcnt lgkmcnt(0)
s_sub_u32 s54, s54, 1
s_cbranch_scc1 L_A_oc_x
s_cmp_ge_u32 s7, 8
s_cbranch_scc0 L_A_oc
L_A_oc_x:
s_waitcnt vmcnt(0)
s_barrier
s_endpgm
L_AC:
s_mov_b32 s32, 0xffff
s_mov_b32 s33, 0
s_mov_b32 s34, -1
s_mov_b32 s35, 0
s_waitcnt lgkmcnt(0)
s_mov_b32 s24, s40
s_mov_b32 s25, s41
s_mov_b32 s26, 663552
s_mov_b32 s27, 0x20000
s_mov_b32 s28, s44
s_mov_b32 s29, s45
s_mov_b32 s30, 4718592
s_mov_b32 s31, 0x20000
s_mov_b32 s20, s46
s_mov_b32 s21, s47
s_mov_b32 s22, 256
s_mov_b32 s23, 0x20000
s_mov_b32 s16, s48
s_mov_b32 s17, s49
s_mov_b32 s18, 7340032
s_mov_b32 s19, 0x20000
s_or_b32 s7, s4, s3
s_cmp_eq_u32 s7, 0
s_cselect_b32 s55, 1, 0
v_mov_b32 v20, 0
v_mov_b32 v21, 0
v_mov_b32 v22, 0
v_mov_b32 v23, 0
s_cbranch_scc0 L_AC_i1
s_lshl_b32 s7, s6, 4
s_add_u32 s7, s7, s5
s_lshl_b32 s7, s7, 8
s_add_u32 s7, s7, 5505024
v_mov_b32 v24, s7
buffer_store_dword v20, v24, s[16:19], 0 offen sc1
L_AC_i1:
v_lshrrev_b32 v17, 5, v0
v_lshlrev_b32 v17, 4, v17
v_bfe_u32 v18, v0, 4, 1
v_lshl_add_u32 v17, v18, 2, v17
v_bfe_u32 v18, v0, 2, 2
v_add_u32 v17, v17, v18
v_mul_u32_u24 v17, 160, v17
v_and_b32 v18, 3, v0
v_lshl_add_u32 v1, v18, 3, v17
v_bfe_u32 v18, v0, 1, 1
v_mul_u32_u24 v18, 5120, v18
v_add_u32 v18, 128, v18
v_add_u32 v2, v18, v1
v_lshrrev_b32 v11, 4, v0
v_bfe_u32 v17, v0, 1, 3
v_xor_b32 v11, v11, v17
v_and_b32 v17, 15, v0
v_lshlrev_b32 v17, 7, v17
v_lshl_add_u32 v11, v11, 4, v17
v_xor_b32 v12, 64, v11
v_add_u32 v3, 61568, v1
v_add_u32 v4, 61568, v2
s_lshl_b32 s7, s3, 12
s_add_u32 s7, s7, 76960
v_add_u32 v11, s7, v11
v_add_u32 v12, s7, v12
s_lshr_b32 s7, s3, 1
s_lshl_b32 s7, s7, 3
v_and_b32 v17, 15, v0
v_xor_b32 v17, s7, v17
v_lshrrev_b32 v18, 4, v0
v_lshlrev_b32 v18, 2, v18
v_xor_b32 v18, s7, v18
v_sub_u32 v17, v17, v18
v_mov_b32 v19, 0xf149f2ca
s_and_b32 s7, s3, 1
s_or_b32 s7, s7, s5
s_cmp_eq_u32 s7, 0
s_cselect_b64 s[42:43], -1, 0
v_subrev_u32 v18, 0, v17
v_cmp_gt_u32 vcc, 8, v18
s_nop 1
v_cndmask_b32 v56, v19, 0, vcc
v_cmp_gt_i32 vcc, -8, v18
s_nop 1
v_cndmask_b32 v60, v19, 0, vcc
v_cndmask_b32 v64, v60, v19, s[42:43]
v_cmp_lt_i32 vcc, -1, v18
v_mov_b32 v20, 0xffff
s_nop 0
v_cndmask_b32 v20, 0, v20, vcc
v_mov_b32 v68, v20
v_subrev_u32 v18, 1, v17
v_cmp_gt_u32 vcc, 8, v18
s_nop 1
v_cndmask_b32 v57, v19, 0, vcc
v_cmp_gt_i32 vcc, -8, v18
s_nop 1
v_cndmask_b32 v61, v19, 0, vcc
v_cndmask_b32 v65, v61, v19, s[42:43]
v_cmp_lt_i32 vcc, -1, v18
v_mov_b32 v20, 0xffff0000
s_nop 0
v_cndmask_b32 v20, 0, v20, vcc
v_or_b32 v68, v68, v20
v_subrev_u32 v18, 2, v17
v_cmp_gt_u32 vcc, 8, v18
s_nop 1
v_cndmask_b32 v58, v19, 0, vcc
v_cmp_gt_i32 vcc, -8, v18
s_nop 1
v_cndmask_b32 v62, v19, 0, vcc
v_cndmask_b32 v66, v62, v19, s[42:43]
v_cmp_lt_i32 vcc, -1, v18
v_mov_b32 v20, 0xffff
s_nop 0
v_cndmask_b32 v20, 0, v20, vcc
v_mov_b32 v69, v20
v_subrev_u32 v18, 3, v17
v_cmp_gt_u32 vcc, 8, v18
s_nop 1
v_cndmask_b32 v59, v19, 0, vcc
v_cmp_gt_i32 vcc, -8, v18
s_nop 1
v_cndmask_b32 v63, v19, 0, vcc
v_cndmask_b32 v67, v63, v19, s[42:43]
v_cmp_lt_i32 vcc, -1, v18
v_mov_b32 v20, 0xffff0000
s_nop 0
v_cndmask_b32 v20, 0, v20, vcc
v_or_b32 v69, v69, v20
s_lshl_b32 s7, s5, 3
s_lshl_b32 s53, s3, 1
s_add_u32 s7, s7, s53
s_mul_i32 s7, s7, 18432
s_mul_i32 s53, s6, 2359296
s_add_u32 s58, s7, s53
s_lshl_b32 s53, s4, 11
s_add_u32 s53, s53, s58
v_lshl_add_u32 v13, v0, 4, s53
s_lshr_b32 s53, s4, 2
s_add_u32 s53, s53, 16
s_lshl_b32 s53, s53, 10
s_add_u32 s7, s58, s53
s_and_b32 s53, s4, 3
s_lshl_b32 s53, s53, 8
s_add_u32 s7, s7, s53
v_and_b32 v14, 15, v0
v_lshlrev_b32 v14, 4, v14
v_bfe_u32 v17, v0, 4, 1
v_lshl_add_u32 v14, v17, 3, v14
v_add_u32 v14, s7, v14
v_mov_b32 v17, 0x80000000
v_cndmask_b32 v14, v17, v14, s[34:35]
s_lshr_b32 s7, s3, 1
s_add_u32 s7, s7, 1
s_mul_i32 s7, s7, 5120
s_bitcmp1_b32 s3, 0
s_cselect_b32 s54, s7, 0
v_lshlrev_b32 v17, 3, v0
v_add_u32 v17, 132256, v17
v_add_u32 v15, s7, v17
v_add_u32 v16, s54, v17
s_barrier
ds_read_b128 v[72:75], v11 offset:0
ds_read_b128 v[76:79], v11 offset:2048
ds_read_b64_tr_b16 v[88:89], v1 offset:0
ds_read_b64_tr_b16 v[90:91], v1 offset:1280
ds_read_b64_tr_b16 v[92:93], v1 offset:32
ds_read_b64_tr_b16 v[94:95], v1 offset:1312
ds_read_b64_tr_b16 v[96:97], v1 offset:64
ds_read_b64_tr_b16 v[98:99], v1 offset:1344
ds_read_b64_tr_b16 v[100:101], v1 offset:96
ds_read_b64_tr_b16 v[102:103], v1 offset:1376
s_waitcnt lgkmcnt(6)
v_mfma_f32_16x16x32_bf16 v[144:147], v[88:91], v[72:75], 0
ds_read_b64_tr_b16 v[104:105], v2 offset:0
v_mfma_f32_16x16x32_bf16 v[148:151], v[88:91], v[76:79], 0
ds_read_b64_tr_b16 v[106:107], v2 offset:1280
s_waitcnt lgkmcnt(6)
v_mfma_f32_16x16x32_bf16 v[152:155], v[92:95], v[72:75], 0
ds_read_b64_tr_b16 v[108:109], v1 offset:5136
v_mfma_f32_16x16x32_bf16 v[156:159], v[92:95], v[76:79], 0
ds_read_b64_tr_b16 v[110:111], v1 offset:6416
s_waitcnt lgkmcnt(6)
v_mfma_f32_16x16x32_bf16 v[160:163], v[96:99], v[72:75], 0
ds_read_b64_tr_b16 v[112:113], v1 offset:5168
v_mfma_f32_16x16x32_bf16 v[164:167], v[96:99], v[76:79], 0
ds_read_b64_tr_b16 v[114:115], v1 offset:6448
s_waitcnt lgkmcnt(6)
v_mfma_f32_16x16x32_bf16 v[168:171], v[100:103], v[72:75], 0
ds_read_b64_tr_b16 v[116:117], v1 offset:5200
v_mfma_f32_16x16x32_bf16 v[172:175], v[100:103], v[76:79], 0
ds_read_b64_tr_b16 v[118:119], v1 offset:6480
s_waitcnt lgkmcnt(6)
v_mfma_f32_16x16x32_bf16 v[176:179], v[104:107], v[72:75], 0
ds_read_b64_tr_b16 v[120:121], v1 offset:5232
v_mfma_f32_16x16x32_bf16 v[180:183], v[104:107], v[76:79], 0
ds_read_b64_tr_b16 v[122:123], v1 offset:6512
s_waitcnt lgkmcnt(6)
v_mfma_f32_16x16x32_bf16 v[184:187], v[108:111], v[72:75], 0
ds_read_b64_tr_b16 v[124:125], v1 offset:10272
v_mfma_f32_16x16x32_bf16 v[188:191], v[108:111], v[76:79], 0
ds_read_b64_tr_b16 v[126:127], v1 offset:11552
s_waitcnt lgkmcnt(6)
v_mfma_f32_16x16x32_bf16 v[192:195], v[112:115], v[72:75], 0
ds_read_b64_tr_b16 v[128:129], v1 offset:10304
v_mfma_f32_16x16x32_bf16 v[196:199], v[112:115], v[76:79], 0
ds_read_b64_tr_b16 v[130:131], v1 offset:11584
s_waitcnt lgkmcnt(6)
v_mfma_f32_16x16x32_bf16 v[200:203], v[116:119], v[72:75], 0
ds_read_b64_tr_b16 v[132:133], v1 offset:10336
v_mfma_f32_16x16x32_bf16 v[204:207], v[116:119], v[76:79], 0
ds_read_b64_tr_b16 v[134:135], v1 offset:11616
s_waitcnt lgkmcnt(6)
v_mfma_f32_16x16x32_bf16 v[208:211], v[120:123], v[72:75], 0
ds_read_b64_tr_b16 v[136:137], v1 offset:10368
v_mfma_f32_16x16x32_bf16 v[212:215], v[120:123], v[76:79], 0
ds_read_b64_tr_b16 v[138:139], v1 offset:11648
s_waitcnt lgkmcnt(6)
v_mfma_f32_16x16x32_bf16 v[216:219], v[72:75], v[124:127], 0
ds_read_b64_tr_b16 v[140:141], v1 offset:10400
v_mfma_f32_16x16x32_bf16 v[220:223], v[76:79], v[124:127], 0
ds_read_b64_tr_b16 v[142:143], v1 offset:11680
s_waitcnt lgkmcnt(6)
v_mfma_f32_16x16x32_bf16 v[224:227], v[72:75], v[128:131], 0
s_barrier
ds_read_b128 v[80:83], v12 offset:0
v_mfma_f32_16x16x32_bf16 v[228:231], v[76:79], v[128:131], 0
ds_read_b128 v[84:87], v12 offset:2048
ds_read_b64_tr_b16 v[88:89], v1 offset:15392
s_waitcnt lgkmcnt(7)
v_mfma_f32_16x16x32_bf16 v[232:235], v[72:75], v[132:135], 0
ds_read_b64_tr_b16 v[90:91], v1 offset:16672
v_mfma_f32_16x16x32_bf16 v[236:239], v[76:79], v[132:135], 0
ds_read_b64_tr_b16 v[92:93], v1 offset:15424
s_waitcnt lgkmcnt(7)
v_mfma_f32_16x16x32_bf16 v[240:243], v[72:75], v[136:139], 0
ds_read_b64_tr_b16 v[94:95], v1 offset:16704
v_mfma_f32_16x16x32_bf16 v[244:247], v[76:79], v[136:139], 0
ds_read_b64_tr_b16 v[96:97], v1 offset:15456
s_waitcnt lgkmcnt(7)
v_mfma_f32_16x16x32_bf16 v[248:251], v[72:75], v[140:143], 0
ds_read_b64_tr_b16 v[98:99], v1 offset:16736
v_mfma_f32_16x16x32_bf16 v[252:255], v[76:79], v[140:143], 0
ds_read_b64_tr_b16 v[100:101], v1 offset:15488
s_waitcnt lgkmcnt(5)
v_mfma_f32_16x16x32_bf16 v[144:147], v[88:91], v[80:83], v[144:147]
ds_read_b64_tr_b16 v[102:103], v1 offset:16768
v_mfma_f32_16x16x32_bf16 v[148:151], v[88:91], v[84:87], v[148:151]
ds_read_b64_tr_b16 v[104:105], v2 offset:15392
s_waitcnt lgkmcnt(5)
v_mfma_f32_16x16x32_bf16 v[152:155], v[92:95], v[80:83], v[152:155]
ds_read_b64_tr_b16 v[106:107], v2 offset:16672
v_mfma_f32_16x16x32_bf16 v[156:159], v[92:95], v[84:87], v[156:159]
ds_read_b64_tr_b16 v[108:109], v1 offset:20528
s_waitcnt lgkmcnt(5)
v_mfma_f32_16x16x32_bf16 v[160:163], v[96:99], v[80:83], v[160:163]
ds_read_b64_tr_b16 v[110:111], v1 offset:21808
v_mfma_f32_16x16x32_bf16 v[164:167], v[96:99], v[84:87], v[164:167]
ds_read_b64_tr_b16 v[112:113], v1 offset:20560
s_waitcnt lgkmcnt(5)
v_mfma_f32_16x16x32_bf16 v[168:171], v[100:103], v[80:83], v[168:171]
ds_read_b64_tr_b16 v[114:115], v1 offset:21840
v_mfma_f32_16x16x32_bf16 v[172:175], v[100:103], v[84:87], v[172:175]
ds_read_b64_tr_b16 v[116:117], v1 offset:20592
s_waitcnt lgkmcnt(5)
v_mfma_f32_16x16x32_bf16 v[176:179], v[104:107], v[80:83], v[176:179]
ds_read_b64_tr_b16 v[118:119], v1 offset:21872
v_mfma_f32_16x16x32_bf16 v[180:183], v[104:107], v[84:87], v[180:183]
ds_read_b64_tr_b16 v[120:121], v1 offset:20624
s_waitcnt lgkmcnt(5)
v_mfma_f32_16x16x32_bf16 v[184:187], v[108:111], v[80:83], v[184:187]
ds_read_b64_tr_b16 v[122:123], v1 offset:21904
v_mfma_f32_16x16x32_bf16 v[188:191], v[108:111], v[84:87], v[188:191]
ds_read_b64_tr_b16 v[124:125], v1 offset:25664
s_waitcnt lgkmcnt(5)
v_mfma_f32_16x16x32_bf16 v[192:195], v[112:115], v[80:83], v[192:195]
ds_read_b64_tr_b16 v[126:127], v1 offset:26944
v_mfma_f32_16x16x32_bf16 v[196:199], v[112:115], v[84:87], v[196:199]
ds_read_b64_tr_b16 v[128:129], v1 offset:25696
s_waitcnt lgkmcnt(5)
v_mfma_f32_16x16x32_bf16 v[200:203], v[116:119], v[80:83], v[200:203]
ds_read_b64_tr_b16 v[130:131], v1 offset:26976
v_mfma_f32_16x16x32_bf16 v[204:207], v[116:119], v[84:87], v[204:207]
ds_read_b64_tr_b16 v[132:133], v1 offset:25728
s_waitcnt lgkmcnt(5)
v_mfma_f32_16x16x32_bf16 v[208:211], v[120:123], v[80:83], v[208:211]
ds_read_b64_tr_b16 v[134:135], v1 offset:27008
v_mfma_f32_16x16x32_bf16 v[212:215], v[120:123], v[84:87], v[212:215]
ds_read_b64_tr_b16 v[136:137], v1 offset:25760
s_waitcnt lgkmcnt(5)
v_mfma_f32_16x16x32_bf16 v[216:219], v[80:83], v[124:127], v[216:219]
ds_read_b64_tr_b16 v[138:139], v1 offset:27040
v_mfma_f32_16x16x32_bf16 v[220:223], v[84:87], v[124:127], v[220:223]
ds_read_b64_tr_b16 v[140:141], v1 offset:25792
s_waitcnt lgkmcnt(5)
v_mfma_f32_16x16x32_bf16 v[224:227], v[80:83], v[128:131], v[224:227]
ds_read_b64_tr_b16 v[142:143], v1 offset:27072
v_mfma_f32_16x16x32_bf16 v[228:231], v[84:87], v[128:131], v[228:231]
s_barrier
ds_read_b128 v[72:75], v11 offset:18432
ds_read_b128 v[76:79], v11 offset:20480
s_waitcnt lgkmcnt(6)
v_mfma_f32_16x16x32_bf16 v[232:235], v[80:83], v[132:135], v[232:235]
ds_read_b64_tr_b16 v[88:89], v1 offset:30784
v_mfma_f32_16x16x32_bf16 v[236:239], v[84:87], v[132:135], v[236:239]
ds_read_b64_tr_b16 v[90:91], v1 offset:32064
ds_read_b64_tr_b16 v[92:93], v1 offset:30816
s_waitcnt lgkmcnt(7)
v_mfma_f32_16x16x32_bf16 v[240:243], v[80:83], v[136:139], v[240:243]
ds_read_b64_tr_b16 v[94:95], v1 offset:32096
v_mfma_f32_16x16x32_bf16 v[244:247], v[84:87], v[136:139], v[244:247]
ds_read_b64_tr_b16 v[96:97], v1 offset:30848
s_waitcnt lgkmcnt(7)
v_mfma_f32_16x16x32_bf16 v[248:251], v[80:83], v[140:143], v[248:251]
ds_read_b64_tr_b16 v[98:99], v1 offset:32128
v_mfma_f32_16x16x32_bf16 v[252:255], v[84:87], v[140:143], v[252:255]
ds_read_b64_tr_b16 v[100:101], v1 offset:30880
s_waitcnt vmcnt(0)
s_cmp_eq_u32 s55, 0
s_cbranch_scc1 L_AC_f2
v_mov_b32 v20, 1
s_bitcmp1_b32 s55, 0
s_cbranch_scc0 L_AC_f1
s_lshl_b32 s7, s6, 4
s_add_u32 s7, s7, s5
s_lshl_b32 s7, s7, 2
s_add_u32 s7, s7, 32
v_mov_b32 v24, s7
buffer_store_dword v20, v24, s[20:23], 0 offen sc1
L_AC_f1:
s_bitcmp1_b32 s55, 1
s_cbranch_scc0 L_AC_f2
s_lshl_b32 s7, s4, 2
v_mov_b32 v25, s7
buffer_store_dword v20, v25, s[20:23], 0 offen sc1
L_AC_f2:
s_waitcnt lgkmcnt(5)
v_mfma_f32_16x16x32_bf16 v[144:147], v[88:91], v[72:75], v[144:147]
ds_read_b64_tr_b16 v[102:103], v1 offset:32160
v_mfma_f32_16x16x32_bf16 v[148:151], v[88:91], v[76:79], v[148:151]
ds_read_b64_tr_b16 v[104:105], v2 offset:30784
s_waitcnt lgkmcnt(5)
v_mfma_f32_16x16x32_bf16 v[152:155], v[92:95], v[72:75], v[152:155]
ds_read_b64_tr_b16 v[106:107], v2 offset:32064
v_mfma_f32_16x16x32_bf16 v[156:159], v[92:95], v[76:79], v[156:159]
ds_read_b64_tr_b16 v[108:109], v1 offset:35920
s_waitcnt lgkmcnt(5)
v_mfma_f32_16x16x32_bf16 v[160:163], v[96:99], v[72:75], v[160:163]
ds_read_b64_tr_b16 v[110:111], v1 offset:37200
v_mfma_f32_16x16x32_bf16 v[164:167], v[96:99], v[76:79], v[164:167]
ds_read_b64_tr_b16 v[112:113], v1 offset:35952
s_waitcnt lgkmcnt(5)
v_mfma_f32_16x16x32_bf16 v[168:171], v[100:103], v[72:75], v[168:171]
ds_read_b64_tr_b16 v[114:115], v1 offset:37232
v_mfma_f32_16x16x32_bf16 v[172:175], v[100:103], v[76:79], v[172:175]
ds_read_b64_tr_b16 v[116:117], v1 offset:35984
s_waitcnt lgkmcnt(5)
v_mfma_f32_16x16x32_bf16 v[176:179], v[104:107], v[72:75], v[176:179]
ds_read_b64_tr_b16 v[118:119], v1 offset:37264
v_mfma_f32_16x16x32_bf16 v[180:183], v[104:107], v[76:79], v[180:183]
ds_read_b64_tr_b16 v[120:121], v1 offset:36016
s_waitcnt lgkmcnt(5)
v_mfma_f32_16x16x32_bf16 v[184:187], v[108:111], v[72:75], v[184:187]
ds_read_b64_tr_b16 v[122:123], v1 offset:37296
v_mfma_f32_16x16x32_bf16 v[188:191], v[108:111], v[76:79], v[188:191]
ds_read_b64_tr_b16 v[124:125], v1 offset:41056
s_waitcnt lgkmcnt(5)
v_mfma_f32_16x16x32_bf16 v[192:195], v[112:115], v[72:75], v[192:195]
ds_read_b64_tr_b16 v[126:127], v1 offset:42336
v_mfma_f32_16x16x32_bf16 v[196:199], v[112:115], v[76:79], v[196:199]
ds_read_b64_tr_b16 v[128:129], v1 offset:41088
s_waitcnt lgkmcnt(5)
v_mfma_f32_16x16x32_bf16 v[200:203], v[116:119], v[72:75], v[200:203]
ds_read_b64_tr_b16 v[130:131], v1 offset:42368
v_mfma_f32_16x16x32_bf16 v[204:207], v[116:119], v[76:79], v[204:207]
ds_read_b64_tr_b16 v[132:133], v1 offset:41120
s_waitcnt lgkmcnt(5)
v_mfma_f32_16x16x32_bf16 v[208:211], v[120:123], v[72:75], v[208:211]
ds_read_b64_tr_b16 v[134:135], v1 offset:42400
v_mfma_f32_16x16x32_bf16 v[212:215], v[120:123], v[76:79], v[212:215]
ds_read_b64_tr_b16 v[136:137], v1 offset:41152
s_waitcnt lgkmcnt(5)
v_mfma_f32_16x16x32_bf16 v[216:219], v[72:75], v[124:127], v[216:219]
ds_read_b64_tr_b16 v[138:139], v1 offset:42432
v_mfma_f32_16x16x32_bf16 v[220:223], v[76:79], v[124:127], v[220:223]
ds_read_b64_tr_b16 v[140:141], v1 offset:41184
s_waitcnt lgkmcnt(5)
v_mfma_f32_16x16x32_bf16 v[224:227], v[72:75], v[128:131], v[224:227]
ds_read_b64_tr_b16 v[142:143], v1 offset:42464
v_mfma_f32_16x16x32_bf16 v[228:231], v[76:79], v[128:131], v[228:231]
s_barrier
ds_read_b128 v[80:83], v12 offset:18432
ds_read_b128 v[84:87], v12 offset:20480
s_waitcnt lgkmcnt(6)
v_mfma_f32_16x16x32_bf16 v[232:235], v[72:75], v[132:135], v[232:235]
ds_read_b64_tr_b16 v[88:89], v1 offset:46176
v_mfma_f32_16x16x32_bf16 v[236:239], v[76:79], v[132:135], v[236:239]
ds_read_b64_tr_b16 v[90:91], v1 offset:47456
ds_read_b64_tr_b16 v[92:93], v1 offset:46208
s_waitcnt lgkmcnt(7)
v_mfma_f32_16x16x32_bf16 v[240:243], v[72:75], v[136:139], v[240:243]
ds_read_b64_tr_b16 v[94:95], v1 offset:47488
v_mfma_f32_16x16x32_bf16 v[244:247], v[76:79], v[136:139], v[244:247]
ds_read_b64_tr_b16 v[96:97], v1 offset:46240
s_waitcnt lgkmcnt(7)
v_mfma_f32_16x16x32_bf16 v[248:251], v[72:75], v[140:143], v[248:251]
ds_read_b64_tr_b16 v[98:99], v1 offset:47520
v_mfma_f32_16x16x32_bf16 v[252:255], v[76:79], v[140:143], v[252:255]
ds_read_b64_tr_b16 v[100:101], v1 offset:46272
s_waitcnt lgkmcnt(5)
v_mfma_f32_16x16x32_bf16 v[144:147], v[88:91], v[80:83], v[144:147]
ds_read_b64_tr_b16 v[102:103], v1 offset:47552
v_mfma_f32_16x16x32_bf16 v[148:151], v[88:91], v[84:87], v[148:151]
ds_read_b64_tr_b16 v[104:105], v2 offset:46176
s_waitcnt lgkmcnt(5)
v_mfma_f32_16x16x32_bf16 v[152:155], v[92:95], v[80:83], v[152:155]
ds_read_b64_tr_b16 v[106:107], v2 offset:47456
v_mfma_f32_16x16x32_bf16 v[156:159], v[92:95], v[84:87], v[156:159]
ds_read_b64_tr_b16 v[108:109], v1 offset:51312
s_waitcnt lgkmcnt(5)
v_mfma_f32_16x16x32_bf16 v[160:163], v[96:99], v[80:83], v[160:163]
ds_read_b64_tr_b16 v[110:111], v1 offset:52592
v_mfma_f32_16x16x32_bf16 v[164:167], v[96:99], v[84:87], v[164:167]
ds_read_b64_tr_b16 v[112:113], v1 offset:51344
s_waitcnt lgkmcnt(5)
v_mfma_f32_16x16x32_bf16 v[168:171], v[100:103], v[80:83], v[168:171]
ds_read_b64_tr_b16 v[114:115], v1 offset:52624
v_mfma_f32_16x16x32_bf16 v[172:175], v[100:103], v[84:87], v[172:175]
ds_read_b64_tr_b16 v[116:117], v1 offset:51376
s_waitcnt lgkmcnt(5)
v_mfma_f32_16x16x32_bf16 v[176:179], v[104:107], v[80:83], v[176:179]
ds_read_b64_tr_b16 v[118:119], v1 offset:52656
v_mfma_f32_16x16x32_bf16 v[180:183], v[104:107], v[84:87], v[180:183]
ds_read_b64_tr_b16 v[120:121], v1 offset:51408
s_waitcnt lgkmcnt(5)
v_mfma_f32_16x16x32_bf16 v[184:187], v[108:111], v[80:83], v[184:187]
ds_read_b64_tr_b16 v[122:123], v1 offset:52688
v_mfma_f32_16x16x32_bf16 v[188:191], v[108:111], v[84:87], v[188:191]
ds_read_b64_tr_b16 v[124:125], v1 offset:56448
s_waitcnt lgkmcnt(5)
v_mfma_f32_16x16x32_bf16 v[192:195], v[112:115], v[80:83], v[192:195]
ds_read_b64_tr_b16 v[126:127], v1 offset:57728
v_mfma_f32_16x16x32_bf16 v[196:199], v[112:115], v[84:87], v[196:199]
ds_read_b64_tr_b16 v[128:129], v1 offset:56480
s_waitcnt lgkmcnt(5)
v_mfma_f32_16x16x32_bf16 v[200:203], v[116:119], v[80:83], v[200:203]
ds_read_b64_tr_b16 v[130:131], v1 offset:57760
v_mfma_f32_16x16x32_bf16 v[204:207], v[116:119], v[84:87], v[204:207]
ds_read_b64_tr_b16 v[132:133], v1 offset:56512
s_waitcnt lgkmcnt(5)
v_mfma_f32_16x16x32_bf16 v[208:211], v[120:123], v[80:83], v[208:211]
ds_read_b64_tr_b16 v[134:135], v1 offset:57792
v_mfma_f32_16x16x32_bf16 v[212:215], v[120:123], v[84:87], v[212:215]
ds_read_b64_tr_b16 v[136:137], v1 offset:56544
s_waitcnt lgkmcnt(5)
v_mfma_f32_16x16x32_bf16 v[216:219], v[80:83], v[124:127], v[216:219]
ds_read_b64_tr_b16 v[138:139], v1 offset:57824
v_mfma_f32_16x16x32_bf16 v[220:223], v[84:87], v[124:127], v[220:223]
ds_read_b64_tr_b16 v[140:141], v1 offset:56576
s_waitcnt lgkmcnt(5)
v_mfma_f32_16x16x32_bf16 v[224:227], v[80:83], v[128:131], v[224:227]
ds_read_b64_tr_b16 v[142:143], v1 offset:57856
v_mfma_f32_16x16x32_bf16 v[228:231], v[84:87], v[128:131], v[228:231]
s_barrier
ds_read_b128 v[72:75], v11 offset:36864
ds_read_b128 v[76:79], v11 offset:38912
s_waitcnt lgkmcnt(6)
v_mfma_f32_16x16x32_bf16 v[232:235], v[80:83], v[132:135], v[232:235]
ds_read_b64_tr_b16 v[88:89], v3 offset:0
v_mfma_f32_16x16x32_bf16 v[236:239], v[84:87], v[132:135], v[236:239]
ds_read_b64_tr_b16 v[90:91], v3 offset:1280
ds_read_b64_tr_b16 v[92:93], v3 offset:32
s_waitcnt lgkmcnt(7)
v_mfma_f32_16x16x32_bf16 v[240:243], v[80:83], v[136:139], v[240:243]
ds_read_b64_tr_b16 v[94:95], v3 offset:1312
v_mfma_f32_16x16x32_bf16 v[244:247], v[84:87], v[136:139], v[244:247]
ds_read_b64_tr_b16 v[96:97], v3 offset:64
s_waitcnt lgkmcnt(7)
v_mfma_f32_16x16x32_bf16 v[248:251], v[80:83], v[140:143], v[248:251]
ds_read_b64_tr_b16 v[98:99], v3 offset:1344
v_mfma_f32_16x16x32_bf16 v[252:255], v[84:87], v[140:143], v[252:255]
ds_read_b64_tr_b16 v[100:101], v3 offset:96
s_waitcnt lgkmcnt(5)
v_mfma_f32_16x16x32_bf16 v[144:147], v[88:91], v[72:75], v[144:147]
ds_read_b64_tr_b16 v[102:103], v3 offset:1376
v_mfma_f32_16x16x32_bf16 v[148:151], v[88:91], v[76:79], v[148:151]
ds_read_b64_tr_b16 v[104:105], v4 offset:0
s_waitcnt lgkmcnt(5)
v_mfma_f32_16x16x32_bf16 v[152:155], v[92:95], v[72:75], v[152:155]
ds_read_b64_tr_b16 v[106:107], v4 offset:1280
v_mfma_f32_16x16x32_bf16 v[156:159], v[92:95], v[76:79], v[156:159]
ds_read_b64_tr_b16 v[108:109], v3 offset:5136
s_waitcnt lgkmcnt(5)
v_mfma_f32_16x16x32_bf16 v[160:163], v[96:99], v[72:75], v[160:163]
ds_read_b64_tr_b16 v[110:111], v3 offset:6416
v_mfma_f32_16x16x32_bf16 v[164:167], v[96:99], v[76:79], v[164:167]
ds_read_b64_tr_b16 v[112:113], v3 offset:5168
s_waitcnt lgkmcnt(5)
v_mfma_f32_16x16x32_bf16 v[168:171], v[100:103], v[72:75], v[168:171]
ds_read_b64_tr_b16 v[114:115], v3 offset:6448
v_mfma_f32_16x16x32_bf16 v[172:175], v[100:103], v[76:79], v[172:175]
ds_read_b64_tr_b16 v[116:117], v3 offset:5200
s_waitcnt lgkmcnt(5)
v_mfma_f32_16x16x32_bf16 v[176:179], v[104:107], v[72:75], v[176:179]
ds_read_b64_tr_b16 v[118:119], v3 offset:6480
v_mfma_f32_16x16x32_bf16 v[180:183], v[104:107], v[76:79], v[180:183]
ds_read_b64_tr_b16 v[120:121], v3 offset:5232
s_waitcnt lgkmcnt(5)
v_mfma_f32_16x16x32_bf16 v[184:187], v[108:111], v[72:75], v[184:187]
ds_read_b64_tr_b16 v[122:123], v3 offset:6512
v_mfma_f32_16x16x32_bf16 v[188:191], v[108:111], v[76:79], v[188:191]
ds_read_b64_tr_b16 v[124:125], v3 offset:10272
s_waitcnt lgkmcnt(5)
v_mfma_f32_16x16x32_bf16 v[192:195], v[112:115], v[72:75], v[192:195]
ds_read_b64_tr_b16 v[126:127], v3 offset:11552
v_mfma_f32_16x16x32_bf16 v[196:199], v[112:115], v[76:79], v[196:199]
ds_read_b64_tr_b16 v[128:129], v3 offset:10304
s_waitcnt lgkmcnt(5)
v_mfma_f32_16x16x32_bf16 v[200:203], v[116:119], v[72:75], v[200:203]
ds_read_b64_tr_b16 v[130:131], v3 offset:11584
v_mfma_f32_16x16x32_bf16 v[204:207], v[116:119], v[76:79], v[204:207]
ds_read_b64_tr_b16 v[132:133], v3 offset:10336
s_waitcnt lgkmcnt(5)
v_mfma_f32_16x16x32_bf16 v[208:211], v[120:123], v[72:75], v[208:211]
ds_read_b64_tr_b16 v[134:135], v3 offset:11616
v_mfma_f32_16x16x32_bf16 v[212:215], v[120:123], v[76:79], v[212:215]
ds_read_b64_tr_b16 v[136:137], v3 offset:10368
s_waitcnt lgkmcnt(5)
v_mfma_f32_16x16x32_bf16 v[216:219], v[72:75], v[124:127], v[216:219]
ds_read_b64_tr_b16 v[138:139], v3 offset:11648
v_mfma_f32_16x16x32_bf16 v[220:223], v[76:79], v[124:127], v[220:223]
ds_read_b64_tr_b16 v[140:141], v3 offset:10400
s_waitcnt lgkmcnt(5)
v_mfma_f32_16x16x32_bf16 v[224:227], v[72:75], v[128:131], v[224:227]
ds_read_b64_tr_b16 v[142:143], v3 offset:11680
v_mfma_f32_16x16x32_bf16 v[228:231], v[76:79], v[128:131], v[228:231]
s_barrier
ds_read_b128 v[80:83], v12 offset:36864
ds_read_b128 v[84:87], v12 offset:38912
s_waitcnt lgkmcnt(6)
v_mfma_f32_16x16x32_bf16 v[232:235], v[72:75], v[132:135], v[232:235]
ds_read_b64_tr_b16 v[88:89], v1 offset:0
v_mfma_f32_16x16x32_bf16 v[236:239], v[76:79], v[132:135], v[236:239]
ds_read_b64_tr_b16 v[90:91], v1 offset:1280
ds_read_b64_tr_b16 v[92:93], v1 offset:32
s_waitcnt lgkmcnt(7)
v_mfma_f32_16x16x32_bf16 v[240:243], v[72:75], v[136:139], v[240:243]
ds_read_b64_tr_b16 v[94:95], v1 offset:1312
v_mfma_f32_16x16x32_bf16 v[244:247], v[76:79], v[136:139], v[244:247]
ds_read_b64_tr_b16 v[96:97], v1 offset:64
s_waitcnt lgkmcnt(7)
v_mfma_f32_16x16x32_bf16 v[248:251], v[72:75], v[140:143], v[248:251]
ds_read_b64_tr_b16 v[98:99], v1 offset:1344
v_mfma_f32_16x16x32_bf16 v[252:255], v[76:79], v[140:143], v[252:255]
ds_read_b64_tr_b16 v[100:101], v1 offset:96
s_waitcnt lgkmcnt(5)
v_mfma_f32_16x16x32_bf16 v[144:147], v[88:91], v[80:83], v[144:147]
ds_read_b64_tr_b16 v[102:103], v1 offset:1376
v_mfma_f32_16x16x32_bf16 v[148:151], v[88:91], v[84:87], v[148:151]
ds_read_b64_tr_b16 v[104:105], v2 offset:0
s_waitcnt lgkmcnt(5)
v_mfma_f32_16x16x32_bf16 v[152:155], v[92:95], v[80:83], v[152:155]
ds_read_b64_tr_b16 v[106:107], v2 offset:1280
v_mfma_f32_16x16x32_bf16 v[156:159], v[92:95], v[84:87], v[156:159]
ds_read_b64_tr_b16 v[108:109], v1 offset:5136
s_waitcnt lgkmcnt(5)
v_mfma_f32_16x16x32_bf16 v[160:163], v[96:99], v[80:83], v[160:163]
ds_read_b64_tr_b16 v[110:111], v1 offset:6416
v_mfma_f32_16x16x32_bf16 v[164:167], v[96:99], v[84:87], v[164:167]
ds_read_b64_tr_b16 v[112:113], v1 offset:5168
s_waitcnt lgkmcnt(5)
v_mfma_f32_16x16x32_bf16 v[168:171], v[100:103], v[80:83], v[168:171]
ds_read_b64_tr_b16 v[114:115], v1 offset:6448
v_mfma_f32_16x16x32_bf16 v[172:175], v[100:103], v[84:87], v[172:175]
ds_read_b64_tr_b16 v[116:117], v1 offset:5200
s_waitcnt lgkmcnt(5)
v_mfma_f32_16x16x32_bf16 v[176:179], v[104:107], v[80:83], v[176:179]
ds_read_b64_tr_b16 v[118:119], v1 offset:6480
v_mfma_f32_16x16x32_bf16 v[180:183], v[104:107], v[84:87], v[180:183]
ds_read_b64_tr_b16 v[120:121], v1 offset:5232
s_waitcnt lgkmcnt(5)
v_mfma_f32_16x16x32_bf16 v[184:187], v[108:111], v[80:83], v[184:187]
ds_read_b64_tr_b16 v[122:123], v1 offset:6512
v_mfma_f32_16x16x32_bf16 v[188:191], v[108:111], v[84:87], v[188:191]
ds_read_b64_tr_b16 v[124:125], v1 offset:10272
s_waitcnt lgkmcnt(5)
v_mfma_f32_16x16x32_bf16 v[192:195], v[112:115], v[80:83], v[192:195]
ds_read_b64_tr_b16 v[126:127], v1 offset:11552
v_mfma_f32_16x16x32_bf16 v[196:199], v[112:115], v[84:87], v[196:199]
ds_read_b64_tr_b16 v[128:129], v1 offset:10304
s_waitcnt lgkmcnt(5)
v_mfma_f32_16x16x32_bf16 v[200:203], v[116:119], v[80:83], v[200:203]
ds_read_b64_tr_b16 v[130:131], v1 offset:11584
v_mfma_f32_16x16x32_bf16 v[204:207], v[116:119], v[84:87], v[204:207]
ds_read_b64_tr_b16 v[132:133], v1 offset:10336
s_waitcnt lgkmcnt(5)
v_mfma_f32_16x16x32_bf16 v[208:211], v[120:123], v[80:83], v[208:211]
ds_read_b64_tr_b16 v[134:135], v1 offset:11616
v_mfma_f32_16x16x32_bf16 v[212:215], v[120:123], v[84:87], v[212:215]
ds_read_b64_tr_b16 v[136:137], v1 offset:10368
s_waitcnt lgkmcnt(5)
v_mfma_f32_16x16x32_bf16 v[216:219], v[80:83], v[124:127], v[216:219]
ds_read_b64_tr_b16 v[138:139], v1 offset:11648
v_mfma_f32_16x16x32_bf16 v[220:223], v[84:87], v[124:127], v[220:223]
ds_read_b64_tr_b16 v[140:141], v1 offset:10400
s_waitcnt lgkmcnt(5)
v_mfma_f32_16x16x32_bf16 v[224:227], v[80:83], v[128:131], v[224:227]
ds_read_b64_tr_b16 v[142:143], v1 offset:11680
v_mfma_f32_16x16x32_bf16 v[228:231], v[84:87], v[128:131], v[228:231]
s_barrier
ds_read_b128 v[72:75], v11 offset:0
ds_read_b128 v[76:79], v11 offset:2048
s_waitcnt lgkmcnt(6)
v_mfma_f32_16x16x32_bf16 v[232:235], v[80:83], v[132:135], v[232:235]
ds_read_b64_tr_b16 v[88:89], v1 offset:15392
v_mfma_f32_16x16x32_bf16 v[236:239], v[84:87], v[132:135], v[236:239]
ds_read_b64_tr_b16 v[90:91], v1 offset:16672
ds_read_b64_tr_b16 v[92:93], v1 offset:15424
s_waitcnt lgkmcnt(7)
v_mfma_f32_16x16x32_bf16 v[240:243], v[80:83], v[136:139], v[240:243]
ds_read_b64_tr_b16 v[94:95], v1 offset:16704
v_mfma_f32_16x16x32_bf16 v[244:247], v[84:87], v[136:139], v[244:247]
ds_read_b64_tr_b16 v[96:97], v1 offset:15456
s_waitcnt lgkmcnt(7)
v_mfma_f32_16x16x32_bf16 v[248:251], v[80:83], v[140:143], v[248:251]
ds_read_b64_tr_b16 v[98:99], v1 offset:16736
v_mfma_f32_16x16x32_bf16 v[252:255], v[84:87], v[140:143], v[252:255]
ds_read_b64_tr_b16 v[100:101], v1 offset:15488
s_waitcnt lgkmcnt(5)
v_mfma_f32_16x16x32_bf16 v[144:147], v[88:91], v[72:75], v[144:147]
ds_read_b64_tr_b16 v[102:103], v1 offset:16768
v_mfma_f32_16x16x32_bf16 v[148:151], v[88:91], v[76:79], v[148:151]
ds_read_b64_tr_b16 v[104:105], v2 offset:15392
s_waitcnt lgkmcnt(5)
v_mfma_f32_16x16x32_bf16 v[152:155], v[92:95], v[72:75], v[152:155]
ds_read_b64_tr_b16 v[106:107], v2 offset:16672
v_mfma_f32_16x16x32_bf16 v[156:159], v[92:95], v[76:79], v[156:159]
ds_read_b64_tr_b16 v[108:109], v1 offset:20528
s_waitcnt lgkmcnt(5)
v_mfma_f32_16x16x32_bf16 v[160:163], v[96:99], v[72:75], v[160:163]
ds_read_b64_tr_b16 v[110:111], v1 offset:21808
v_mfma_f32_16x16x32_bf16 v[164:167], v[96:99], v[76:79], v[164:167]
ds_read_b64_tr_b16 v[112:113], v1 offset:20560
s_waitcnt lgkmcnt(5)
v_mfma_f32_16x16x32_bf16 v[168:171], v[100:103], v[72:75], v[168:171]
ds_read_b64_tr_b16 v[114:115], v1 offset:21840
v_mfma_f32_16x16x32_bf16 v[172:175], v[100:103], v[76:79], v[172:175]
ds_read_b64_tr_b16 v[116:117], v1 offset:20592
s_waitcnt lgkmcnt(5)
v_mfma_f32_16x16x32_bf16 v[176:179], v[104:107], v[72:75], v[176:179]
ds_read_b64_tr_b16 v[118:119], v1 offset:21872
v_mfma_f32_16x16x32_bf16 v[180:183], v[104:107], v[76:79], v[180:183]
ds_read_b64_tr_b16 v[120:121], v1 offset:20624
s_waitcnt lgkmcnt(5)
v_mfma_f32_16x16x32_bf16 v[184:187], v[108:111], v[72:75], v[184:187]
ds_read_b64_tr_b16 v[122:123], v1 offset:21904
v_mfma_f32_16x16x32_bf16 v[188:191], v[108:111], v[76:79], v[188:191]
ds_read_b64_tr_b16 v[124:125], v1 offset:25664
s_waitcnt lgkmcnt(5)
v_mfma_f32_16x16x32_bf16 v[192:195], v[112:115], v[72:75], v[192:195]
ds_read_b64_tr_b16 v[126:127], v1 offset:26944
v_mfma_f32_16x16x32_bf16 v[196:199], v[112:115], v[76:79], v[196:199]
ds_read_b64_tr_b16 v[128:129], v1 offset:25696
s_waitcnt lgkmcnt(5)
v_mfma_f32_16x16x32_bf16 v[200:203], v[116:119], v[72:75], v[200:203]
ds_read_b64_tr_b16 v[130:131], v1 offset:26976
v_mfma_f32_16x16x32_bf16 v[204:207], v[116:119], v[76:79], v[204:207]
ds_read_b64_tr_b16 v[132:133], v1 offset:25728
s_waitcnt lgkmcnt(5)
v_mfma_f32_16x16x32_bf16 v[208:211], v[120:123], v[72:75], v[208:211]
ds_read_b64_tr_b16 v[134:135], v1 offset:27008
v_mfma_f32_16x16x32_bf16 v[212:215], v[120:123], v[76:79], v[212:215]
ds_read_b64_tr_b16 v[136:137], v1 offset:25760
s_waitcnt lgkmcnt(5)
v_mfma_f32_16x16x32_bf16 v[216:219], v[72:75], v[124:127], v[216:219]
ds_read_b64_tr_b16 v[138:139], v1 offset:27040
v_mfma_f32_16x16x32_bf16 v[220:223], v[76:79], v[124:127], v[220:223]
ds_read_b64_tr_b16 v[140:141], v1 offset:25792
s_waitcnt lgkmcnt(5)
v_mfma_f32_16x16x32_bf16 v[224:227], v[72:75], v[128:131], v[224:227]
ds_read_b64_tr_b16 v[142:143], v1 offset:27072
v_mfma_f32_16x16x32_bf16 v[228:231], v[76:79], v[128:131], v[228:231]
s_barrier
ds_read_b128 v[80:83], v12 offset:0
ds_read_b128 v[84:87], v12 offset:2048
s_waitcnt lgkmcnt(6)
v_mfma_f32_16x16x32_bf16 v[232:235], v[72:75], v[132:135], v[232:235]
ds_read_b64_tr_b16 v[88:89], v1 offset:30784
v_mfma_f32_16x16x32_bf16 v[236:239], v[76:79], v[132:135], v[236:239]
ds_read_b64_tr_b16 v[90:91], v1 offset:32064
ds_read_b64_tr_b16 v[92:93], v1 offset:30816
s_waitcnt lgkmcnt(7)
v_mfma_f32_16x16x32_bf16 v[240:243], v[72:75], v[136:139], v[240:243]
ds_read_b64_tr_b16 v[94:95], v1 offset:32096
v_mfma_f32_16x16x32_bf16 v[244:247], v[76:79], v[136:139], v[244:247]
ds_read_b64_tr_b16 v[96:97], v1 offset:30848
s_waitcnt lgkmcnt(7)
v_mfma_f32_16x16x32_bf16 v[248:251], v[72:75], v[140:143], v[248:251]
ds_read_b64_tr_b16 v[98:99], v1 offset:32128
v_mfma_f32_16x16x32_bf16 v[252:255], v[76:79], v[140:143], v[252:255]
ds_read_b64_tr_b16 v[100:101], v1 offset:30880
s_waitcnt lgkmcnt(5)
v_mfma_f32_16x16x32_bf16 v[144:147], v[88:91], v[80:83], v[144:147]
ds_read_b64_tr_b16 v[102:103], v1 offset:32160
v_mfma_f32_16x16x32_bf16 v[148:151], v[88:91], v[84:87], v[148:151]
ds_read_b64_tr_b16 v[104:105], v2 offset:30784
s_waitcnt lgkmcnt(5)
v_mfma_f32_16x16x32_bf16 v[152:155], v[92:95], v[80:83], v[152:155]
ds_read_b64_tr_b16 v[106:107], v2 offset:32064
v_mfma_f32_16x16x32_bf16 v[156:159], v[92:95], v[84:87], v[156:159]
ds_read_b64_tr_b16 v[108:109], v1 offset:35920
s_waitcnt lgkmcnt(5)
v_mfma_f32_16x16x32_bf16 v[160:163], v[96:99], v[80:83], v[160:163]
ds_read_b64_tr_b16 v[110:111], v1 offset:37200
v_mfma_f32_16x16x32_bf16 v[164:167], v[96:99], v[84:87], v[164:167]
ds_read_b64_tr_b16 v[112:113], v1 offset:35952
s_waitcnt lgkmcnt(5)
v_mfma_f32_16x16x32_bf16 v[168:171], v[100:103], v[80:83], v[168:171]
ds_read_b64_tr_b16 v[114:115], v1 offset:37232
v_mfma_f32_16x16x32_bf16 v[172:175], v[100:103], v[84:87], v[172:175]
ds_read_b64_tr_b16 v[116:117], v1 offset:35984
s_waitcnt lgkmcnt(5)
v_mfma_f32_16x16x32_bf16 v[176:179], v[104:107], v[80:83], v[176:179]
ds_read_b64_tr_b16 v[118:119], v1 offset:37264
v_mfma_f32_16x16x32_bf16 v[180:183], v[104:107], v[84:87], v[180:183]
ds_read_b64_tr_b16 v[120:121], v1 offset:36016
s_waitcnt lgkmcnt(5)
v_mfma_f32_16x16x32_bf16 v[184:187], v[108:111], v[80:83], v[184:187]
ds_read_b64_tr_b16 v[122:123], v1 offset:37296
v_mfma_f32_16x16x32_bf16 v[188:191], v[108:111], v[84:87], v[188:191]
ds_read_b64_tr_b16 v[124:125], v1 offset:41056
s_waitcnt lgkmcnt(5)
v_mfma_f32_16x16x32_bf16 v[192:195], v[112:115], v[80:83], v[192:195]
ds_read_b64_tr_b16 v[126:127], v1 offset:42336
v_mfma_f32_16x16x32_bf16 v[196:199], v[112:115], v[84:87], v[196:199]
ds_read_b64_tr_b16 v[128:129], v1 offset:41088
s_waitcnt lgkmcnt(5)
v_mfma_f32_16x16x32_bf16 v[200:203], v[116:119], v[80:83], v[200:203]
ds_read_b64_tr_b16 v[130:131], v1 offset:42368
v_mfma_f32_16x16x32_bf16 v[204:207], v[116:119], v[84:87], v[204:207]
ds_read_b64_tr_b16 v[132:133], v1 offset:41120
s_waitcnt lgkmcnt(5)
v_mfma_f32_16x16x32_bf16 v[208:211], v[120:123], v[80:83], v[208:211]
ds_read_b64_tr_b16 v[134:135], v1 offset:42400
v_mfma_f32_16x16x32_bf16 v[212:215], v[120:123], v[84:87], v[212:215]
ds_read_b64_tr_b16 v[136:137], v1 offset:41152
s_waitcnt lgkmcnt(5)
v_mfma_f32_16x16x32_bf16 v[216:219], v[80:83], v[124:127], v[216:219]
ds_read_b64_tr_b16 v[138:139], v1 offset:42432
v_mfma_f32_16x16x32_bf16 v[220:223], v[84:87], v[124:127], v[220:223]
ds_read_b64_tr_b16 v[140:141], v1 offset:41184
s_waitcnt lgkmcnt(5)
v_mfma_f32_16x16x32_bf16 v[224:227], v[80:83], v[128:131], v[224:227]
ds_read_b64_tr_b16 v[142:143], v1 offset:42464
v_mfma_f32_16x16x32_bf16 v[228:231], v[84:87], v[128:131], v[228:231]
s_barrier
ds_read_b128 v[72:75], v11 offset:18432
ds_read_b128 v[76:79], v11 offset:20480
s_waitcnt lgkmcnt(6)
v_mfma_f32_16x16x32_bf16 v[232:235], v[80:83], v[132:135], v[232:235]
ds_read_b64_tr_b16 v[88:89], v1 offset:46176
v_mfma_f32_16x16x32_bf16 v[236:239], v[84:87], v[132:135], v[236:239]
ds_read_b64_tr_b16 v[90:91], v1 offset:47456
ds_read_b64_tr_b16 v[92:93], v1 offset:46208
s_waitcnt lgkmcnt(7)
v_mfma_f32_16x16x32_bf16 v[240:243], v[80:83], v[136:139], v[240:243]
ds_read_b64_tr_b16 v[94:95], v1 offset:47488
v_mfma_f32_16x16x32_bf16 v[244:247], v[84:87], v[136:139], v[244:247]
ds_read_b64_tr_b16 v[96:97], v1 offset:46240
s_waitcnt lgkmcnt(7)
v_mfma_f32_16x16x32_bf16 v[248:251], v[80:83], v[140:143], v[248:251]
ds_read_b64_tr_b16 v[98:99], v1 offset:47520
v_mfma_f32_16x16x32_bf16 v[252:255], v[84:87], v[140:143], v[252:255]
ds_read_b64_tr_b16 v[100:101], v1 offset:46272
s_waitcnt lgkmcnt(5)
v_mfma_f32_16x16x32_bf16 v[144:147], v[88:91], v[72:75], v[144:147]
ds_read_b64_tr_b16 v[102:103], v1 offset:47552
v_mfma_f32_16x16x32_bf16 v[148:151], v[88:91], v[76:79], v[148:151]
ds_read_b64_tr_b16 v[104:105], v2 offset:46176
s_waitcnt lgkmcnt(5)
v_mfma_f32_16x16x32_bf16 v[152:155], v[92:95], v[72:75], v[152:155]
ds_read_b64_tr_b16 v[106:107], v2 offset:47456
v_mfma_f32_16x16x32_bf16 v[156:159], v[92:95], v[76:79], v[156:159]
ds_read_b64_tr_b16 v[108:109], v1 offset:51312
s_waitcnt lgkmcnt(5)
v_mfma_f32_16x16x32_bf16 v[160:163], v[96:99], v[72:75], v[160:163]
ds_read_b64_tr_b16 v[110:111], v1 offset:52592
v_mfma_f32_16x16x32_bf16 v[164:167], v[96:99], v[76:79], v[164:167]
ds_read_b64_tr_b16 v[112:113], v1 offset:51344
s_waitcnt lgkmcnt(5)
v_mfma_f32_16x16x32_bf16 v[168:171], v[100:103], v[72:75], v[168:171]
ds_read_b64_tr_b16 v[114:115], v1 offset:52624
v_mfma_f32_16x16x32_bf16 v[172:175], v[100:103], v[76:79], v[172:175]
ds_read_b64_tr_b16 v[116:117], v1 offset:51376
s_waitcnt lgkmcnt(5)
v_mfma_f32_16x16x32_bf16 v[176:179], v[104:107], v[72:75], v[176:179]
ds_read_b64_tr_b16 v[118:119], v1 offset:52656
v_mfma_f32_16x16x32_bf16 v[180:183], v[104:107], v[76:79], v[180:183]
ds_read_b64_tr_b16 v[120:121], v1 offset:51408
s_waitcnt lgkmcnt(5)
v_mfma_f32_16x16x32_bf16 v[184:187], v[108:111], v[72:75], v[184:187]
ds_read_b64_tr_b16 v[122:123], v1 offset:52688
v_mfma_f32_16x16x32_bf16 v[188:191], v[108:111], v[76:79], v[188:191]
ds_read_b64_tr_b16 v[124:125], v1 offset:56448
s_waitcnt lgkmcnt(5)
v_mfma_f32_16x16x32_bf16 v[192:195], v[112:115], v[72:75], v[192:195]
ds_read_b64_tr_b16 v[126:127], v1 offset:57728
v_mfma_f32_16x16x32_bf16 v[196:199], v[112:115], v[76:79], v[196:199]
ds_read_b64_tr_b16 v[128:129], v1 offset:56480
s_waitcnt lgkmcnt(5)
v_mfma_f32_16x16x32_bf16 v[200:203], v[116:119], v[72:75], v[200:203]
ds_read_b64_tr_b16 v[130:131], v1 offset:57760
v_mfma_f32_16x16x32_bf16 v[204:207], v[116:119], v[76:79], v[204:207]
ds_read_b64_tr_b16 v[132:133], v1 offset:56512
s_waitcnt lgkmcnt(5)
v_mfma_f32_16x16x32_bf16 v[208:211], v[120:123], v[72:75], v[208:211]
ds_read_b64_tr_b16 v[134:135], v1 offset:57792
v_mfma_f32_16x16x32_bf16 v[212:215], v[120:123], v[76:79], v[212:215]
ds_read_b64_tr_b16 v[136:137], v1 offset:56544
s_waitcnt lgkmcnt(5)
v_mfma_f32_16x16x32_bf16 v[216:219], v[72:75], v[124:127], v[216:219]
ds_read_b64_tr_b16 v[138:139], v1 offset:57824
v_mfma_f32_16x16x32_bf16 v[220:223], v[76:79], v[124:127], v[220:223]
ds_read_b64_tr_b16 v[140:141], v1 offset:56576
s_waitcnt lgkmcnt(5)
v_mfma_f32_16x16x32_bf16 v[224:227], v[72:75], v[128:131], v[224:227]
ds_read_b64_tr_b16 v[142:143], v1 offset:57856
v_mfma_f32_16x16x32_bf16 v[228:231], v[76:79], v[128:131], v[228:231]
s_barrier
ds_read_b128 v[80:83], v12 offset:18432
ds_read_b128 v[84:87], v12 offset:20480
s_waitcnt lgkmcnt(6)
v_mfma_f32_16x16x32_bf16 v[232:235], v[72:75], v[132:135], v[232:235]
ds_read_b64_tr_b16 v[88:89], v3 offset:0
v_mfma_f32_16x16x32_bf16 v[236:239], v[76:79], v[132:135], v[236:239]
ds_read_b64_tr_b16 v[90:91], v3 offset:1280
ds_read_b64_tr_b16 v[92:93], v3 offset:32
s_waitcnt lgkmcnt(7)
v_mfma_f32_16x16x32_bf16 v[240:243], v[72:75], v[136:139], v[240:243]
ds_read_b64_tr_b16 v[94:95], v3 offset:1312
v_mfma_f32_16x16x32_bf16 v[244:247], v[76:79], v[136:139], v[244:247]
ds_read_b64_tr_b16 v[96:97], v3 offset:64
s_waitcnt lgkmcnt(7)
v_mfma_f32_16x16x32_bf16 v[248:251], v[72:75], v[140:143], v[248:251]
ds_read_b64_tr_b16 v[98:99], v3 offset:1344
v_mfma_f32_16x16x32_bf16 v[252:255], v[76:79], v[140:143], v[252:255]
ds_read_b64_tr_b16 v[100:101], v3 offset:96
s_waitcnt lgkmcnt(5)
v_mfma_f32_16x16x32_bf16 v[144:147], v[88:91], v[80:83], v[144:147]
ds_read_b64_tr_b16 v[102:103], v3 offset:1376
v_mfma_f32_16x16x32_bf16 v[148:151], v[88:91], v[84:87], v[148:151]
ds_read_b64_tr_b16 v[104:105], v4 offset:0
s_waitcnt lgkmcnt(5)
v_mfma_f32_16x16x32_bf16 v[152:155], v[92:95], v[80:83], v[152:155]
ds_read_b64_tr_b16 v[106:107], v4 offset:1280
v_mfma_f32_16x16x32_bf16 v[156:159], v[92:95], v[84:87], v[156:159]
ds_read_b64_tr_b16 v[108:109], v3 offset:5136
s_waitcnt lgkmcnt(5)
v_mfma_f32_16x16x32_bf16 v[160:163], v[96:99], v[80:83], v[160:163]
ds_read_b64_tr_b16 v[110:111], v3 offset:6416
v_mfma_f32_16x16x32_bf16 v[164:167], v[96:99], v[84:87], v[164:167]
ds_read_b64_tr_b16 v[112:113], v3 offset:5168
s_waitcnt lgkmcnt(5)
v_mfma_f32_16x16x32_bf16 v[168:171], v[100:103], v[80:83], v[168:171]
ds_read_b64_tr_b16 v[114:115], v3 offset:6448
v_mfma_f32_16x16x32_bf16 v[172:175], v[100:103], v[84:87], v[172:175]
ds_read_b64_tr_b16 v[116:117], v3 offset:5200
s_waitcnt lgkmcnt(5)
v_mfma_f32_16x16x32_bf16 v[176:179], v[104:107], v[80:83], v[176:179]
ds_read_b64_tr_b16 v[118:119], v3 offset:6480
v_mfma_f32_16x16x32_bf16 v[180:183], v[104:107], v[84:87], v[180:183]
ds_read_b64_tr_b16 v[120:121], v3 offset:5232
s_waitcnt lgkmcnt(5)
v_mfma_f32_16x16x32_bf16 v[184:187], v[108:111], v[80:83], v[184:187]
ds_read_b64_tr_b16 v[122:123], v3 offset:6512
v_mfma_f32_16x16x32_bf16 v[188:191], v[108:111], v[84:87], v[188:191]
ds_read_b64_tr_b16 v[124:125], v3 offset:10272
s_waitcnt lgkmcnt(5)
v_mfma_f32_16x16x32_bf16 v[192:195], v[112:115], v[80:83], v[192:195]
ds_read_b64_tr_b16 v[126:127], v3 offset:11552
v_mfma_f32_16x16x32_bf16 v[196:199], v[112:115], v[84:87], v[196:199]
ds_read_b64_tr_b16 v[128:129], v3 offset:10304
s_waitcnt lgkmcnt(5)
v_mfma_f32_16x16x32_bf16 v[200:203], v[116:119], v[80:83], v[200:203]
ds_read_b64_tr_b16 v[130:131], v3 offset:11584
v_mfma_f32_16x16x32_bf16 v[204:207], v[116:119], v[84:87], v[204:207]
ds_read_b64_tr_b16 v[132:133], v3 offset:10336
s_waitcnt lgkmcnt(5)
v_mfma_f32_16x16x32_bf16 v[208:211], v[120:123], v[80:83], v[208:211]
ds_read_b64_tr_b16 v[134:135], v3 offset:11616
v_mfma_f32_16x16x32_bf16 v[212:215], v[120:123], v[84:87], v[212:215]
ds_read_b64_tr_b16 v[136:137], v3 offset:10368
s_waitcnt lgkmcnt(5)
v_mfma_f32_16x16x32_bf16 v[216:219], v[80:83], v[124:127], v[216:219]
ds_read_b64_tr_b16 v[138:139], v3 offset:11648
v_mfma_f32_16x16x32_bf16 v[220:223], v[84:87], v[124:127], v[220:223]
ds_read_b64_tr_b16 v[140:141], v3 offset:10400
s_waitcnt lgkmcnt(5)
v_mfma_f32_16x16x32_bf16 v[224:227], v[80:83], v[128:131], v[224:227]
ds_read_b64_tr_b16 v[142:143], v3 offset:11680
v_mfma_f32_16x16x32_bf16 v[228:231], v[84:87], v[128:131], v[228:231]
s_barrier
ds_read_b128 v[72:75], v11 offset:36864
ds_read_b128 v[76:79], v11 offset:38912
s_waitcnt lgkmcnt(6)
v_mfma_f32_16x16x32_bf16 v[232:235], v[80:83], v[132:135], v[232:235]
ds_read_b64_tr_b16 v[88:89], v1 offset:0
v_mfma_f32_16x16x32_bf16 v[236:239], v[84:87], v[132:135], v[236:239]
ds_read_b64_tr_b16 v[90:91], v1 offset:1280
ds_read_b64_tr_b16 v[92:93], v1 offset:32
s_waitcnt lgkmcnt(7)
v_mfma_f32_16x16x32_bf16 v[240:243], v[80:83], v[136:139], v[240:243]
ds_read_b64_tr_b16 v[94:95], v1 offset:1312
v_mfma_f32_16x16x32_bf16 v[244:247], v[84:87], v[136:139], v[244:247]
ds_read_b64_tr_b16 v[96:97], v1 offset:64
s_waitcnt lgkmcnt(7)
v_mfma_f32_16x16x32_bf16 v[248:251], v[80:83], v[140:143], v[248:251]
ds_read_b64_tr_b16 v[98:99], v1 offset:1344
v_mfma_f32_16x16x32_bf16 v[252:255], v[84:87], v[140:143], v[252:255]
ds_read_b64_tr_b16 v[100:101], v1 offset:96
s_waitcnt lgkmcnt(5)
v_mfma_f32_16x16x32_bf16 v[144:147], v[88:91], v[72:75], v[144:147]
ds_read_b64_tr_b16 v[102:103], v1 offset:1376
v_mfma_f32_16x16x32_bf16 v[148:151], v[88:91], v[76:79], v[148:151]
ds_read_b64_tr_b16 v[104:105], v2 offset:0
s_waitcnt lgkmcnt(5)
v_mfma_f32_16x16x32_bf16 v[152:155], v[92:95], v[72:75], v[152:155]
ds_read_b64_tr_b16 v[106:107], v2 offset:1280
v_mfma_f32_16x16x32_bf16 v[156:159], v[92:95], v[76:79], v[156:159]
ds_read_b64_tr_b16 v[108:109], v1 offset:5136
s_waitcnt lgkmcnt(5)
v_mfma_f32_16x16x32_bf16 v[160:163], v[96:99], v[72:75], v[160:163]
ds_read_b64_tr_b16 v[110:111], v1 offset:6416
v_mfma_f32_16x16x32_bf16 v[164:167], v[96:99], v[76:79], v[164:167]
ds_read_b64_tr_b16 v[112:113], v1 offset:5168
s_waitcnt lgkmcnt(5)
v_mfma_f32_16x16x32_bf16 v[168:171], v[100:103], v[72:75], v[168:171]
ds_read_b64_tr_b16 v[114:115], v1 offset:6448
v_mfma_f32_16x16x32_bf16 v[172:175], v[100:103], v[76:79], v[172:175]
ds_read_b64_tr_b16 v[116:117], v1 offset:5200
s_waitcnt lgkmcnt(5)
v_mfma_f32_16x16x32_bf16 v[176:179], v[104:107], v[72:75], v[176:179]
ds_read_b64_tr_b16 v[118:119], v1 offset:6480
v_mfma_f32_16x16x32_bf16 v[180:183], v[104:107], v[76:79], v[180:183]
ds_read_b64_tr_b16 v[120:121], v1 offset:5232
s_waitcnt lgkmcnt(5)
v_mfma_f32_16x16x32_bf16 v[184:187], v[108:111], v[72:75], v[184:187]
ds_read_b64_tr_b16 v[122:123], v1 offset:6512
v_mfma_f32_16x16x32_bf16 v[188:191], v[108:111], v[76:79], v[188:191]
ds_read_b64_tr_b16 v[124:125], v1 offset:10272
s_waitcnt lgkmcnt(5)
v_mfma_f32_16x16x32_bf16 v[192:195], v[112:115], v[72:75], v[192:195]
ds_read_b64_tr_b16 v[126:127], v1 offset:11552
v_mfma_f32_16x16x32_bf16 v[196:199], v[112:115], v[76:79], v[196:199]
ds_read_b64_tr_b16 v[128:129], v1 offset:10304
s_waitcnt lgkmcnt(5)
v_mfma_f32_16x16x32_bf16 v[200:203], v[116:119], v[72:75], v[200:203]
ds_read_b64_tr_b16 v[130:131], v1 offset:11584
v_mfma_f32_16x16x32_bf16 v[204:207], v[116:119], v[76:79], v[204:207]
ds_read_b64_tr_b16 v[132:133], v1 offset:10336
s_waitcnt lgkmcnt(5)
v_mfma_f32_16x16x32_bf16 v[208:211], v[120:123], v[72:75], v[208:211]
ds_read_b64_tr_b16 v[134:135], v1 offset:11616
v_mfma_f32_16x16x32_bf16 v[212:215], v[120:123], v[76:79], v[212:215]
ds_read_b64_tr_b16 v[136:137], v1 offset:10368
s_waitcnt lgkmcnt(5)
v_mfma_f32_16x16x32_bf16 v[216:219], v[72:75], v[124:127], v[216:219]
ds_read_b64_tr_b16 v[138:139], v1 offset:11648
v_mfma_f32_16x16x32_bf16 v[220:223], v[76:79], v[124:127], v[220:223]
ds_read_b64_tr_b16 v[140:141], v1 offset:10400
s_waitcnt lgkmcnt(5)
v_mfma_f32_16x16x32_bf16 v[224:227], v[72:75], v[128:131], v[224:227]
ds_read_b64_tr_b16 v[142:143], v1 offset:11680
v_mfma_f32_16x16x32_bf16 v[228:231], v[76:79], v[128:131], v[228:231]
s_barrier
ds_read_b128 v[80:83], v12 offset:36864
ds_read_b128 v[84:87], v12 offset:38912
s_waitcnt lgkmcnt(6)
v_mfma_f32_16x16x32_bf16 v[232:235], v[72:75], v[132:135], v[232:235]
ds_read_b64_tr_b16 v[88:89], v1 offset:15392
v_mfma_f32_16x16x32_bf16 v[236:239], v[76:79], v[132:135], v[236:239]
ds_read_b64_tr_b16 v[90:91], v1 offset:16672
ds_read_b64_tr_b16 v[92:93], v1 offset:15424
s_waitcnt lgkmcnt(7)
v_mfma_f32_16x16x32_bf16 v[240:243], v[72:75], v[136:139], v[240:243]
ds_read_b64_tr_b16 v[94:95], v1 offset:16704
v_mfma_f32_16x16x32_bf16 v[244:247], v[76:79], v[136:139], v[244:247]
ds_read_b64_tr_b16 v[96:97], v1 offset:15456
s_waitcnt lgkmcnt(7)
v_mfma_f32_16x16x32_bf16 v[248:251], v[72:75], v[140:143], v[248:251]
ds_read_b64_tr_b16 v[98:99], v1 offset:16736
v_mfma_f32_16x16x32_bf16 v[252:255], v[76:79], v[140:143], v[252:255]
ds_read_b64_tr_b16 v[100:101], v1 offset:15488
s_waitcnt lgkmcnt(5)
v_mfma_f32_16x16x32_bf16 v[144:147], v[88:91], v[80:83], v[144:147]
ds_read_b64_tr_b16 v[102:103], v1 offset:16768
v_mfma_f32_16x16x32_bf16 v[148:151], v[88:91], v[84:87], v[148:151]
ds_read_b64_tr_b16 v[104:105], v2 offset:15392
s_waitcnt lgkmcnt(5)
v_mfma_f32_16x16x32_bf16 v[152:155], v[92:95], v[80:83], v[152:155]
ds_read_b64_tr_b16 v[106:107], v2 offset:16672
v_mfma_f32_16x16x32_bf16 v[156:159], v[92:95], v[84:87], v[156:159]
ds_read_b64_tr_b16 v[108:109], v1 offset:20528
s_waitcnt lgkmcnt(5)
v_mfma_f32_16x16x32_bf16 v[160:163], v[96:99], v[80:83], v[160:163]
ds_read_b64_tr_b16 v[110:111], v1 offset:21808
v_mfma_f32_16x16x32_bf16 v[164:167], v[96:99], v[84:87], v[164:167]
ds_read_b64_tr_b16 v[112:113], v1 offset:20560
s_waitcnt lgkmcnt(5)
v_mfma_f32_16x16x32_bf16 v[168:171], v[100:103], v[80:83], v[168:171]
ds_read_b64_tr_b16 v[114:115], v1 offset:21840
v_mfma_f32_16x16x32_bf16 v[172:175], v[100:103], v[84:87], v[172:175]
ds_read_b64_tr_b16 v[116:117], v1 offset:20592
s_waitcnt lgkmcnt(5)
v_mfma_f32_16x16x32_bf16 v[176:179], v[104:107], v[80:83], v[176:179]
ds_read_b64_tr_b16 v[118:119], v1 offset:21872
v_mfma_f32_16x16x32_bf16 v[180:183], v[104:107], v[84:87], v[180:183]
ds_read_b64_tr_b16 v[120:121], v1 offset:20624
s_waitcnt lgkmcnt(5)
v_mfma_f32_16x16x32_bf16 v[184:187], v[108:111], v[80:83], v[184:187]
ds_read_b64_tr_b16 v[122:123], v1 offset:21904
v_mfma_f32_16x16x32_bf16 v[188:191], v[108:111], v[84:87], v[188:191]
ds_read_b64_tr_b16 v[124:125], v1 offset:25664
s_waitcnt lgkmcnt(5)
v_mfma_f32_16x16x32_bf16 v[192:195], v[112:115], v[80:83], v[192:195]
ds_read_b64_tr_b16 v[126:127], v1 offset:26944
v_mfma_f32_16x16x32_bf16 v[196:199], v[112:115], v[84:87], v[196:199]
ds_read_b64_tr_b16 v[128:129], v1 offset:25696
s_waitcnt lgkmcnt(5)
v_mfma_f32_16x16x32_bf16 v[200:203], v[116:119], v[80:83], v[200:203]
ds_read_b64_tr_b16 v[130:131], v1 offset:26976
v_mfma_f32_16x16x32_bf16 v[204:207], v[116:119], v[84:87], v[204:207]
ds_read_b64_tr_b16 v[132:133], v1 offset:25728
s_waitcnt lgkmcnt(5)
v_mfma_f32_16x16x32_bf16 v[208:211], v[120:123], v[80:83], v[208:211]
ds_read_b64_tr_b16 v[134:135], v1 offset:27008
v_mfma_f32_16x16x32_bf16 v[212:215], v[120:123], v[84:87], v[212:215]
ds_read_b64_tr_b16 v[136:137], v1 offset:25760
s_waitcnt lgkmcnt(5)
v_mfma_f32_16x16x32_bf16 v[216:219], v[80:83], v[124:127], v[216:219]
ds_read_b64_tr_b16 v[138:139], v1 offset:27040
v_mfma_f32_16x16x32_bf16 v[220:223], v[84:87], v[124:127], v[220:223]
ds_read_b64_tr_b16 v[140:141], v1 offset:25792
s_waitcnt lgkmcnt(5)
v_mfma_f32_16x16x32_bf16 v[224:227], v[80:83], v[128:131], v[224:227]
ds_read_b64_tr_b16 v[142:143], v1 offset:27072
v_mfma_f32_16x16x32_bf16 v[228:231], v[84:87], v[128:131], v[228:231]
s_barrier
ds_read_b128 v[72:75], v11 offset:0
ds_read_b128 v[76:79], v11 offset:2048
s_waitcnt lgkmcnt(6)
v_mfma_f32_16x16x32_bf16 v[232:235], v[80:83], v[132:135], v[232:235]
ds_read_b64_tr_b16 v[88:89], v1 offset:30784
v_mfma_f32_16x16x32_bf16 v[236:239], v[84:87], v[132:135], v[236:239]
ds_read_b64_tr_b16 v[90:91], v1 offset:32064
ds_read_b64_tr_b16 v[92:93], v1 offset:30816
s_waitcnt lgkmcnt(7)
v_mfma_f32_16x16x32_bf16 v[240:243], v[80:83], v[136:139], v[240:243]
ds_read_b64_tr_b16 v[94:95], v1 offset:32096
v_mfma_f32_16x16x32_bf16 v[244:247], v[84:87], v[136:139], v[244:247]
ds_read_b64_tr_b16 v[96:97], v1 offset:30848
s_waitcnt lgkmcnt(7)
v_mfma_f32_16x16x32_bf16 v[248:251], v[80:83], v[140:143], v[248:251]
ds_read_b64_tr_b16 v[98:99], v1 offset:32128
v_mfma_f32_16x16x32_bf16 v[252:255], v[84:87], v[140:143], v[252:255]
ds_read_b64_tr_b16 v[100:101], v1 offset:30880
s_waitcnt lgkmcnt(5)
v_mfma_f32_16x16x32_bf16 v[144:147], v[88:91], v[72:75], v[144:147]
ds_read_b64_tr_b16 v[102:103], v1 offset:32160
v_mfma_f32_16x16x32_bf16 v[148:151], v[88:91], v[76:79], v[148:151]
ds_read_b64_tr_b16 v[104:105], v2 offset:30784
s_waitcnt lgkmcnt(5)
v_mfma_f32_16x16x32_bf16 v[152:155], v[92:95], v[72:75], v[152:155]
ds_read_b64_tr_b16 v[106:107], v2 offset:32064
v_mfma_f32_16x16x32_bf16 v[156:159], v[92:95], v[76:79], v[156:159]
ds_read_b64_tr_b16 v[108:109], v1 offset:35920
s_waitcnt lgkmcnt(5)
v_mfma_f32_16x16x32_bf16 v[160:163], v[96:99], v[72:75], v[160:163]
ds_read_b64_tr_b16 v[110:111], v1 offset:37200
v_mfma_f32_16x16x32_bf16 v[164:167], v[96:99], v[76:79], v[164:167]
ds_read_b64_tr_b16 v[112:113], v1 offset:35952
s_waitcnt lgkmcnt(5)
v_mfma_f32_16x16x32_bf16 v[168:171], v[100:103], v[72:75], v[168:171]
ds_read_b64_tr_b16 v[114:115], v1 offset:37232
v_mfma_f32_16x16x32_bf16 v[172:175], v[100:103], v[76:79], v[172:175]
ds_read_b64_tr_b16 v[116:117], v1 offset:35984
s_waitcnt lgkmcnt(5)
v_mfma_f32_16x16x32_bf16 v[176:179], v[104:107], v[72:75], v[176:179]
ds_read_b64_tr_b16 v[118:119], v1 offset:37264
v_mfma_f32_16x16x32_bf16 v[180:183], v[104:107], v[76:79], v[180:183]
ds_read_b64_tr_b16 v[120:121], v1 offset:36016
s_waitcnt lgkmcnt(5)
v_mfma_f32_16x16x32_bf16 v[184:187], v[108:111], v[72:75], v[184:187]
ds_read_b64_tr_b16 v[122:123], v1 offset:37296
v_mfma_f32_16x16x32_bf16 v[188:191], v[108:111], v[76:79], v[188:191]
ds_read_b64_tr_b16 v[124:125], v1 offset:41056
s_waitcnt lgkmcnt(5)
v_mfma_f32_16x16x32_bf16 v[192:195], v[112:115], v[72:75], v[192:195]
ds_read_b64_tr_b16 v[126:127], v1 offset:42336
v_mfma_f32_16x16x32_bf16 v[196:199], v[112:115], v[76:79], v[196:199]
ds_read_b64_tr_b16 v[128:129], v1 offset:41088
s_waitcnt lgkmcnt(5)
v_mfma_f32_16x16x32_bf16 v[200:203], v[116:119], v[72:75], v[200:203]
ds_read_b64_tr_b16 v[130:131], v1 offset:42368
v_mfma_f32_16x16x32_bf16 v[204:207], v[116:119], v[76:79], v[204:207]
ds_read_b64_tr_b16 v[132:133], v1 offset:41120
s_waitcnt lgkmcnt(5)
v_mfma_f32_16x16x32_bf16 v[208:211], v[120:123], v[72:75], v[208:211]
ds_read_b64_tr_b16 v[134:135], v1 offset:42400
v_mfma_f32_16x16x32_bf16 v[212:215], v[120:123], v[76:79], v[212:215]
ds_read_b64_tr_b16 v[136:137], v1 offset:41152
s_waitcnt lgkmcnt(5)
v_mfma_f32_16x16x32_bf16 v[216:219], v[72:75], v[124:127], v[216:219]
ds_read_b64_tr_b16 v[138:139], v1 offset:42432
v_mfma_f32_16x16x32_bf16 v[220:223], v[76:79], v[124:127], v[220:223]
ds_read_b64_tr_b16 v[140:141], v1 offset:41184
s_waitcnt lgkmcnt(5)
v_mfma_f32_16x16x32_bf16 v[224:227], v[72:75], v[128:131], v[224:227]
ds_read_b64_tr_b16 v[142:143], v1 offset:42464
v_mfma_f32_16x16x32_bf16 v[228:231], v[76:79], v[128:131], v[228:231]
s_barrier
ds_read_b128 v[80:83], v12 offset:0
ds_read_b128 v[84:87], v12 offset:2048
s_waitcnt lgkmcnt(6)
v_mfma_f32_16x16x32_bf16 v[232:235], v[72:75], v[132:135], v[232:235]
ds_read_b64_tr_b16 v[88:89], v1 offset:46176
v_mfma_f32_16x16x32_bf16 v[236:239], v[76:79], v[132:135], v[236:239]
ds_read_b64_tr_b16 v[90:91], v1 offset:47456
ds_read_b64_tr_b16 v[92:93], v1 offset:46208
s_waitcnt lgkmcnt(7)
v_mfma_f32_16x16x32_bf16 v[240:243], v[72:75], v[136:139], v[240:243]
ds_read_b64_tr_b16 v[94:95], v1 offset:47488
v_mfma_f32_16x16x32_bf16 v[244:247], v[76:79], v[136:139], v[244:247]
ds_read_b64_tr_b16 v[96:97], v1 offset:46240
s_waitcnt lgkmcnt(7)
v_mfma_f32_16x16x32_bf16 v[248:251], v[72:75], v[140:143], v[248:251]
ds_read_b64_tr_b16 v[98:99], v1 offset:47520
v_mfma_f32_16x16x32_bf16 v[252:255], v[76:79], v[140:143], v[252:255]
ds_read_b64_tr_b16 v[100:101], v1 offset:46272
s_waitcnt lgkmcnt(5)
v_mfma_f32_16x16x32_bf16 v[144:147], v[88:91], v[80:83], v[144:147]
ds_read_b64_tr_b16 v[102:103], v1 offset:47552
v_mfma_f32_16x16x32_bf16 v[148:151], v[88:91], v[84:87], v[148:151]
ds_read_b64_tr_b16 v[104:105], v2 offset:46176
s_waitcnt lgkmcnt(5)
v_mfma_f32_16x16x32_bf16 v[152:155], v[92:95], v[80:83], v[152:155]
ds_read_b64_tr_b16 v[106:107], v2 offset:47456
v_mfma_f32_16x16x32_bf16 v[156:159], v[92:95], v[84:87], v[156:159]
ds_read_b64_tr_b16 v[108:109], v1 offset:51312
s_waitcnt lgkmcnt(5)
v_mfma_f32_16x16x32_bf16 v[160:163], v[96:99], v[80:83], v[160:163]
ds_read_b64_tr_b16 v[110:111], v1 offset:52592
v_mfma_f32_16x16x32_bf16 v[164:167], v[96:99], v[84:87], v[164:167]
ds_read_b64_tr_b16 v[112:113], v1 offset:51344
s_waitcnt lgkmcnt(5)
v_mfma_f32_16x16x32_bf16 v[168:171], v[100:103], v[80:83], v[168:171]
ds_read_b64_tr_b16 v[114:115], v1 offset:52624
v_mfma_f32_16x16x32_bf16 v[172:175], v[100:103], v[84:87], v[172:175]
ds_read_b64_tr_b16 v[116:117], v1 offset:51376
s_waitcnt lgkmcnt(5)
v_mfma_f32_16x16x32_bf16 v[176:179], v[104:107], v[80:83], v[176:179]
ds_read_b64_tr_b16 v[118:119], v1 offset:52656
v_mfma_f32_16x16x32_bf16 v[180:183], v[104:107], v[84:87], v[180:183]
ds_read_b64_tr_b16 v[120:121], v1 offset:51408
s_waitcnt lgkmcnt(5)
v_mfma_f32_16x16x32_bf16 v[184:187], v[108:111], v[80:83], v[184:187]
ds_read_b64_tr_b16 v[122:123], v1 offset:52688
v_mfma_f32_16x16x32_bf16 v[188:191], v[108:111], v[84:87], v[188:191]
ds_read_b64_tr_b16 v[124:125], v1 offset:56448
s_waitcnt lgkmcnt(5)
v_mfma_f32_16x16x32_bf16 v[192:195], v[112:115], v[80:83], v[192:195]
ds_read_b64_tr_b16 v[126:127], v1 offset:57728
v_mfma_f32_16x16x32_bf16 v[196:199], v[112:115], v[84:87], v[196:199]
ds_read_b64_tr_b16 v[128:129], v1 offset:56480
s_waitcnt lgkmcnt(5)
v_mfma_f32_16x16x32_bf16 v[200:203], v[116:119], v[80:83], v[200:203]
ds_read_b64_tr_b16 v[130:131], v1 offset:57760
v_mfma_f32_16x16x32_bf16 v[204:207], v[116:119], v[84:87], v[204:207]
ds_read_b64_tr_b16 v[132:133], v1 offset:56512
s_waitcnt lgkmcnt(5)
v_mfma_f32_16x16x32_bf16 v[208:211], v[120:123], v[80:83], v[208:211]
ds_read_b64_tr_b16 v[134:135], v1 offset:57792
v_mfma_f32_16x16x32_bf16 v[212:215], v[120:123], v[84:87], v[212:215]
ds_read_b64_tr_b16 v[136:137], v1 offset:56544
s_waitcnt lgkmcnt(5)
v_mfma_f32_16x16x32_bf16 v[216:219], v[80:83], v[124:127], v[216:219]
ds_read_b64_tr_b16 v[138:139], v1 offset:57824
v_mfma_f32_16x16x32_bf16 v[220:223], v[84:87], v[124:127], v[220:223]
ds_read_b64_tr_b16 v[140:141], v1 offset:56576
s_waitcnt lgkmcnt(5)
v_mfma_f32_16x16x32_bf16 v[224:227], v[80:83], v[128:131], v[224:227]
ds_read_b64_tr_b16 v[142:143], v1 offset:57856
v_mfma_f32_16x16x32_bf16 v[228:231], v[84:87], v[128:131], v[228:231]
s_barrier
ds_read_b128 v[72:75], v11 offset:18432
ds_read_b128 v[76:79], v11 offset:20480
s_waitcnt lgkmcnt(6)
v_mfma_f32_16x16x32_bf16 v[232:235], v[80:83], v[132:135], v[232:235]
ds_read_b64_tr_b16 v[88:89], v3 offset:0
v_mfma_f32_16x16x32_bf16 v[236:239], v[84:87], v[132:135], v[236:239]
ds_read_b64_tr_b16 v[90:91], v3 offset:1280
ds_read_b64_tr_b16 v[92:93], v3 offset:32
s_waitcnt lgkmcnt(7)
v_mfma_f32_16x16x32_bf16 v[240:243], v[80:83], v[136:139], v[240:243]
ds_read_b64_tr_b16 v[94:95], v3 offset:1312
v_mfma_f32_16x16x32_bf16 v[244:247], v[84:87], v[136:139], v[244:247]
ds_read_b64_tr_b16 v[96:97], v3 offset:64
s_waitcnt lgkmcnt(7)
v_mfma_f32_16x16x32_bf16 v[248:251], v[80:83], v[140:143], v[248:251]
ds_read_b64_tr_b16 v[98:99], v3 offset:1344
v_mfma_f32_16x16x32_bf16 v[252:255], v[84:87], v[140:143], v[252:255]
ds_read_b64_tr_b16 v[100:101], v3 offset:96
s_waitcnt lgkmcnt(5)
v_mfma_f32_16x16x32_bf16 v[144:147], v[88:91], v[72:75], v[144:147]
ds_read_b64_tr_b16 v[102:103], v3 offset:1376
v_mfma_f32_16x16x32_bf16 v[148:151], v[88:91], v[76:79], v[148:151]
ds_read_b64_tr_b16 v[104:105], v4 offset:0
s_waitcnt lgkmcnt(5)
v_mfma_f32_16x16x32_bf16 v[152:155], v[92:95], v[72:75], v[152:155]
ds_read_b64_tr_b16 v[106:107], v4 offset:1280
v_mfma_f32_16x16x32_bf16 v[156:159], v[92:95], v[76:79], v[156:159]
ds_read_b64_tr_b16 v[108:109], v3 offset:5136
s_waitcnt lgkmcnt(5)
v_mfma_f32_16x16x32_bf16 v[160:163], v[96:99], v[72:75], v[160:163]
ds_read_b64_tr_b16 v[110:111], v3 offset:6416
v_mfma_f32_16x16x32_bf16 v[164:167], v[96:99], v[76:79], v[164:167]
ds_read_b64_tr_b16 v[112:113], v3 offset:5168
s_waitcnt lgkmcnt(5)
v_mfma_f32_16x16x32_bf16 v[168:171], v[100:103], v[72:75], v[168:171]
ds_read_b64_tr_b16 v[114:115], v3 offset:6448
v_mfma_f32_16x16x32_bf16 v[172:175], v[100:103], v[76:79], v[172:175]
ds_read_b64_tr_b16 v[116:117], v3 offset:5200
s_waitcnt lgkmcnt(5)
v_mfma_f32_16x16x32_bf16 v[176:179], v[104:107], v[72:75], v[176:179]
ds_read_b64_tr_b16 v[118:119], v3 offset:6480
v_mfma_f32_16x16x32_bf16 v[180:183], v[104:107], v[76:79], v[180:183]
ds_read_b64_tr_b16 v[120:121], v3 offset:5232
s_waitcnt lgkmcnt(5)
v_mfma_f32_16x16x32_bf16 v[184:187], v[108:111], v[72:75], v[184:187]
ds_read_b64_tr_b16 v[122:123], v3 offset:6512
v_mfma_f32_16x16x32_bf16 v[188:191], v[108:111], v[76:79], v[188:191]
ds_read_b64_tr_b16 v[124:125], v3 offset:10272
s_waitcnt lgkmcnt(5)
v_mfma_f32_16x16x32_bf16 v[192:195], v[112:115], v[72:75], v[192:195]
ds_read_b64_tr_b16 v[126:127], v3 offset:11552
v_mfma_f32_16x16x32_bf16 v[196:199], v[112:115], v[76:79], v[196:199]
ds_read_b64_tr_b16 v[128:129], v3 offset:10304
s_waitcnt lgkmcnt(5)
v_mfma_f32_16x16x32_bf16 v[200:203], v[116:119], v[72:75], v[200:203]
ds_read_b64_tr_b16 v[130:131], v3 offset:11584
v_mfma_f32_16x16x32_bf16 v[204:207], v[116:119], v[76:79], v[204:207]
ds_read_b64_tr_b16 v[132:133], v3 offset:10336
s_waitcnt lgkmcnt(5)
v_mfma_f32_16x16x32_bf16 v[208:211], v[120:123], v[72:75], v[208:211]
ds_read_b64_tr_b16 v[134:135], v3 offset:11616
v_mfma_f32_16x16x32_bf16 v[212:215], v[120:123], v[76:79], v[212:215]
ds_read_b64_tr_b16 v[136:137], v3 offset:10368
s_waitcnt lgkmcnt(5)
v_mfma_f32_16x16x32_bf16 v[216:219], v[72:75], v[124:127], v[216:219]
ds_read_b64_tr_b16 v[138:139], v3 offset:11648
v_mfma_f32_16x16x32_bf16 v[220:223], v[76:79], v[124:127], v[220:223]
ds_read_b64_tr_b16 v[140:141], v3 offset:10400
s_waitcnt lgkmcnt(5)
v_mfma_f32_16x16x32_bf16 v[224:227], v[72:75], v[128:131], v[224:227]
ds_read_b64_tr_b16 v[142:143], v3 offset:11680
v_mfma_f32_16x16x32_bf16 v[228:231], v[76:79], v[128:131], v[228:231]
s_barrier
ds_read_b128 v[80:83], v12 offset:18432
ds_read_b128 v[84:87], v12 offset:20480
s_waitcnt lgkmcnt(6)
v_mfma_f32_16x16x32_bf16 v[232:235], v[72:75], v[132:135], v[232:235]
ds_read_b64_tr_b16 v[88:89], v1 offset:0
v_mfma_f32_16x16x32_bf16 v[236:239], v[76:79], v[132:135], v[236:239]
ds_read_b64_tr_b16 v[90:91], v1 offset:1280
ds_read_b64_tr_b16 v[92:93], v1 offset:32
s_waitcnt lgkmcnt(7)
v_mfma_f32_16x16x32_bf16 v[240:243], v[72:75], v[136:139], v[240:243]
ds_read_b64_tr_b16 v[94:95], v1 offset:1312
v_mfma_f32_16x16x32_bf16 v[244:247], v[76:79], v[136:139], v[244:247]
ds_read_b64_tr_b16 v[96:97], v1 offset:64
s_waitcnt lgkmcnt(7)
v_mfma_f32_16x16x32_bf16 v[248:251], v[72:75], v[140:143], v[248:251]
ds_read_b64_tr_b16 v[98:99], v1 offset:1344
v_mfma_f32_16x16x32_bf16 v[252:255], v[76:79], v[140:143], v[252:255]
ds_read_b64_tr_b16 v[100:101], v1 offset:96
s_waitcnt lgkmcnt(5)
v_mfma_f32_16x16x32_bf16 v[144:147], v[88:91], v[80:83], v[144:147]
ds_read_b64_tr_b16 v[102:103], v1 offset:1376
v_mfma_f32_16x16x32_bf16 v[148:151], v[88:91], v[84:87], v[148:151]
ds_read_b64_tr_b16 v[104:105], v2 offset:0
s_waitcnt lgkmcnt(5)
v_mfma_f32_16x16x32_bf16 v[152:155], v[92:95], v[80:83], v[152:155]
ds_read_b64_tr_b16 v[106:107], v2 offset:1280
v_mfma_f32_16x16x32_bf16 v[156:159], v[92:95], v[84:87], v[156:159]
ds_read_b64_tr_b16 v[108:109], v1 offset:5136
s_waitcnt lgkmcnt(5)
v_mfma_f32_16x16x32_bf16 v[160:163], v[96:99], v[80:83], v[160:163]
ds_read_b64_tr_b16 v[110:111], v1 offset:6416
v_mfma_f32_16x16x32_bf16 v[164:167], v[96:99], v[84:87], v[164:167]
ds_read_b64_tr_b16 v[112:113], v1 offset:5168
s_waitcnt lgkmcnt(5)
v_mfma_f32_16x16x32_bf16 v[168:171], v[100:103], v[80:83], v[168:171]
ds_read_b64_tr_b16 v[114:115], v1 offset:6448
v_mfma_f32_16x16x32_bf16 v[172:175], v[100:103], v[84:87], v[172:175]
ds_read_b64_tr_b16 v[116:117], v1 offset:5200
s_waitcnt lgkmcnt(5)
v_mfma_f32_16x16x32_bf16 v[176:179], v[104:107], v[80:83], v[176:179]
ds_read_b64_tr_b16 v[118:119], v1 offset:6480
v_mfma_f32_16x16x32_bf16 v[180:183], v[104:107], v[84:87], v[180:183]
ds_read_b64_tr_b16 v[120:121], v1 offset:5232
s_waitcnt lgkmcnt(5)
v_mfma_f32_16x16x32_bf16 v[184:187], v[108:111], v[80:83], v[184:187]
ds_read_b64_tr_b16 v[122:123], v1 offset:6512
v_mfma_f32_16x16x32_bf16 v[188:191], v[108:111], v[84:87], v[188:191]
ds_read_b64_tr_b16 v[124:125], v1 offset:10272
s_waitcnt lgkmcnt(5)
v_mfma_f32_16x16x32_bf16 v[192:195], v[112:115], v[80:83], v[192:195]
ds_read_b64_tr_b16 v[126:127], v1 offset:11552
v_mfma_f32_16x16x32_bf16 v[196:199], v[112:115], v[84:87], v[196:199]
ds_read_b64_tr_b16 v[128:129], v1 offset:10304
s_waitcnt lgkmcnt(5)
v_mfma_f32_16x16x32_bf16 v[200:203], v[116:119], v[80:83], v[200:203]
ds_read_b64_tr_b16 v[130:131], v1 offset:11584
v_mfma_f32_16x16x32_bf16 v[204:207], v[116:119], v[84:87], v[204:207]
ds_read_b64_tr_b16 v[132:133], v1 offset:10336
s_waitcnt lgkmcnt(5)
v_mfma_f32_16x16x32_bf16 v[208:211], v[120:123], v[80:83], v[208:211]
ds_read_b64_tr_b16 v[134:135], v1 offset:11616
v_mfma_f32_16x16x32_bf16 v[212:215], v[120:123], v[84:87], v[212:215]
ds_read_b64_tr_b16 v[136:137], v1 offset:10368
s_waitcnt lgkmcnt(5)
v_mfma_f32_16x16x32_bf16 v[216:219], v[80:83], v[124:127], v[216:219]
ds_read_b64_tr_b16 v[138:139], v1 offset:11648
v_mfma_f32_16x16x32_bf16 v[220:223], v[84:87], v[124:127], v[220:223]
ds_read_b64_tr_b16 v[140:141], v1 offset:10400
s_waitcnt lgkmcnt(5)
v_mfma_f32_16x16x32_bf16 v[224:227], v[80:83], v[128:131], v[224:227]
ds_read_b64_tr_b16 v[142:143], v1 offset:11680
v_mfma_f32_16x16x32_bf16 v[228:231], v[84:87], v[128:131], v[228:231]
s_barrier
ds_read_b128 v[72:75], v11 offset:36864
ds_read_b128 v[76:79], v11 offset:38912
s_waitcnt lgkmcnt(6)
v_mfma_f32_16x16x32_bf16 v[232:235], v[80:83], v[132:135], v[232:235]
ds_read_b64_tr_b16 v[88:89], v1 offset:15392
v_mfma_f32_16x16x32_bf16 v[236:239], v[84:87], v[132:135], v[236:239]
ds_read_b64_tr_b16 v[90:91], v1 offset:16672
ds_read_b64_tr_b16 v[92:93], v1 offset:15424
s_waitcnt lgkmcnt(7)
v_mfma_f32_16x16x32_bf16 v[240:243], v[80:83], v[136:139], v[240:243]
ds_read_b64_tr_b16 v[94:95], v1 offset:16704
v_mfma_f32_16x16x32_bf16 v[244:247], v[84:87], v[136:139], v[244:247]
ds_read_b64_tr_b16 v[96:97], v1 offset:15456
s_waitcnt lgkmcnt(7)
v_mfma_f32_16x16x32_bf16 v[248:251], v[80:83], v[140:143], v[248:251]
ds_read_b64_tr_b16 v[98:99], v1 offset:16736
v_mfma_f32_16x16x32_bf16 v[252:255], v[84:87], v[140:143], v[252:255]
ds_read_b64_tr_b16 v[100:101], v1 offset:15488
s_waitcnt lgkmcnt(5)
v_mfma_f32_16x16x32_bf16 v[144:147], v[88:91], v[72:75], v[144:147]
ds_read_b64_tr_b16 v[102:103], v1 offset:16768
v_mfma_f32_16x16x32_bf16 v[148:151], v[88:91], v[76:79], v[148:151]
ds_read_b64_tr_b16 v[104:105], v2 offset:15392
s_waitcnt lgkmcnt(5)
v_mfma_f32_16x16x32_bf16 v[152:155], v[92:95], v[72:75], v[152:155]
ds_read_b64_tr_b16 v[106:107], v2 offset:16672
v_mfma_f32_16x16x32_bf16 v[156:159], v[92:95], v[76:79], v[156:159]
ds_read_b64_tr_b16 v[108:109], v1 offset:20528
s_waitcnt lgkmcnt(5)
v_mfma_f32_16x16x32_bf16 v[160:163], v[96:99], v[72:75], v[160:163]
ds_read_b64_tr_b16 v[110:111], v1 offset:21808
v_mfma_f32_16x16x32_bf16 v[164:167], v[96:99], v[76:79], v[164:167]
ds_read_b64_tr_b16 v[112:113], v1 offset:20560
s_waitcnt lgkmcnt(5)
v_mfma_f32_16x16x32_bf16 v[168:171], v[100:103], v[72:75], v[168:171]
ds_read_b64_tr_b16 v[114:115], v1 offset:21840
v_mfma_f32_16x16x32_bf16 v[172:175], v[100:103], v[76:79], v[172:175]
ds_read_b64_tr_b16 v[116:117], v1 offset:20592
s_waitcnt lgkmcnt(5)
v_mfma_f32_16x16x32_bf16 v[176:179], v[104:107], v[72:75], v[176:179]
ds_read_b64_tr_b16 v[118:119], v1 offset:21872
v_mfma_f32_16x16x32_bf16 v[180:183], v[104:107], v[76:79], v[180:183]
ds_read_b64_tr_b16 v[120:121], v1 offset:20624
s_waitcnt lgkmcnt(5)
v_mfma_f32_16x16x32_bf16 v[184:187], v[108:111], v[72:75], v[184:187]
ds_read_b64_tr_b16 v[122:123], v1 offset:21904
v_mfma_f32_16x16x32_bf16 v[188:191], v[108:111], v[76:79], v[188:191]
ds_read_b64_tr_b16 v[124:125], v1 offset:25664
s_waitcnt lgkmcnt(5)
v_mfma_f32_16x16x32_bf16 v[192:195], v[112:115], v[72:75], v[192:195]
ds_read_b64_tr_b16 v[126:127], v1 offset:26944
v_mfma_f32_16x16x32_bf16 v[196:199], v[112:115], v[76:79], v[196:199]
ds_read_b64_tr_b16 v[128:129], v1 offset:25696
s_waitcnt lgkmcnt(5)
v_mfma_f32_16x16x32_bf16 v[200:203], v[116:119], v[72:75], v[200:203]
ds_read_b64_tr_b16 v[130:131], v1 offset:26976
v_mfma_f32_16x16x32_bf16 v[204:207], v[116:119], v[76:79], v[204:207]
ds_read_b64_tr_b16 v[132:133], v1 offset:25728
s_waitcnt lgkmcnt(5)
v_mfma_f32_16x16x32_bf16 v[208:211], v[120:123], v[72:75], v[208:211]
ds_read_b64_tr_b16 v[134:135], v1 offset:27008
v_mfma_f32_16x16x32_bf16 v[212:215], v[120:123], v[76:79], v[212:215]
ds_read_b64_tr_b16 v[136:137], v1 offset:25760
s_waitcnt lgkmcnt(5)
v_mfma_f32_16x16x32_bf16 v[216:219], v[72:75], v[124:127], v[216:219]
ds_read_b64_tr_b16 v[138:139], v1 offset:27040
v_mfma_f32_16x16x32_bf16 v[220:223], v[76:79], v[124:127], v[220:223]
ds_read_b64_tr_b16 v[140:141], v1 offset:25792
s_waitcnt lgkmcnt(5)
v_mfma_f32_16x16x32_bf16 v[224:227], v[72:75], v[128:131], v[224:227]
ds_read_b64_tr_b16 v[142:143], v1 offset:27072
v_mfma_f32_16x16x32_bf16 v[228:231], v[76:79], v[128:131], v[228:231]
s_barrier
ds_read_b128 v[80:83], v12 offset:36864
ds_read_b128 v[84:87], v12 offset:38912
s_waitcnt lgkmcnt(6)
v_mfma_f32_16x16x32_bf16 v[232:235], v[72:75], v[132:135], v[232:235]
ds_read_b64_tr_b16 v[88:89], v1 offset:30784
v_mfma_f32_16x16x32_bf16 v[236:239], v[76:79], v[132:135], v[236:239]
ds_read_b64_tr_b16 v[90:91], v1 offset:32064
ds_read_b64_tr_b16 v[92:93], v1 offset:30816
s_waitcnt lgkmcnt(7)
v_mfma_f32_16x16x32_bf16 v[240:243], v[72:75], v[136:139], v[240:243]
ds_read_b64_tr_b16 v[94:95], v1 offset:32096
v_mfma_f32_16x16x32_bf16 v[244:247], v[76:79], v[136:139], v[244:247]
ds_read_b64_tr_b16 v[96:97], v1 offset:30848
s_waitcnt lgkmcnt(7)
v_mfma_f32_16x16x32_bf16 v[248:251], v[72:75], v[140:143], v[248:251]
ds_read_b64_tr_b16 v[98:99], v1 offset:32128
v_mfma_f32_16x16x32_bf16 v[252:255], v[76:79], v[140:143], v[252:255]
ds_read_b64_tr_b16 v[100:101], v1 offset:30880
s_waitcnt lgkmcnt(5)
v_mfma_f32_16x16x32_bf16 v[144:147], v[88:91], v[80:83], v[144:147]
ds_read_b64_tr_b16 v[102:103], v1 offset:32160
v_mfma_f32_16x16x32_bf16 v[148:151], v[88:91], v[84:87], v[148:151]
ds_read_b64_tr_b16 v[104:105], v2 offset:30784
s_waitcnt lgkmcnt(5)
v_mfma_f32_16x16x32_bf16 v[152:155], v[92:95], v[80:83], v[152:155]
ds_read_b64_tr_b16 v[106:107], v2 offset:32064
v_mfma_f32_16x16x32_bf16 v[156:159], v[92:95], v[84:87], v[156:159]
ds_read_b64_tr_b16 v[108:109], v1 offset:35920
s_waitcnt lgkmcnt(5)
v_mfma_f32_16x16x32_bf16 v[160:163], v[96:99], v[80:83], v[160:163]
ds_read_b64_tr_b16 v[110:111], v1 offset:37200
v_mfma_f32_16x16x32_bf16 v[164:167], v[96:99], v[84:87], v[164:167]
ds_read_b64_tr_b16 v[112:113], v1 offset:35952
s_waitcnt lgkmcnt(5)
v_mfma_f32_16x16x32_bf16 v[168:171], v[100:103], v[80:83], v[168:171]
ds_read_b64_tr_b16 v[114:115], v1 offset:37232
v_mfma_f32_16x16x32_bf16 v[172:175], v[100:103], v[84:87], v[172:175]
ds_read_b64_tr_b16 v[116:117], v1 offset:35984
s_waitcnt lgkmcnt(5)
v_mfma_f32_16x16x32_bf16 v[176:179], v[104:107], v[80:83], v[176:179]
ds_read_b64_tr_b16 v[118:119], v1 offset:37264
v_mfma_f32_16x16x32_bf16 v[180:183], v[104:107], v[84:87], v[180:183]
ds_read_b64_tr_b16 v[120:121], v1 offset:36016
s_waitcnt lgkmcnt(5)
v_mfma_f32_16x16x32_bf16 v[184:187], v[108:111], v[80:83], v[184:187]
ds_read_b64_tr_b16 v[122:123], v1 offset:37296
v_mfma_f32_16x16x32_bf16 v[188:191], v[108:111], v[84:87], v[188:191]
ds_read_b64_tr_b16 v[124:125], v1 offset:41056
s_waitcnt lgkmcnt(5)
v_mfma_f32_16x16x32_bf16 v[192:195], v[112:115], v[80:83], v[192:195]
ds_read_b64_tr_b16 v[126:127], v1 offset:42336
v_mfma_f32_16x16x32_bf16 v[196:199], v[112:115], v[84:87], v[196:199]
ds_read_b64_tr_b16 v[128:129], v1 offset:41088
s_waitcnt lgkmcnt(5)
v_mfma_f32_16x16x32_bf16 v[200:203], v[116:119], v[80:83], v[200:203]
ds_read_b64_tr_b16 v[130:131], v1 offset:42368
v_mfma_f32_16x16x32_bf16 v[204:207], v[116:119], v[84:87], v[204:207]
ds_read_b64_tr_b16 v[132:133], v1 offset:41120
s_waitcnt lgkmcnt(5)
v_mfma_f32_16x16x32_bf16 v[208:211], v[120:123], v[80:83], v[208:211]
ds_read_b64_tr_b16 v[134:135], v1 offset:42400
v_mfma_f32_16x16x32_bf16 v[212:215], v[120:123], v[84:87], v[212:215]
ds_read_b64_tr_b16 v[136:137], v1 offset:41152
s_waitcnt lgkmcnt(5)
v_mfma_f32_16x16x32_bf16 v[216:219], v[80:83], v[124:127], v[216:219]
ds_read_b64_tr_b16 v[138:139], v1 offset:42432
v_mfma_f32_16x16x32_bf16 v[220:223], v[84:87], v[124:127], v[220:223]
ds_read_b64_tr_b16 v[140:141], v1 offset:41184
s_waitcnt lgkmcnt(5)
v_mfma_f32_16x16x32_bf16 v[224:227], v[80:83], v[128:131], v[224:227]
ds_read_b64_tr_b16 v[142:143], v1 offset:42464
v_mfma_f32_16x16x32_bf16 v[228:231], v[84:87], v[128:131], v[228:231]
s_waitcnt lgkmcnt(4)
v_mfma_f32_16x16x32_bf16 v[232:235], v[80:83], v[132:135], v[232:235]
v_mfma_f32_16x16x32_bf16 v[236:239], v[84:87], v[132:135], v[236:239]
s_waitcnt lgkmcnt(2)
v_mfma_f32_16x16x32_bf16 v[240:243], v[80:83], v[136:139], v[240:243]
v_mfma_f32_16x16x32_bf16 v[244:247], v[84:87], v[136:139], v[244:247]
s_waitcnt lgkmcnt(0)
v_mfma_f32_16x16x32_bf16 v[248:251], v[80:83], v[140:143], v[248:251]
v_mfma_f32_16x16x32_bf16 v[252:255], v[84:87], v[140:143], v[252:255]
v_cvt_pk_bf16_f32 v118, v180, v181
v_mov_b32 v46, 0
v_cvt_pk_bf16_f32 v119, v182, v183
v_mov_b32 v47, 0
v_cvt_pk_bf16_f32 v38, v188, v189
v_cvt_pk_bf16_f32 v39, v190, v191
v_cvt_pk_bf16_f32 v40, v196, v197
v_cvt_pk_bf16_f32 v41, v198, v199
v_cvt_pk_bf16_f32 v42, v204, v205
v_cvt_pk_bf16_f32 v43, v206, v207
v_cvt_pk_bf16_f32 v44, v212, v213
v_cvt_pk_bf16_f32 v45, v214, v215
v_permlane32_swap_b32 v118, v46
v_permlane32_swap_b32 v119, v47
v_cvt_pk_bf16_f32 v124, v220, v221
v_cvt_pk_bf16_f32 v125, v222, v223
v_cvt_pk_bf16_f32 v130, v228, v229
v_cvt_pk_bf16_f32 v131, v230, v231
v_cvt_pk_bf16_f32 v136, v236, v237
v_cvt_pk_bf16_f32 v137, v238, v239
v_cvt_pk_bf16_f32 v142, v244, v245
v_cvt_pk_bf16_f32 v143, v246, v247
v_cvt_pk_bf16_f32 v52, v252, v253
v_cvt_pk_bf16_f32 v53, v254, v255
s_bitcmp1_b32 s3, 0
s_cbranch_scc1 L_AC_nodump
ds_write_b64 v15, v[38:39] offset:0
ds_write_b64 v15, v[124:125] offset:2560
ds_write_b64 v15, v[40:41] offset:512
ds_write_b64 v15, v[130:131] offset:3072
ds_write_b64 v15, v[42:43] offset:1024
ds_write_b64 v15, v[136:137] offset:3584
ds_write_b64 v15, v[44:45] offset:1536
ds_write_b64 v15, v[142:143] offset:4096
ds_write_b64 v15, v[46:47] offset:2048
ds_write_b64 v15, v[52:53] offset:4608
L_AC_nodump:
v_cvt_pk_bf16_f32 v102, v176, v177
v_mov_b32 v36, 0
v_cvt_pk_bf16_f32 v103, v178, v179
v_mov_b32 v37, 0
v_cvt_pk_bf16_f32 v28, v184, v185
v_cvt_pk_bf16_f32 v29, v186, v187
v_cvt_pk_bf16_f32 v30, v192, v193
v_cvt_pk_bf16_f32 v31, v194, v195
v_cvt_pk_bf16_f32 v32, v200, v201
v_cvt_pk_bf16_f32 v33, v202, v203
v_cvt_pk_bf16_f32 v34, v208, v209
v_cvt_pk_bf16_f32 v35, v210, v211
v_permlane32_swap_b32 v102, v36
v_permlane32_swap_b32 v103, v37
v_cvt_pk_bf16_f32 v122, v216, v217
v_cvt_pk_bf16_f32 v123, v218, v219
v_cvt_pk_bf16_f32 v128, v224, v225
v_cvt_pk_bf16_f32 v129, v226, v227
v_cvt_pk_bf16_f32 v134, v232, v233
v_cvt_pk_bf16_f32 v135, v234, v235
v_cvt_pk_bf16_f32 v140, v240, v241
v_cvt_pk_bf16_f32 v141, v242, v243
v_cvt_pk_bf16_f32 v50, v248, v249
v_cvt_pk_bf16_f32 v51, v250, v251
v_cvt_pk_bf16_f32 v104, v148, v149
v_cvt_pk_bf16_f32 v105, v150, v151
v_cvt_pk_bf16_f32 v108, v156, v157
v_cndmask_b32 v106, 0, v108, s[32:33]
v_xor_b32 v108, v108, v106
v_cvt_pk_bf16_f32 v109, v158, v159
v_cvt_pk_bf16_f32 v112, v164, v165
v_cndmask_b32 v110, 0, v112, s[32:33]
v_xor_b32 v112, v112, v110
v_cvt_pk_bf16_f32 v113, v166, v167
v_cndmask_b32 v111, 0, v113, s[32:33]
v_xor_b32 v113, v113, v111
v_cvt_pk_bf16_f32 v116, v172, v173
v_cndmask_b32 v114, 0, v116, s[34:35]
v_xor_b32 v116, v116, v114
v_cvt_pk_bf16_f32 v117, v174, v175
v_cndmask_b32 v115, 0, v117, s[32:33]
v_xor_b32 v117, v117, v115
v_mov_b32 v107, 0
s_waitcnt lgkmcnt(0)
s_barrier
ds_read_b64 v[18:19], v16 offset:0
ds_read_b64 v[120:121], v16 offset:2560
ds_read_b64 v[20:21], v16 offset:512
ds_read_b64 v[126:127], v16 offset:3072
ds_read_b64 v[22:23], v16 offset:1024
ds_read_b64 v[132:133], v16 offset:3584
ds_read_b64 v[24:25], v16 offset:1536
ds_read_b64 v[138:139], v16 offset:4096
ds_read_b64 v[26:27], v16 offset:2048
ds_read_b64 v[48:49], v16 offset:4608
s_mov_b32 s56, 0x3eae1a93
s_mov_b32 s57, s56
s_mov_b32 s53, 0xbeae1a93
v_mfma_f32_16x16x32_bf16 v[224:227], v[38:41], v[104:107], v[56:59]
v_cvt_pk_bf16_f32 v88, v144, v145
v_cvt_pk_bf16_f32 v89, v146, v147
v_mfma_f32_16x16x32_bf16 v[228:231], v[28:31], v[104:107], v[60:63]
v_cvt_pk_bf16_f32 v92, v152, v153
v_cndmask_b32 v90, 0, v92, s[32:33]
v_mfma_f32_16x16x32_bf16 v[232:235], v[40:43], v[108:111], v[56:59]
v_xor_b32 v92, v92, v90
v_cvt_pk_bf16_f32 v93, v154, v155
v_mfma_f32_16x16x32_bf16 v[236:239], v[30:33], v[108:111], v[60:63]
v_cvt_pk_bf16_f32 v96, v160, v161
v_cndmask_b32 v94, 0, v96, s[32:33]
v_mfma_f32_16x16x32_bf16 v[240:243], v[42:45], v[112:115], v[56:59]
v_xor_b32 v96, v96, v94
v_cvt_pk_bf16_f32 v97, v162, v163
v_mfma_f32_16x16x32_bf16 v[244:247], v[32:35], v[112:115], v[60:63]
v_cndmask_b32 v95, 0, v97, s[32:33]
v_xor_b32 v97, v97, v95
v_mfma_f32_16x16x32_bf16 v[248:251], v[44:47], v[116:119], v[56:59]
v_cvt_pk_bf16_f32 v100, v168, v169
v_cndmask_b32 v98, 0, v100, s[34:35]
v_mfma_f32_16x16x32_bf16 v[252:255], v[34:37], v[116:119], v[60:63]
v_xor_b32 v100, v100, v98
v_cvt_pk_bf16_f32 v101, v170, v171
v_cndmask_b32 v99, 0, v101, s[32:33]
v_xor_b32 v101, v101, v99
v_mov_b32 v91, 0
v_mov_b32 v72, 0x3f803f80
v_mov_b32 v73, 0x3f803f80
v_mov_b32 v74, 0x3f803f80
v_mov_b32 v75, 0x3f803f80
s_waitcnt lgkmcnt(0)
v_mfma_f32_16x16x32_bf16 v[184:187], v[28:31], v[88:91], v[56:59]
v_max_f32 v224, v224, v228
v_max_f32 v225, v225, v229
v_mfma_f32_16x16x32_bf16 v[188:191], v[18:21], v[88:91], v[64:67]
v_max_f32 v226, v226, v230
v_max_f32 v227, v227, v231
v_mfma_f32_16x16x32_bf16 v[192:195], v[30:33], v[92:95], v[56:59]
v_max3_f32 v80, v224, v225, v226
v_max_f32 v80, v80, v227
v_mfma_f32_16x16x32_bf16 v[196:199], v[20:23], v[92:95], v[64:67]
v_max_f32 v232, v232, v236
v_max_f32 v233, v233, v237
v_mfma_f32_16x16x32_bf16 v[200:203], v[32:35], v[96:99], v[56:59]
v_max_f32 v234, v234, v238
v_max_f32 v235, v235, v239
v_mfma_f32_16x16x32_bf16 v[204:207], v[22:25], v[96:99], v[64:67]
v_max3_f32 v81, v232, v233, v234
v_max_f32 v81, v81, v235
v_mfma_f32_16x16x32_bf16 v[208:211], v[34:37], v[100:103], v[56:59]
v_max_f32 v240, v240, v244
v_max_f32 v241, v241, v245
v_mfma_f32_16x16x32_bf16 v[212:215], v[24:27], v[100:103], v[64:67]
v_max_f32 v242, v242, v246
v_max_f32 v243, v243, v247
v_max3_f32 v82, v240, v241, v242
v_max_f32 v82, v82, v243
v_max_f32 v248, v248, v252
v_max_f32 v249, v249, v253
v_max_f32 v250, v250, v254
v_max_f32 v251, v251, v255
v_max3_f32 v83, v248, v249, v250
v_max_f32 v83, v83, v251
v_permlane32_swap_b32 v80, v81
v_max_f32 v184, v184, v188
v_max_f32 v185, v185, v189
v_permlane32_swap_b32 v82, v83
v_max_f32 v186, v186, v190
v_max_f32 v187, v187, v191
v_max_f32 v80, v80, v81
v_max3_f32 v76, v184, v185, v186
v_max_f32 v76, v76, v187
v_max_f32 v82, v82, v83
v_max_f32 v192, v192, v196
v_max_f32 v193, v193, v197
v_permlane16_swap_b32 v80, v82
v_max_f32 v194, v194, v198
v_max_f32 v195, v195, v199
v_max_f32 v80, v80, v82
v_max3_f32 v77, v192, v193, v194
v_max_f32 v77, v77, v195
v_mul_f32 v80, s53, v80
v_max_f32 v200, v200, v204
v_max_f32 v201, v201, v205
v_mov_b32 v82, v80
v_max_f32 v202, v202, v206
v_max_f32 v203, v203, v207
v_permlane16_swap_b32 v80, v82
v_max3_f32 v78, v200, v201, v202
v_max_f32 v78, v78, v203
v_mov_b32 v81, v80
v_max_f32 v208, v208, v212
v_max_f32 v209, v209, v213
v_mov_b32 v83, v82
v_max_f32 v210, v210, v214
v_max_f32 v211, v211, v215
v_permlane32_swap_b32 v80, v81
v_max3_f32 v79, v208, v209, v210
v_max_f32 v79, v79, v211
v_permlane32_swap_b32 v82, v83
v_permlane32_swap_b32 v76, v77
v_pk_fma_f32 v[224:225], v[224:225], s[56:57], v[80:81] op_sel:[0,0,0] op_sel_hi:[1,1,0]
v_pk_fma_f32 v[226:227], v[226:227], s[56:57], v[80:81] op_sel:[0,0,0] op_sel_hi:[1,1,0]
v_permlane32_swap_b32 v78, v79
v_pk_fma_f32 v[232:233], v[232:233], s[56:57], v[80:81] op_sel:[0,0,1] op_sel_hi:[1,1,1]
v_pk_fma_f32 v[234:235], v[234:235], s[56:57], v[80:81] op_sel:[0,0,1] op_sel_hi:[1,1,1]
v_max_f32 v76, v76, v77
v_pk_fma_f32 v[240:241], v[240:241], s[56:57], v[82:83] op_sel:[0,0,0] op_sel_hi:[1,1,0]
v_pk_fma_f32 v[242:243], v[242:243], s[56:57], v[82:83] op_sel:[0,0,0] op_sel_hi:[1,1,0]
v_max_f32 v78, v78, v79
v_pk_fma_f32 v[248:249], v[248:249], s[56:57], v[82:83] op_sel:[0,0,1] op_sel_hi:[1,1,1]
v_pk_fma_f32 v[250:251], v[250:251], s[56:57], v[82:83] op_sel:[0,0,1] op_sel_hi:[1,1,1]
v_permlane16_swap_b32 v76, v78
v_exp_f32 v224, v224
v_exp_f32 v225, v225
v_max_f32 v76, v76, v78
v_exp_f32 v226, v226
v_exp_f32 v227, v227
v_mul_f32 v76, s53, v76
v_exp_f32 v232, v232
v_exp_f32 v233, v233
v_mov_b32 v78, v76
v_exp_f32 v234, v234
v_exp_f32 v235, v235
v_permlane16_swap_b32 v76, v78
v_cvt_pk_bf16_f32 v160, v224, v225
v_and_b32 v162, v160, v68
v_mov_b32 v77, v76
v_xor_b32 v160, v160, v162
v_cvt_pk_bf16_f32 v161, v226, v227
v_mov_b32 v79, v78
v_and_b32 v163, v161, v69
v_xor_b32 v161, v161, v163
v_permlane32_swap_b32 v76, v77
v_exp_f32 v240, v240
v_exp_f32 v241, v241
v_permlane32_swap_b32 v78, v79
v_exp_f32 v242, v242
v_exp_f32 v243, v243
v_cvt_pk_bf16_f32 v164, v232, v233
v_and_b32 v166, v164, v68
v_xor_b32 v164, v164, v166
v_cvt_pk_bf16_f32 v165, v234, v235
v_and_b32 v167, v165, v69
v_xor_b32 v165, v165, v167
v_exp_f32 v248, v248
v_exp_f32 v249, v249
v_exp_f32 v250, v250
v_exp_f32 v251, v251
v_cvt_pk_bf16_f32 v168, v240, v241
v_and_b32 v170, v168, v68
v_xor_b32 v168, v168, v170
v_cvt_pk_bf16_f32 v169, v242, v243
v_and_b32 v171, v169, v69
v_xor_b32 v169, v169, v171
v_cvt_pk_bf16_f32 v172, v248, v249
v_and_b32 v174, v172, v68
v_xor_b32 v172, v172, v174
v_cvt_pk_bf16_f32 v173, v250, v251
v_and_b32 v175, v173, v69
v_xor_b32 v173, v173, v175
v_pk_fma_f32 v[184:185], v[184:185], s[56:57], v[76:77] op_sel:[0,0,0] op_sel_hi:[1,1,0]
v_pk_fma_f32 v[186:187], v[186:187], s[56:57], v[76:77] op_sel:[0,0,0] op_sel_hi:[1,1,0]
v_pk_fma_f32 v[192:193], v[192:193], s[56:57], v[76:77] op_sel:[0,0,1] op_sel_hi:[1,1,1]
v_pk_fma_f32 v[194:195], v[194:195], s[56:57], v[76:77] op_sel:[0,0,1] op_sel_hi:[1,1,1]
v_pk_fma_f32 v[200:201], v[200:201], s[56:57], v[78:79] op_sel:[0,0,0] op_sel_hi:[1,1,0]
v_pk_fma_f32 v[202:203], v[202:203], s[56:57], v[78:79] op_sel:[0,0,0] op_sel_hi:[1,1,0]
v_pk_fma_f32 v[208:209], v[208:209], s[56:57], v[78:79] op_sel:[0,0,1] op_sel_hi:[1,1,1]
v_pk_fma_f32 v[210:211], v[210:211], s[56:57], v[78:79] op_sel:[0,0,1] op_sel_hi:[1,1,1]
v_mfma_f32_16x16x32_bf16 v[104:107], v[72:75], v[160:163], 0
v_exp_f32 v184, v184
v_exp_f32 v185, v185
v_mfma_f32_16x16x32_bf16 v[108:111], v[72:75], v[164:167], 0
v_exp_f32 v186, v186
v_exp_f32 v187, v187
v_mfma_f32_16x16x32_bf16 v[112:115], v[72:75], v[168:171], 0
v_exp_f32 v192, v192
v_exp_f32 v193, v193
v_mfma_f32_16x16x32_bf16 v[116:119], v[72:75], v[172:175], 0
v_exp_f32 v194, v194
v_exp_f32 v195, v195
v_mfma_f32_16x16x32_bf16 v[224:227], v[122:125], v[160:163], 0
v_cvt_pk_bf16_f32 v144, v184, v185
v_and_b32 v146, v144, v68
v_mfma_f32_16x16x32_bf16 v[228:231], v[128:131], v[164:167], 0
v_xor_b32 v144, v144, v146
v_cvt_pk_bf16_f32 v145, v186, v187
v_mfma_f32_16x16x32_bf16 v[240:243], v[128:131], v[160:163], 0
v_and_b32 v147, v145, v69
v_xor_b32 v145, v145, v147
v_mfma_f32_16x16x32_bf16 v[232:235], v[134:137], v[168:171], 0
v_exp_f32 v200, v200
v_exp_f32 v201, v201
v_mfma_f32_16x16x32_bf16 v[244:247], v[134:137], v[164:167], 0
v_exp_f32 v202, v202
v_exp_f32 v203, v203
v_mfma_f32_16x16x32_bf16 v[236:239], v[140:143], v[172:175], 0
v_cvt_pk_bf16_f32 v148, v192, v193
v_and_b32 v150, v148, v68
v_mfma_f32_16x16x32_bf16 v[248:251], v[140:143], v[168:171], 0
v_xor_b32 v148, v148, v150
v_cvt_pk_bf16_f32 v149, v194, v195
v_mfma_f32_16x16x32_bf16 v[252:255], v[50:53], v[172:175], 0
v_and_b32 v151, v149, v69
v_xor_b32 v149, v149, v151
v_exp_f32 v208, v208
v_exp_f32 v209, v209
v_exp_f32 v210, v210
v_exp_f32 v211, v211
v_cvt_pk_bf16_f32 v152, v200, v201
v_and_b32 v154, v152, v68
v_xor_b32 v152, v152, v154
v_cvt_pk_bf16_f32 v153, v202, v203
v_and_b32 v155, v153, v69
v_xor_b32 v153, v153, v155
v_cvt_pk_bf16_f32 v156, v208, v209
v_and_b32 v158, v156, v68
v_xor_b32 v156, v156, v158
v_cvt_pk_bf16_f32 v157, v210, v211
v_and_b32 v159, v157, v69
v_xor_b32 v157, v157, v159
v_mfma_f32_16x16x32_bf16 v[88:91], v[72:75], v[144:147], 0
v_rcp_f32 v104, v104
v_rcp_f32 v108, v108
v_mfma_f32_16x16x32_bf16 v[92:95], v[72:75], v[148:151], 0
v_rcp_f32 v112, v112
v_rcp_f32 v116, v116
v_mfma_f32_16x16x32_bf16 v[96:99], v[72:75], v[152:155], 0
v_mul_f32 v224, v224, v104
v_mul_f32 v225, v225, v104
v_mfma_f32_16x16x32_bf16 v[100:103], v[72:75], v[156:159], 0
v_cvt_pk_bf16_f32 v28, v224, v225
v_mul_f32 v226, v226, v104
v_mfma_f32_16x16x32_bf16 v[184:187], v[120:123], v[144:147], 0
v_mul_f32 v227, v227, v104
v_cvt_pk_bf16_f32 v29, v226, v227
v_mfma_f32_16x16x32_bf16 v[188:191], v[126:129], v[148:151], 0
v_mul_f32 v228, v228, v108
v_mul_f32 v229, v229, v108
v_mfma_f32_16x16x32_bf16 v[200:203], v[126:129], v[144:147], 0
v_cvt_pk_bf16_f32 v30, v228, v229
v_mul_f32 v240, v240, v104
v_mfma_f32_16x16x32_bf16 v[192:195], v[132:135], v[152:155], 0
v_mul_f32 v241, v241, v104
v_cvt_pk_bf16_f32 v17, v240, v241
v_mfma_f32_16x16x32_bf16 v[204:207], v[132:135], v[148:151], 0
v_cndmask_b32 v30, v30, v17, s[32:33]
v_mul_f32 v230, v230, v108
v_mfma_f32_16x16x32_bf16 v[196:199], v[138:141], v[156:159], 0
v_mul_f32 v231, v231, v108
v_cvt_pk_bf16_f32 v31, v230, v231
v_mfma_f32_16x16x32_bf16 v[208:211], v[138:141], v[152:155], 0
v_mfma_f32_16x16x32_bf16 v[212:215], v[48:51], v[156:159], 0
v_pk_mul_f32 v[232:233], v[232:233], v[112:113] op_sel_hi:[1,0]
v_cvt_pk_bf16_f32 v32, v232, v233
v_pk_mul_f32 v[244:245], v[244:245], v[108:109] op_sel_hi:[1,0]
v_cvt_pk_bf16_f32 v17, v244, v245
v_cndmask_b32 v32, v32, v17, s[32:33]
v_pk_mul_f32 v[234:235], v[234:235], v[112:113] op_sel_hi:[1,0]
v_cvt_pk_bf16_f32 v33, v234, v235
v_pk_mul_f32 v[246:247], v[246:247], v[108:109] op_sel_hi:[1,0]
v_cvt_pk_bf16_f32 v17, v246, v247
v_cndmask_b32 v33, v33, v17, s[32:33]
v_pk_mul_f32 v[236:237], v[236:237], v[116:117] op_sel_hi:[1,0]
v_cvt_pk_bf16_f32 v34, v236, v237
v_pk_mul_f32 v[248:249], v[248:249], v[112:113] op_sel_hi:[1,0]
v_cvt_pk_bf16_f32 v17, v248, v249
v_cndmask_b32 v34, v34, v17, s[34:35]
v_pk_mul_f32 v[238:239], v[238:239], v[116:117] op_sel_hi:[1,0]
v_cvt_pk_bf16_f32 v35, v238, v239
v_pk_mul_f32 v[250:251], v[250:251], v[112:113] op_sel_hi:[1,0]
v_cvt_pk_bf16_f32 v17, v250, v251
v_cndmask_b32 v35, v35, v17, s[32:33]
v_pk_mul_f32 v[252:253], v[252:253], v[116:117] op_sel_hi:[1,0]
v_cvt_pk_bf16_f32 v36, v252, v253
v_pk_mul_f32 v[254:255], v[254:255], v[116:117] op_sel_hi:[1,0]
v_cvt_pk_bf16_f32 v37, v254, v255
s_movk_i32 s50, 18432
buffer_store_dwordx4 v[28:31], v13, s[16:19], s50 offen sc1
buffer_store_dwordx4 v[32:35], v13, s[16:19], s50 offen offset:1024 sc1
buffer_store_dwordx2 v[36:37], v14, s[16:19], s50 offen sc1
v_rcp_f32 v88, v88
v_rcp_f32 v92, v92
v_rcp_f32 v96, v96
v_rcp_f32 v100, v100
v_pk_mul_f32 v[184:185], v[184:185], v[88:89] op_sel_hi:[1,0]
v_cvt_pk_bf16_f32 v18, v184, v185
v_pk_mul_f32 v[186:187], v[186:187], v[88:89] op_sel_hi:[1,0]
v_cvt_pk_bf16_f32 v19, v186, v187
v_pk_mul_f32 v[188:189], v[188:189], v[92:93] op_sel_hi:[1,0]
v_cvt_pk_bf16_f32 v20, v188, v189
v_pk_mul_f32 v[200:201], v[200:201], v[88:89] op_sel_hi:[1,0]
v_cvt_pk_bf16_f32 v17, v200, v201
v_cndmask_b32 v20, v20, v17, s[32:33]
v_pk_mul_f32 v[190:191], v[190:191], v[92:93] op_sel_hi:[1,0]
v_cvt_pk_bf16_f32 v21, v190, v191
v_pk_mul_f32 v[192:193], v[192:193], v[96:97] op_sel_hi:[1,0]
v_cvt_pk_bf16_f32 v22, v192, v193
v_pk_mul_f32 v[204:205], v[204:205], v[92:93] op_sel_hi:[1,0]
v_cvt_pk_bf16_f32 v17, v204, v205
v_cndmask_b32 v22, v22, v17, s[32:33]
v_pk_mul_f32 v[194:195], v[194:195], v[96:97] op_sel_hi:[1,0]
v_cvt_pk_bf16_f32 v23, v194, v195
v_pk_mul_f32 v[206:207], v[206:207], v[92:93] op_sel_hi:[1,0]
v_cvt_pk_bf16_f32 v17, v206, v207
v_cndmask_b32 v23, v23, v17, s[32:33]
v_pk_mul_f32 v[196:197], v[196:197], v[100:101] op_sel_hi:[1,0]
v_cvt_pk_bf16_f32 v24, v196, v197
v_pk_mul_f32 v[208:209], v[208:209], v[96:97] op_sel_hi:[1,0]
v_cvt_pk_bf16_f32 v17, v208, v209
v_cndmask_b32 v24, v24, v17, s[34:35]
v_pk_mul_f32 v[198:199], v[198:199], v[100:101] op_sel_hi:[1,0]
v_cvt_pk_bf16_f32 v25, v198, v199
v_pk_mul_f32 v[210:211], v[210:211], v[96:97] op_sel_hi:[1,0]
v_cvt_pk_bf16_f32 v17, v210, v211
v_cndmask_b32 v25, v25, v17, s[32:33]
v_pk_mul_f32 v[212:213], v[212:213], v[100:101] op_sel_hi:[1,0]
v_cvt_pk_bf16_f32 v26, v212, v213
v_pk_mul_f32 v[214:215], v[214:215], v[100:101] op_sel_hi:[1,0]
v_cvt_pk_bf16_f32 v27, v214, v215
buffer_store_dwordx4 v[18:21], v13, s[16:19], 0 offen sc1
buffer_store_dwordx4 v[22:25], v13, s[16:19], 0 offen offset:1024 sc1
buffer_store_dwordx2 v[26:27], v14, s[16:19], 0 offen sc1
s_branch L_P2
L_BW1:
s_mul_i32 s7, s6, 24
s_add_u32 s7, s7, 16
s_load_dwordx2 s[40:41], s[0:1], s7
s_load_dwordx4 s[44:47], s[0:1], 48
s_load_dwordx2 s[48:49], s[0:1], 64
s_mov_b32 s32, 0xffff
s_mov_b32 s33, 0
s_mov_b32 s34, -1
s_mov_b32 s35, 0
s_mov_b32 s59, 0
s_waitcnt vmcnt(6)
s_barrier
s_add_u32 s90, s90, 110592
s_cmp_eq_u32 s90, 1990656
s_cselect_b32 s90, 0, s90
s_add_u32 m0, s42, 20544
s_nop 0
buffer_load_dwordx4 v16, s[12:15], s90 offen offset:0 lds
s_addk_i32 m0, 1024
s_nop 0
buffer_load_dwordx4 v17, s[12:15], s90 offen offset:0 lds
s_addk_i32 m0, 2960
s_nop 0
buffer_load_dwordx4 v16, s[12:15], s90 offen offset:1152 lds
s_addk_i32 m0, 1024
s_nop 0
buffer_load_dwordx4 v17, s[12:15], s90 offen offset:1152 lds
s_addk_i32 m0, -2960
s_mov_b32 exec_hi, 0
buffer_load_dwordx4 v18, s[12:15], s90 offen offset:0 lds
s_addk_i32 m0, 3984
s_nop 0
buffer_load_dwordx4 v18, s[12:15], s90 offen offset:1152 lds
s_mov_b32 exec_hi, -1
s_add_u32 s90, s90, 110592
s_cmp_eq_u32 s90, 1990656
s_cselect_b32 s90, 0, s90
s_addk_i32 m0, 4240
s_nop 0
buffer_load_dwordx4 v16, s[12:15], s90 offen offset:0 lds
s_addk_i32 m0, 1024
s_nop 0
buffer_load_dwordx4 v17, s[12:15], s90 offen offset:0 lds
s_addk_i32 m0, 2960
s_nop 0
buffer_load_dwordx4 v16, s[12:15], s90 offen offset:1152 lds
s_addk_i32 m0, 1024
s_nop 0
buffer_load_dwordx4 v17, s[12:15], s90 offen offset:1152 lds
s_addk_i32 m0, -2960
s_mov_b32 exec_hi, 0
buffer_load_dwordx4 v18, s[12:15], s90 offen offset:0 lds
s_addk_i32 m0, 3984
s_nop 0
buffer_load_dwordx4 v18, s[12:15], s90 offen offset:1152 lds
s_mov_b32 exec_hi, -1
s_waitcnt vmcnt(12)
s_barrier
s_add_u32 s90, s90, 110592
s_cmp_eq_u32 s90, 1990656
s_cselect_b32 s90, 0, s90
s_addk_i32 m0, 4240
s_nop 0
buffer_load_dwordx4 v16, s[12:15], s90 offen offset:0 lds
s_addk_i32 m0, 1024
s_nop 0
buffer_load_dwordx4 v17, s[12:15], s90 offen offset:0 lds
s_addk_i32 m0, 2960
s_nop 0
buffer_load_dwordx4 v16, s[12:15], s90 offen offset:1152 lds
s_addk_i32 m0, 1024
s_nop 0
buffer_load_dwordx4 v17, s[12:15], s90 offen offset:1152 lds
s_addk_i32 m0, -2960
s_mov_b32 exec_hi, 0
buffer_load_dwordx4 v18, s[12:15], s90 offen offset:0 lds
s_addk_i32 m0, 3984
s_nop 0
buffer_load_dwordx4 v18, s[12:15], s90 offen offset:1152 lds
s_mov_b32 exec_hi, -1
s_cmp_eq_u32 s59, 1
s_waitcnt lgkmcnt(0)
v_subrev_u32 v19, 1152, v16
v_subrev_u32 v20, 1152, v17
v_subrev_u32 v21, 1152, v18
s_mov_b32 s24, s40
s_mov_b32 s25, s41
s_mov_b32 s26, 663552
s_mov_b32 s27, 0x20000
s_mov_b32 s28, s44
s_mov_b32 s29, s45
s_mov_b32 s30, 4718592
s_mov_b32 s31, 0x20000
s_mov_b32 s20, s46
s_mov_b32 s21, s47
s_mov_b32 s22, 256
s_mov_b32 s23, 0x20000
s_mov_b32 s16, s48
s_mov_b32 s17, s49
s_mov_b32 s18, 7340032
s_mov_b32 s19, 0x20000
s_and_b32 s7, s4, 3
s_lshl_b32 s53, s7, 3
s_lshr_b32 s52, 0x07050200, s53
s_and_b32 s52, s52, 0xff
s_lshr_b32 s53, s4, 2
s_mul_i32 s53, s53, 9
s_add_u32 s52, s52, s53
s_lshl_b32 s52, s52, 6
s_cmp_eq_u32 s7, 1
s_cselect_b32 s55, 64, 0
s_cmp_lt_u32 s7, 2
s_cselect_b32 s56, 12, 8
v_add_u32 v1, 0, v0
v_mul_u32_u24 v2, 5462, v1
s_cselect_b32 s59, 1, 0
s_waitcnt vmcnt(12)
s_barrier
s_add_u32 s90, s90, 110592
s_cmp_eq_u32 s90, 1990656
s_cselect_b32 s90, 0, s90
s_add_u32 m0, s42, 0
s_nop 0
buffer_load_dwordx4 v16, s[12:15], s90 offen offset:0 lds
s_addk_i32 m0, 1024
s_nop 0
buffer_load_dwordx4 v17, s[12:15], s90 offen offset:0 lds
s_addk_i32 m0, 2960
s_nop 0
buffer_load_dwordx4 v16, s[12:15], s90 offen offset:1152 lds
s_addk_i32 m0, 1024
s_nop 0
buffer_load_dwordx4 v17, s[12:15], s90 offen offset:1152 lds
s_addk_i32 m0, -2960
s_mov_b32 exec_hi, 0
buffer_load_dwordx4 v18, s[12:15], s90 offen offset:0 lds
s_addk_i32 m0, 3984
s_nop 0
buffer_load_dwordx4 v18, s[12:15], s90 offen offset:1152 lds
s_mov_b32 exec_hi, -1
s_cmp_eq_u32 s59, 1
v_lshrrev_b32 v2, 16, v2
v_mad_i32_i24 v1, v2, -12, v1
v_bfe_u32 v3, v2, 2, 1
v_lshlrev_b32 v4, 1, v3
v_xor_b32 v1, v1, v4
v_cmp_gt_u32 vcc, s56, v1
v_lshl_add_u32 v1, v1, 4, s52
v_mov_b32 v4, 8388608
v_cndmask_b32 v1, v4, v1, vcc
v_and_b32 v4, 3, v2
v_lshl_add_u32 v5, v3, 2, v4
v_mul_u32_u24 v3, 72, v3
v_add_u32 v4, v3, v4
v_bfe_u32 v3, v2, 3, 1
v_lshl_add_u32 v5, v3, 4, v5
v_lshl_add_u32 v4, v3, 2, v4
v_bfe_u32 v3, v2, 4, 1
v_lshl_add_u32 v5, v3, 3, v5
v_mul_u32_u24 v3, 144, v3
v_add_u32 v4, v3, v4
v_mul_u32_u24 v5, 1152, v5
v_add_u32 v26, v5, v1
v_mul_u32_u24 v4, 1152, v4
v_add_u32 v32, v4, v1
v_add_u32 v1, 64, v0
v_mul_u32_u24 v2, 5462, v1
v_lshrrev_b32 v2, 16, v2
v_mad_i32_i24 v1, v2, -12, v1
v_bfe_u32 v3, v2, 2, 1
v_lshlrev_b32 v4, 1, v3
v_xor_b32 v1, v1, v4
v_cmp_gt_u32 vcc, s56, v1
v_lshl_add_u32 v1, v1, 4, s52
v_mov_b32 v4, 8388608
s_cselect_b32 s59, 1, 0
s_waitcnt vmcnt(12)
s_barrier
s_add_u32 s90, s90, 110592
s_cmp_eq_u32 s90, 1990656
s_cselect_b32 s90, 0, s90
s_addk_i32 m0, 4240
s_nop 0
buffer_load_dwordx4 v16, s[12:15], s90 offen offset:0 lds
s_addk_i32 m0, 1024
s_nop 0
buffer_load_dwordx4 v17, s[12:15], s90 offen offset:0 lds
s_addk_i32 m0, 2960
s_nop 0
buffer_load_dwordx4 v16, s[12:15], s90 offen offset:1152 lds
s_addk_i32 m0, 1024
s_nop 0
buffer_load_dwordx4 v17, s[12:15], s90 offen offset:1152 lds
s_addk_i32 m0, -2960
s_mov_b32 exec_hi, 0
buffer_load_dwordx4 v18, s[12:15], s90 offen offset:0 lds
s_addk_i32 m0, 3984
s_nop 0
buffer_load_dwordx4 v18, s[12:15], s90 offen offset:1152 lds
s_mov_b32 exec_hi, -1
s_cmp_eq_u32 s59, 1
v_cndmask_b32 v1, v4, v1, vcc
v_and_b32 v4, 3, v2
v_lshl_add_u32 v5, v3, 2, v4
v_mul_u32_u24 v3, 72, v3
v_add_u32 v4, v3, v4
v_bfe_u32 v3, v2, 3, 1
v_lshl_add_u32 v5, v3, 4, v5
v_lshl_add_u32 v4, v3, 2, v4
v_bfe_u32 v3, v2, 4, 1
v_lshl_add_u32 v5, v3, 3, v5
v_mul_u32_u24 v3, 144, v3
v_add_u32 v4, v3, v4
v_mul_u32_u24 v5, 1152, v5
v_add_u32 v27, v5, v1
v_mul_u32_u24 v4, 1152, v4
v_add_u32 v33, v4, v1
v_add_u32 v1, 128, v0
v_mul_u32_u24 v2, 5462, v1
v_lshrrev_b32 v2, 16, v2
v_mad_i32_i24 v1, v2, -12, v1
v_bfe_u32 v3, v2, 2, 1
v_lshlrev_b32 v4, 1, v3
v_xor_b32 v1, v1, v4
v_cmp_gt_u32 vcc, s56, v1
v_lshl_add_u32 v1, v1, 4, s52
v_mov_b32 v4, 8388608
v_cndmask_b32 v1, v4, v1, vcc
v_and_b32 v4, 3, v2
v_lshl_add_u32 v5, v3, 2, v4
v_mul_u32_u24 v3, 72, v3
v_add_u32 v4, v3, v4
v_bfe_u32 v3, v2, 3, 1
v_lshl_add_u32 v5, v3, 4, v5
v_lshl_add_u32 v4, v3, 2, v4
s_cselect_b32 s59, 1, 0
s_waitcnt vmcnt(12)
s_barrier
s_add_u32 s90, s90, 110592
s_cmp_eq_u32 s90, 1990656
s_cselect_b32 s90, 0, s90
s_addk_i32 m0, 4240
s_nop 0
buffer_load_dwordx4 v16, s[12:15], s90 offen offset:0 lds
s_addk_i32 m0, 1024
s_nop 0
buffer_load_dwordx4 v17, s[12:15], s90 offen offset:0 lds
s_addk_i32 m0, 2960
s_nop 0
buffer_load_dwordx4 v16, s[12:15], s90 offen offset:1152 lds
s_addk_i32 m0, 1024
s_nop 0
buffer_load_dwordx4 v17, s[12:15], s90 offen offset:1152 lds
s_addk_i32 m0, -2960
s_mov_b32 exec_hi, 0
buffer_load_dwordx4 v18, s[12:15], s90 offen offset:0 lds
s_addk_i32 m0, 3984
s_nop 0
buffer_load_dwordx4 v18, s[12:15], s90 offen offset:1152 lds
s_mov_b32 exec_hi, -1
s_cmp_eq_u32 s59, 1
v_bfe_u32 v3, v2, 4, 1
v_lshl_add_u32 v5, v3, 3, v5
v_mul_u32_u24 v3, 144, v3
v_add_u32 v4, v3, v4
v_mul_u32_u24 v5, 1152, v5
v_add_u32 v28, v5, v1
v_mul_u32_u24 v4, 1152, v4
v_add_u32 v34, v4, v1
v_add_u32 v1, 192, v0
v_mul_u32_u24 v2, 5462, v1
v_lshrrev_b32 v2, 16, v2
v_mad_i32_i24 v1, v2, -12, v1
v_bfe_u32 v3, v2, 2, 1
v_lshlrev_b32 v4, 1, v3
v_xor_b32 v1, v1, v4
v_cmp_gt_u32 vcc, s56, v1
v_lshl_add_u32 v1, v1, 4, s52
v_mov_b32 v4, 8388608
v_cndmask_b32 v1, v4, v1, vcc
v_and_b32 v4, 3, v2
v_lshl_add_u32 v5, v3, 2, v4
v_mul_u32_u24 v3, 72, v3
v_add_u32 v4, v3, v4
v_bfe_u32 v3, v2, 3, 1
v_lshl_add_u32 v5, v3, 4, v5
v_lshl_add_u32 v4, v3, 2, v4
v_bfe_u32 v3, v2, 4, 1
v_lshl_add_u32 v5, v3, 3, v5
v_mul_u32_u24 v3, 144, v3
v_add_u32 v4, v3, v4
v_mul_u32_u24 v5, 1152, v5
v_add_u32 v29, v5, v1
v_mul_u32_u24 v4, 1152, v4
v_add_u32 v35, v4, v1
s_cselect_b32 s59, 1, 0
s_waitcnt vmcnt(12)
s_barrier
s_add_u32 s90, s90, 110592
s_cmp_eq_u32 s90, 1990656
s_cselect_b32 s90, 0, s90
s_addk_i32 m0, 4240
s_nop 0
buffer_load_dwordx4 v16, s[12:15], s90 offen offset:0 lds
s_addk_i32 m0, 1024
s_nop 0
buffer_load_dwordx4 v17, s[12:15], s90 offen offset:0 lds
s_addk_i32 m0, 2960
s_nop 0
buffer_load_dwordx4 v16, s[12:15], s90 offen offset:1152 lds
s_addk_i32 m0, 1024
s_nop 0
buffer_load_dwordx4 v17, s[12:15], s90 offen offset:1152 lds
s_addk_i32 m0, -2960
s_mov_b32 exec_hi, 0
buffer_load_dwordx4 v18, s[12:15], s90 offen offset:0 lds
s_addk_i32 m0, 3984
s_nop 0
buffer_load_dwordx4 v18, s[12:15], s90 offen offset:1152 lds
s_mov_b32 exec_hi, -1
s_cmp_eq_u32 s59, 1
v_add_u32 v1, 256, v0
v_mul_u32_u24 v2, 5462, v1
v_lshrrev_b32 v2, 16, v2
v_mad_i32_i24 v1, v2, -12, v1
v_bfe_u32 v3, v2, 2, 1
v_lshlrev_b32 v4, 1, v3
v_xor_b32 v1, v1, v4
v_cmp_gt_u32 vcc, s56, v1
v_lshl_add_u32 v1, v1, 4, s52
v_mov_b32 v4, 8388608
v_cndmask_b32 v1, v4, v1, vcc
v_and_b32 v4, 3, v2
v_lshl_add_u32 v5, v3, 2, v4
v_mul_u32_u24 v3, 72, v3
v_add_u32 v4, v3, v4
v_bfe_u32 v3, v2, 3, 1
v_lshl_add_u32 v5, v3, 4, v5
v_lshl_add_u32 v4, v3, 2, v4
v_bfe_u32 v3, v2, 4, 1
v_lshl_add_u32 v5, v3, 3, v5
v_mul_u32_u24 v3, 144, v3
v_add_u32 v4, v3, v4
v_mul_u32_u24 v5, 1152, v5
v_add_u32 v30, v5, v1
v_mul_u32_u24 v4, 1152, v4
v_add_u32 v36, v4, v1
v_add_u32 v1, 320, v0
v_mul_u32_u24 v2, 5462, v1
v_lshrrev_b32 v2, 16, v2
v_mad_i32_i24 v1, v2, -12, v1
v_bfe_u32 v3, v2, 2, 1
v_lshlrev_b32 v4, 1, v3
v_xor_b32 v1, v1, v4
v_cmp_gt_u32 vcc, s56, v1
s_cselect_b32 s59, 1, 0
s_waitcnt vmcnt(12)
s_barrier
s_add_u32 s90, s90, 110592
s_cmp_eq_u32 s90, 1990656
s_cselect_b32 s90, 0, s90
s_addk_i32 m0, 4240
s_nop 0
buffer_load_dwordx4 v16, s[12:15], s90 offen offset:0 lds
s_addk_i32 m0, 1024
s_nop 0
buffer_load_dwordx4 v17, s[12:15], s90 offen offset:0 lds
s_addk_i32 m0, 2960
s_nop 0
buffer_load_dwordx4 v16, s[12:15], s90 offen offset:1152 lds
s_addk_i32 m0, 1024
s_nop 0
buffer_load_dwordx4 v17, s[12:15], s90 offen offset:1152 lds
s_addk_i32 m0, -2960
s_mov_b32 exec_hi, 0
buffer_load_dwordx4 v18, s[12:15], s90 offen offset:0 lds
s_addk_i32 m0, 3984
s_nop 0
buffer_load_dwordx4 v18, s[12:15], s90 offen offset:1152 lds
s_mov_b32 exec_hi, -1
s_cmp_eq_u32 s59, 1
v_lshl_add_u32 v1, v1, 4, s52
v_mov_b32 v4, 8388608
v_cndmask_b32 v1, v4, v1, vcc
v_and_b32 v4, 3, v2
v_lshl_add_u32 v5, v3, 2, v4
v_mul_u32_u24 v3, 72, v3
v_add_u32 v4, v3, v4
v_bfe_u32 v3, v2, 3, 1
v_lshl_add_u32 v5, v3, 4, v5
v_lshl_add_u32 v4, v3, 2, v4
v_bfe_u32 v3, v2, 4, 1
v_lshl_add_u32 v5, v3, 3, v5
v_mul_u32_u24 v3, 144, v3
v_add_u32 v4, v3, v4
v_mul_u32_u24 v5, 1152, v5
v_add_u32 v31, v5, v1
v_mul_u32_u24 v4, 1152, v4
v_add_u32 v37, v4, v1
s_and_b32 s55, s3, 3
s_lshl_b32 s57, s55, 3
s_and_b32 s7, s5, 3
s_lshl_b32 s7, s7, 3
s_lshr_b32 s7, 0x14100800, s7
s_and_b32 s7, s7, 0xff
s_lshr_b32 s56, 0x7654321, s7
s_sub_u32 s7, 28, s7
s_lshl_b32 s7, 0x7654321, s7
s_or_b32 s56, s56, s7
s_lshl_b32 s56, s56, 4
s_mul_i32 s7, s4, 0x11111111
s_add_u32 s56, s56, s7
s_and_b32 s56, s56, 0x77777777
s_add_u32 s55, s51, 2
s_mul_i32 s52, s4, 8192
s_cselect_b32 s59, 1, 0
s_waitcnt vmcnt(12)
s_barrier
s_add_u32 s90, s90, 110592
s_cmp_eq_u32 s90, 1990656
s_cselect_b32 s90, 0, s90
s_add_u32 m0, s42, 0
s_nop 0
buffer_load_dwordx4 v16, s[12:15], s90 offen offset:0 lds
s_addk_i32 m0, 1024
s_nop 0
buffer_load_dwordx4 v17, s[12:15], s90 offen offset:0 lds
s_addk_i32 m0, 2960
s_nop 0
buffer_load_dwordx4 v16, s[12:15], s90 offen offset:1152 lds
s_addk_i32 m0, 1024
s_nop 0
buffer_load_dwordx4 v17, s[12:15], s90 offen offset:1152 lds
s_addk_i32 m0, -2960
s_mov_b32 exec_hi, 0
buffer_load_dwordx4 v18, s[12:15], s90 offen offset:0 lds
s_addk_i32 m0, 3984
s_nop 0
buffer_load_dwordx4 v18, s[12:15], s90 offen offset:1152 lds
s_mov_b32 exec_hi, -1
s_cmp_eq_u32 s59, 1
s_add_u32 s52, s52, 5242880
v_and_b32 v1, 15, v0
v_lshrrev_b32 v2, 4, v0
v_lshlrev_b32 v2, 2, v2
v_cmp_gt_u32 s[44:45], 8, v1
v_lshlrev_b32 v8, 2, v0
v_add_u32 v8, 146976, v8
v_mov_b32 v9, 0x80000000
s_cmp_eq_u32 s55, 0
s_cselect_b32 s58, 4, s55
s_lshl_b32 s7, s58, 4
s_sub_u32 s53, s7, 16
s_mov_b64 s[46:47], 0
v_add_u32 v3, s53, v1
v_mul_u32_u24 v4, 57, v3
v_lshrrev_b32 v4, 10, v4
v_mul_u32_u24 v5, 18, v4
v_sub_u32 v3, v3, v5
v_cndmask_b32 v4, v4, 7, s[46:47]
v_add3_u32 v5, v2, s7, 0
v_mul_u32_u24 v6, 57, v5
v_lshrrev_b32 v6, 10, v6
v_cmp_eq_u32 vcc, v4, v6
v_mad_u32_u24 v5, v5, 19, v3
v_lshlrev_b32 v5, 2, v5
v_add_u32 v6, 141472, v5
v_cndmask_b32 v72, v8, v6, vcc
v_add3_u32 v5, v2, s7, 2
v_mul_u32_u24 v6, 57, v5
v_lshrrev_b32 v6, 10, v6
v_cmp_eq_u32 vcc, v4, v6
v_mad_u32_u24 v5, v5, 19, v3
v_lshlrev_b32 v5, 2, v5
v_add_u32 v6, 141472, v5
s_cselect_b32 s59, 1, 0
s_waitcnt vmcnt(12)
s_barrier
s_add_u32 s90, s90, 110592
s_cmp_eq_u32 s90, 1990656
s_cselect_b32 s90, 0, s90
s_addk_i32 m0, 4240
s_nop 0
buffer_load_dwordx4 v16, s[12:15], s90 offen offset:0 lds
s_addk_i32 m0, 1024
s_nop 0
buffer_load_dwordx4 v17, s[12:15], s90 offen offset:0 lds
s_addk_i32 m0, 2960
s_nop 0
buffer_load_dwordx4 v16, s[12:15], s90 offen offset:1152 lds
s_addk_i32 m0, 1024
s_nop 0
buffer_load_dwordx4 v17, s[12:15], s90 offen offset:1152 lds
s_addk_i32 m0, -2960
s_mov_b32 exec_hi, 0
buffer_load_dwordx4 v18, s[12:15], s90 offen offset:0 lds
s_addk_i32 m0, 3984
s_nop 0
buffer_load_dwordx4 v18, s[12:15], s90 offen offset:1152 lds
s_mov_b32 exec_hi, -1
s_cmp_eq_u32 s59, 1
v_cndmask_b32 v73, v8, v6, vcc
s_lshl_b32 s7, s55, 4
s_mov_b32 s53, s7
v_add_u32 v3, s53, v1
v_mul_u32_u24 v4, 57, v3
v_lshrrev_b32 v4, 10, v4
v_mul_u32_u24 v5, 18, v4
v_sub_u32 v3, v3, v5
v_cndmask_b32 v4, v4, 7, s[46:47]
v_add3_u32 v5, v2, s7, 0
v_mul_u32_u24 v6, 57, v5
v_lshrrev_b32 v6, 10, v6
v_cmp_eq_u32 vcc, v4, v6
v_mad_u32_u24 v5, v5, 19, v3
v_lshlrev_b32 v5, 2, v5
v_add_u32 v6, 141472, v5
v_cndmask_b32 v74, v8, v6, vcc
v_add3_u32 v5, v2, s7, 2
v_mul_u32_u24 v6, 57, v5
v_lshrrev_b32 v6, 10, v6
v_cmp_eq_u32 vcc, v4, v6
v_mad_u32_u24 v5, v5, 19, v3
v_lshlrev_b32 v5, 2, v5
v_add_u32 v6, 141472, v5
v_cndmask_b32 v75, v8, v6, vcc
s_add_u32 s53, s7, 16
s_cmp_eq_u32 s55, 3
s_cselect_b32 s53, 56, s53
s_cselect_b64 s[46:47], s[44:45], 0
v_add_u32 v3, s53, v1
v_mul_u32_u24 v4, 57, v3
v_lshrrev_b32 v4, 10, v4
v_mul_u32_u24 v5, 18, v4
v_sub_u32 v3, v3, v5
s_cselect_b32 s59, 1, 0
s_waitcnt vmcnt(12)
s_barrier
s_add_u32 s90, s90, 110592
s_cmp_eq_u32 s90, 1990656
s_cselect_b32 s90, 0, s90
s_addk_i32 m0, 4240
s_nop 0
buffer_load_dwordx4 v16, s[12:15], s90 offen offset:0 lds
s_addk_i32 m0, 1024
s_nop 0
buffer_load_dwordx4 v17, s[12:15], s90 offen offset:0 lds
s_addk_i32 m0, 2960
s_nop 0
buffer_load_dwordx4 v16, s[12:15], s90 offen offset:1152 lds
s_addk_i32 m0, 1024
s_nop 0
buffer_load_dwordx4 v17, s[12:15], s90 offen offset:1152 lds
s_addk_i32 m0, -2960
s_mov_b32 exec_hi, 0
buffer_load_dwordx4 v18, s[12:15], s90 offen offset:0 lds
s_addk_i32 m0, 3984
s_nop 0
buffer_load_dwordx4 v18, s[12:15], s90 offen offset:1152 lds
s_mov_b32 exec_hi, -1
s_cmp_eq_u32 s59, 1
v_cndmask_b32 v4, v4, 7, s[46:47]
v_add3_u32 v5, v2, s7, 0
v_mul_u32_u24 v6, 57, v5
v_lshrrev_b32 v6, 10, v6
v_cmp_eq_u32 vcc, v4, v6
v_mad_u32_u24 v5, v5, 19, v3
v_lshlrev_b32 v5, 2, v5
v_add_u32 v6, 141472, v5
v_cndmask_b32 v76, v8, v6, vcc
v_add3_u32 v5, v2, s7, 2
v_mul_u32_u24 v6, 57, v5
v_lshrrev_b32 v6, 10, v6
v_cmp_eq_u32 vcc, v4, v6
v_mad_u32_u24 v5, v5, 19, v3
v_lshlrev_b32 v5, 2, v5
v_add_u32 v6, 141472, v5
v_cndmask_b32 v77, v8, v6, vcc
v_add_u32 v5, s7, v0
v_mul_u32_u24 v5, 76, v5
v_add_u32 v5, 141544, v5
v_cndmask_b32 v98, v8, v5, s[32:33]
v_lshlrev_b32 v101, 4, v0
v_add_u32 v101, 100512, v101
s_lshl_b32 s7, s55, 10
v_add_u32 v99, s7, v101
s_lshl_b32 s7, s58, 10
v_add_u32 v100, s7, v101
v_mov_b32 v10, 147360
v_mov_b32 v11, 1
s_cselect_b32 s59, 1, 0
s_waitcnt vmcnt(12)
s_barrier
s_add_u32 s90, s90, 110592
s_cmp_eq_u32 s90, 1990656
s_cselect_b32 s90, 0, s90
s_addk_i32 m0, 4240
s_nop 0
buffer_load_dwordx4 v16, s[12:15], s90 offen offset:0 lds
s_addk_i32 m0, 1024
s_nop 0
buffer_load_dwordx4 v17, s[12:15], s90 offen offset:0 lds
s_addk_i32 m0, 2960
s_nop 0
buffer_load_dwordx4 v16, s[12:15], s90 offen offset:1152 lds
s_addk_i32 m0, 1024
s_nop 0
buffer_load_dwordx4 v17, s[12:15], s90 offen offset:1152 lds
s_addk_i32 m0, -2960
s_mov_b32 exec_hi, 0
buffer_load_dwordx4 v18, s[12:15], s90 offen offset:0 lds
s_addk_i32 m0, 3984
s_nop 0
buffer_load_dwordx4 v18, s[12:15], s90 offen offset:1152 lds
s_mov_b32 exec_hi, -1
s_waitcnt vmcnt(12)
s_barrier
s_add_u32 s90, s90, 110592
s_cmp_eq_u32 s90, 1990656
s_cselect_b32 s90, 0, s90
s_addk_i32 m0, 4240
s_nop 0
buffer_load_dwordx4 v16, s[12:15], s90 offen offset:0 lds
s_addk_i32 m0, 1024
s_nop 0
buffer_load_dwordx4 v17, s[12:15], s90 offen offset:0 lds
s_addk_i32 m0, 2960
s_nop 0
buffer_load_dwordx4 v16, s[12:15], s90 offen offset:1152 lds
s_addk_i32 m0, 1024
s_nop 0
buffer_load_dwordx4 v17, s[12:15], s90 offen offset:1152 lds
s_addk_i32 m0, -2960
s_mov_b32 exec_hi, 0
buffer_load_dwordx4 v18, s[12:15], s90 offen offset:0 lds
s_addk_i32 m0, 3984
s_nop 0
buffer_load_dwordx4 v18, s[12:15], s90 offen offset:1152 lds
s_mov_b32 exec_hi, -1
s_waitcnt vmcnt(12)
s_barrier
s_add_u32 s90, s90, 110592
s_cmp_eq_u32 s90, 1990656
s_cselect_b32 s90, 0, s90
s_add_u32 m0, s42, 0
s_nop 0
buffer_load_dwordx4 v16, s[12:15], s90 offen offset:0 lds
s_addk_i32 m0, 1024
s_nop 0
buffer_load_dwordx4 v17, s[12:15], s90 offen offset:0 lds
s_addk_i32 m0, 2960
s_nop 0
buffer_load_dwordx4 v16, s[12:15], s90 offen offset:1152 lds
s_addk_i32 m0, 1024
s_nop 0
buffer_load_dwordx4 v17, s[12:15], s90 offen offset:1152 lds
s_addk_i32 m0, -2960
s_mov_b32 exec_hi, 0
buffer_load_dwordx4 v18, s[12:15], s90 offen offset:0 lds
s_addk_i32 m0, 3984
s_nop 0
buffer_load_dwordx4 v18, s[12:15], s90 offen offset:1152 lds
s_mov_b32 exec_hi, -1
s_waitcnt vmcnt(12)
s_barrier
s_add_u32 s90, s90, 110592
s_cmp_eq_u32 s90, 1990656
s_cselect_b32 s90, 0, s90
s_addk_i32 m0, 4240
s_nop 0
buffer_load_dwordx4 v16, s[12:15], s90 offen offset:0 lds
s_addk_i32 m0, 1024
s_nop 0
buffer_load_dwordx4 v17, s[12:15], s90 offen offset:0 lds
s_addk_i32 m0, 2960
s_nop 0
buffer_load_dwordx4 v16, s[12:15], s90 offen offset:1152 lds
s_addk_i32 m0, 1024
s_nop 0
buffer_load_dwordx4 v17, s[12:15], s90 offen offset:1152 lds
s_addk_i32 m0, -2960
s_mov_b32 exec_hi, 0
buffer_load_dwordx4 v18, s[12:15], s90 offen offset:0 lds
s_addk_i32 m0, 3984
s_nop 0
buffer_load_dwordx4 v18, s[12:15], s90 offen offset:1152 lds
s_mov_b32 exec_hi, -1
s_waitcnt vmcnt(12)
s_barrier
s_add_u32 s90, s90, 110592
s_cmp_eq_u32 s90, 1990656
s_cselect_b32 s90, 0, s90
s_addk_i32 m0, 4240
s_nop 0
buffer_load_dwordx4 v16, s[12:15], s90 offen offset:0 lds
s_addk_i32 m0, 1024
s_nop 0
buffer_load_dwordx4 v17, s[12:15], s90 offen offset:0 lds
s_addk_i32 m0, 2960
s_nop 0
buffer_load_dwordx4 v16, s[12:15], s90 offen offset:1152 lds
s_addk_i32 m0, 1024
s_nop 0
buffer_load_dwordx4 v17, s[12:15], s90 offen offset:1152 lds
s_addk_i32 m0, -2960
s_mov_b32 exec_hi, 0
buffer_load_dwordx4 v18, s[12:15], s90 offen offset:0 lds
s_addk_i32 m0, 3984
s_nop 0
buffer_load_dwordx4 v18, s[12:15], s90 offen offset:1152 lds
s_mov_b32 exec_hi, -1
s_waitcnt vmcnt(12)
s_barrier
s_add_u32 s50, s90, 110592
s_cmp_ge_u32 s50, 1990656
s_cselect_b32 s7, 1990656, 0
s_sub_u32 s50, s50, s7
s_add_u32 m0, s42, 148480
s_nop 0
buffer_load_dwordx4 v19, s[12:15], s50 offen offset:0 lds
s_addk_i32 m0, 1024
s_nop 0
buffer_load_dwordx4 v20, s[12:15], s50 offen offset:0 lds
s_addk_i32 m0, 1024
s_mov_b32 exec_hi, 0
buffer_load_dwordx4 v21, s[12:15], s50 offen offset:0 lds
s_mov_b32 exec_hi, -1
s_add_u32 s50, s90, 221184
s_cmp_ge_u32 s50, 1990656
s_cselect_b32 s7, 1990656, 0
s_sub_u32 s50, s50, s7
s_addk_i32 m0, 3072
s_nop 0
buffer_load_dwordx4 v19, s[12:15], s50 offen offset:0 lds
s_addk_i32 m0, 1024
s_nop 0
buffer_load_dwordx4 v20, s[12:15], s50 offen offset:0 lds
s_addk_i32 m0, 1024
s_mov_b32 exec_hi, 0
buffer_load_dwordx4 v21, s[12:15], s50 offen offset:0 lds
s_mov_b32 exec_hi, -1
s_waitcnt vmcnt(12)
s_barrier
s_add_u32 s50, s90, 331776
s_cmp_ge_u32 s50, 1990656
s_cselect_b32 s7, 1990656, 0
s_sub_u32 s50, s50, s7
s_addk_i32 m0, 3072
s_nop 0
buffer_load_dwordx4 v19, s[12:15], s50 offen offset:0 lds
s_addk_i32 m0, 1024
s_nop 0
buffer_load_dwordx4 v20, s[12:15], s50 offen offset:0 lds
s_addk_i32 m0, 1024
s_mov_b32 exec_hi, 0
buffer_load_dwordx4 v21, s[12:15], s50 offen offset:0 lds
s_mov_b32 exec_hi, -1
s_waitcnt vmcnt(9)
s_barrier
s_barrier
s_add_u32 s50, s90, 442368
s_cmp_ge_u32 s50, 1990656
s_cselect_b32 s7, 1990656, 0
s_sub_u32 s50, s50, s7
s_add_u32 m0, s42, 0
s_nop 0
buffer_load_dwordx4 v19, s[12:15], s50 offen offset:0 lds
s_addk_i32 m0, 1024
s_nop 0
buffer_load_dwordx4 v20, s[12:15], s50 offen offset:0 lds
s_addk_i32 m0, 1024
s_mov_b32 exec_hi, 0
buffer_load_dwordx4 v21, s[12:15], s50 offen offset:0 lds
s_mov_b32 exec_hi, -1
s_add_u32 s50, s90, 552960
s_cmp_ge_u32 s50, 1990656
s_cselect_b32 s7, 1990656, 0
s_sub_u32 s50, s50, s7
s_addk_i32 m0, 3072
s_nop 0
buffer_load_dwordx4 v19, s[12:15], s50 offen offset:0 lds
s_addk_i32 m0, 1024
s_nop 0
buffer_load_dwordx4 v20, s[12:15], s50 offen offset:0 lds
s_addk_i32 m0, 1024
s_mov_b32 exec_hi, 0
buffer_load_dwordx4 v21, s[12:15], s50 offen offset:0 lds
s_mov_b32 exec_hi, -1
s_add_u32 s50, s90, 663552
s_cmp_ge_u32 s50, 1990656
s_cselect_b32 s7, 1990656, 0
s_sub_u32 s50, s50, s7
s_addk_i32 m0, 3072
s_nop 0
buffer_load_dwordx4 v19, s[12:15], s50 offen offset:0 lds
s_addk_i32 m0, 1024
s_nop 0
buffer_load_dwordx4 v20, s[12:15], s50 offen offset:0 lds
s_addk_i32 m0, 1024
s_mov_b32 exec_hi, 0
buffer_load_dwordx4 v21, s[12:15], s50 offen offset:0 lds
s_mov_b32 exec_hi, -1
s_add_u32 s50, s90, 774144
s_cmp_ge_u32 s50, 1990656
s_cselect_b32 s7, 1990656, 0
s_sub_u32 s50, s50, s7
s_add_u32 m0, s42, 46080
s_nop 0
buffer_load_dwordx4 v19, s[12:15], s50 offen offset:0 lds
s_addk_i32 m0, 1024
s_nop 0
buffer_load_dwordx4 v20, s[12:15], s50 offen offset:0 lds
s_addk_i32 m0, 1024
s_mov_b32 exec_hi, 0
buffer_load_dwordx4 v21, s[12:15], s50 offen offset:0 lds
s_mov_b32 exec_hi, -1
s_add_u32 s50, s90, 884736
s_cmp_ge_u32 s50, 1990656
s_cselect_b32 s7, 1990656, 0
s_sub_u32 s50, s50, s7
s_addk_i32 m0, 3232
s_nop 0
buffer_load_dwordx4 v19, s[12:15], s50 offen offset:0 lds
s_addk_i32 m0, 1024
s_nop 0
buffer_load_dwordx4 v20, s[12:15], s50 offen offset:0 lds
s_addk_i32 m0, 1024
s_mov_b32 exec_hi, 0
buffer_load_dwordx4 v21, s[12:15], s50 offen offset:0 lds
s_mov_b32 exec_hi, -1
s_add_u32 s50, s90, 995328
s_cmp_ge_u32 s50, 1990656
s_cselect_b32 s7, 1990656, 0
s_sub_u32 s50, s50, s7
s_addk_i32 m0, 3072
s_nop 0
buffer_load_dwordx4 v19, s[12:15], s50 offen offset:0 lds
s_addk_i32 m0, 1024
s_nop 0
buffer_load_dwordx4 v20, s[12:15], s50 offen offset:0 lds
s_addk_i32 m0, 1024
s_mov_b32 exec_hi, 0
buffer_load_dwordx4 v21, s[12:15], s50 offen offset:0 lds
s_mov_b32 exec_hi, -1
s_add_u32 s50, s90, 1105920
s_cmp_ge_u32 s50, 1990656
s_cselect_b32 s7, 1990656, 0
s_sub_u32 s50, s50, s7
s_addk_i32 m0, 3072
s_nop 0
buffer_load_dwordx4 v19, s[12:15], s50 offen offset:0 lds
s_addk_i32 m0, 1024
s_nop 0
buffer_load_dwordx4 v20, s[12:15], s50 offen offset:0 lds
s_addk_i32 m0, 1024
s_mov_b32 exec_hi, 0
buffer_load_dwordx4 v21, s[12:15], s50 offen offset:0 lds
s_mov_b32 exec_hi, -1
s_add_u32 s50, s90, 1216512
s_cmp_ge_u32 s50, 1990656
s_cselect_b32 s7, 1990656, 0
s_sub_u32 s50, s50, s7
s_addk_i32 m0, 3072
s_nop 0
buffer_load_dwordx4 v19, s[12:15], s50 offen offset:0 lds
s_addk_i32 m0, 1024
s_nop 0
buffer_load_dwordx4 v20, s[12:15], s50 offen offset:0 lds
s_addk_i32 m0, 1024
s_mov_b32 exec_hi, 0
buffer_load_dwordx4 v21, s[12:15], s50 offen offset:0 lds
s_mov_b32 exec_hi, -1
s_add_u32 s50, s90, 1327104
s_cmp_ge_u32 s50, 1990656
s_cselect_b32 s7, 1990656, 0
s_sub_u32 s50, s50, s7
s_addk_i32 m0, 3072
s_nop 0
buffer_load_dwordx4 v19, s[12:15], s50 offen offset:0 lds
s_addk_i32 m0, 1024
s_nop 0
buffer_load_dwordx4 v20, s[12:15], s50 offen offset:0 lds
s_addk_i32 m0, 1024
s_mov_b32 exec_hi, 0
buffer_load_dwordx4 v21, s[12:15], s50 offen offset:0 lds
s_mov_b32 exec_hi, -1
s_waitcnt vmcnt(33)
s_barrier
ds_read_b128 v[112:115], v99 offset:0
ds_read_b128 v[120:123], v100 offset:4096
ds_read_b128 v[124:127], v99 offset:5120
ds_read_b128 v[128:131], v99 offset:6144
ds_read_b128 v[132:135], v101 offset:9216
ds_read_b128 v[140:143], v99 offset:10240
ds_read_b128 v[148:151], v100 offset:14336
ds_read_b128 v[152:155], v99 offset:15360
ds_read_b128 v[156:159], v99 offset:16384
ds_read_b128 v[160:163], v101 offset:19456
ds_read_b128 v[168:171], v99 offset:20480
ds_read_b128 v[176:179], v100 offset:24576
ds_read_b128 v[180:183], v99 offset:25600
ds_read_b128 v[184:187], v99 offset:26624
ds_read_b128 v[188:191], v101 offset:29696
ds_read_b128 v[196:199], v99 offset:30720
ds_read_b128 v[204:207], v100 offset:34816
ds_read_b128 v[208:211], v99 offset:35840
ds_read_b128 v[212:215], v99 offset:36864
ds_read_b128 v[216:219], v101 offset:39936
s_waitcnt lgkmcnt(15)
v_mfma_f32_16x16x32_bf16 v[40:43], v[112:115], v[120:123], 0
v_mfma_f32_16x16x32_bf16 v[44:47], v[112:115], v[124:127], 0
v_mfma_f32_16x16x32_bf16 v[48:51], v[112:115], v[128:131], 0
v_mfma_f32_16x16x32_bf16 v[56:59], v[132:135], v[112:115], 0
s_waitcnt lgkmcnt(10)
v_mfma_f32_16x16x32_bf16 v[40:43], v[140:143], v[148:151], v[40:43]
v_mfma_f32_16x16x32_bf16 v[44:47], v[140:143], v[152:155], v[44:47]
v_mfma_f32_16x16x32_bf16 v[48:51], v[140:143], v[156:159], v[48:51]
v_mfma_f32_16x16x32_bf16 v[56:59], v[160:163], v[140:143], v[56:59]
s_waitcnt lgkmcnt(5)
v_mfma_f32_16x16x32_bf16 v[40:43], v[168:171], v[176:179], v[40:43]
v_mfma_f32_16x16x32_bf16 v[44:47], v[168:171], v[180:183], v[44:47]
v_mfma_f32_16x16x32_bf16 v[48:51], v[168:171], v[184:187], v[48:51]
v_mfma_f32_16x16x32_bf16 v[56:59], v[188:191], v[168:171], v[56:59]
s_waitcnt lgkmcnt(0)
v_mfma_f32_16x16x32_bf16 v[40:43], v[196:199], v[204:207], v[40:43]
v_mfma_f32_16x16x32_bf16 v[44:47], v[196:199], v[208:211], v[44:47]
v_mfma_f32_16x16x32_bf16 v[48:51], v[196:199], v[212:215], v[48:51]
v_mfma_f32_16x16x32_bf16 v[56:59], v[216:219], v[196:199], v[56:59]
s_nop 4
ds_write_b32 v72, v40 offset:0
ds_write_b32 v72, v41 offset:76
ds_write_b32 v73, v42 offset:0
ds_write_b32 v73, v43 offset:76
ds_write_b32 v74, v44 offset:0
ds_write_b32 v74, v45 offset:76
ds_write_b32 v75, v46 offset:0
ds_write_b32 v75, v47 offset:76
ds_write_b32 v76, v48 offset:0
ds_write_b32 v76, v49 offset:76
ds_write_b32 v77, v50 offset:0
ds_write_b32 v77, v51 offset:76
ds_write_b32 v98, v56
s_waitcnt vmcnt(0) lgkmcnt(0)
s_barrier
s_barrier
s_add_u32 s50, s90, 1437696
s_cmp_ge_u32 s50, 1990656
s_cselect_b32 s7, 1990656, 0
s_sub_u32 s50, s50, s7
s_add_u32 m0, s42, 15360
s_nop 0
buffer_load_dwordx4 v19, s[12:15], s50 offen offset:0 lds
s_addk_i32 m0, 1024
s_nop 0
buffer_load_dwordx4 v20, s[12:15], s50 offen offset:0 lds
s_addk_i32 m0, 1024
s_mov_b32 exec_hi, 0
buffer_load_dwordx4 v21, s[12:15], s50 offen offset:0 lds
s_mov_b32 exec_hi, -1
s_add_u32 s50, s90, 1548288
s_cmp_ge_u32 s50, 1990656
s_cselect_b32 s7, 1990656, 0
s_sub_u32 s50, s50, s7
s_addk_i32 m0, 3072
s_nop 0
buffer_load_dwordx4 v19, s[12:15], s50 offen offset:0 lds
s_addk_i32 m0, 1024
s_nop 0
buffer_load_dwordx4 v20, s[12:15], s50 offen offset:0 lds
s_addk_i32 m0, 1024
s_mov_b32 exec_hi, 0
buffer_load_dwordx4 v21, s[12:15], s50 offen offset:0 lds
s_mov_b32 exec_hi, -1
s_add_u32 s50, s90, 1658880
s_cmp_ge_u32 s50, 1990656
s_cselect_b32 s7, 1990656, 0
s_sub_u32 s50, s50, s7
s_addk_i32 m0, 3072
s_nop 0
buffer_load_dwordx4 v19, s[12:15], s50 offen offset:0 lds
s_addk_i32 m0, 1024
s_nop 0
buffer_load_dwordx4 v20, s[12:15], s50 offen offset:0 lds
s_addk_i32 m0, 1024
s_mov_b32 exec_hi, 0
buffer_load_dwordx4 v21, s[12:15], s50 offen offset:0 lds
s_mov_b32 exec_hi, -1
s_add_u32 s50, s90, 1769472
s_cmp_ge_u32 s50, 1990656
s_cselect_b32 s7, 1990656, 0
s_sub_u32 s50, s50, s7
s_addk_i32 m0, 3072
s_nop 0
buffer_load_dwordx4 v19, s[12:15], s50 offen offset:0 lds
s_addk_i32 m0, 1024
s_nop 0
buffer_load_dwordx4 v20, s[12:15], s50 offen offset:0 lds
s_addk_i32 m0, 1024
s_mov_b32 exec_hi, 0
buffer_load_dwordx4 v21, s[12:15], s50 offen offset:0 lds
s_mov_b32 exec_hi, -1
s_add_u32 s50, s90, 1880064
s_cmp_ge_u32 s50, 1990656
s_cselect_b32 s7, 1990656, 0
s_sub_u32 s50, s50, s7
s_addk_i32 m0, 3072
s_nop 0
buffer_load_dwordx4 v19, s[12:15], s50 offen offset:0 lds
s_addk_i32 m0, 1024
s_nop 0
buffer_load_dwordx4 v20, s[12:15], s50 offen offset:0 lds
s_addk_i32 m0, 1024
s_mov_b32 exec_hi, 0
buffer_load_dwordx4 v21, s[12:15], s50 offen offset:0 lds
s_mov_b32 exec_hi, -1
s_add_u32 s50, s90, 1990656
s_cmp_ge_u32 s50, 1990656
s_cselect_b32 s7, 1990656, 0
s_sub_u32 s50, s50, s7
s_addk_i32 m0, 3072
s_nop 0
buffer_load_dwordx4 v19, s[12:15], s50 offen offset:0 lds
s_addk_i32 m0, 1024
s_nop 0
buffer_load_dwordx4 v20, s[12:15], s50 offen offset:0 lds
s_addk_i32 m0, 1024
s_mov_b32 exec_hi, 0
buffer_load_dwordx4 v21, s[12:15], s50 offen offset:0 lds
s_mov_b32 exec_hi, -1
s_mul_i32 s7, s51, 6144
s_add_u32 m0, s7, 77824
s_bfe_u32 s50, s56, 0x30000
s_mul_i32 s50, s50, 82944
s_mul_i32 s7, s51, 36864
s_add_u32 s50, s50, s7
buffer_load_dwordx4 v26, s[24:27], s50 offen offset:0 lds
s_addk_i32 m0, 1024
s_nop 0
buffer_load_dwordx4 v27, s[24:27], s50 offen offset:0 lds
s_addk_i32 m0, 1024
s_nop 0
buffer_load_dwordx4 v28, s[24:27], s50 offen offset:0 lds
s_addk_i32 m0, 1024
s_nop 0
buffer_load_dwordx4 v29, s[24:27], s50 offen offset:0 lds
s_addk_i32 m0, 1024
s_nop 0
buffer_load_dwordx4 v30, s[24:27], s50 offen offset:0 lds
s_addk_i32 m0, 1024
s_nop 0
buffer_load_dwordx4 v31, s[24:27], s50 offen offset:0 lds
s_mul_i32 s7, s51, 6144
s_add_u32 m0, s7, 90112
s_bfe_u32 s50, s56, 0x30004
s_mul_i32 s50, s50, 82944
s_mul_i32 s7, s51, 36864
s_add_u32 s50, s50, s7
buffer_load_dwordx4 v26, s[24:27], s50 offen offset:0 lds
s_addk_i32 m0, 1024
s_nop 0
buffer_load_dwordx4 v27, s[24:27], s50 offen offset:0 lds
s_addk_i32 m0, 1024
s_nop 0
buffer_load_dwordx4 v28, s[24:27], s50 offen offset:0 lds
s_addk_i32 m0, 1024
s_nop 0
buffer_load_dwordx4 v29, s[24:27], s50 offen offset:0 lds
s_addk_i32 m0, 1024
s_nop 0
buffer_load_dwordx4 v30, s[24:27], s50 offen offset:0 lds
s_addk_i32 m0, 1024
s_nop 0
buffer_load_dwordx4 v31, s[24:27], s50 offen offset:0 lds
s_waitcnt vmcnt(12)
s_barrier
s_mul_i32 s7, s51, 6144
s_add_u32 m0, s7, 148480
s_mul_i32 s50, s51, 331776
s_add_u32 s50, s50, 73728
buffer_load_dwordx4 v32, s[24:27], s50 offen offset:0 lds
s_addk_i32 m0, 1024
s_nop 0
buffer_load_dwordx4 v33, s[24:27], s50 offen offset:0 lds
s_addk_i32 m0, 1024
s_nop 0
buffer_load_dwordx4 v34, s[24:27], s50 offen offset:0 lds
s_addk_i32 m0, 1024
s_nop 0
buffer_load_dwordx4 v35, s[24:27], s50 offen offset:0 lds
s_addk_i32 m0, 1024
s_nop 0
buffer_load_dwordx4 v36, s[24:27], s50 offen offset:0 lds
s_addk_i32 m0, 1024
s_nop 0
buffer_load_dwordx4 v37, s[24:27], s50 offen offset:0 lds
s_mul_i32 s7, s51, 6144
s_add_u32 m0, s7, 102400
s_bfe_u32 s50, s56, 0x30008
s_mul_i32 s50, s50, 82944
s_mul_i32 s7, s51, 36864
s_add_u32 s50, s50, s7
buffer_load_dwordx4 v26, s[24:27], s50 offen offset:0 lds
s_addk_i32 m0, 1024
s_nop 0
buffer_load_dwordx4 v27, s[24:27], s50 offen offset:0 lds
s_addk_i32 m0, 1024
s_nop 0
buffer_load_dwordx4 v28, s[24:27], s50 offen offset:0 lds
s_addk_i32 m0, 1024
s_nop 0
buffer_load_dwordx4 v29, s[24:27], s50 offen offset:0 lds
s_addk_i32 m0, 1024
s_nop 0
buffer_load_dwordx4 v30, s[24:27], s50 offen offset:0 lds
s_addk_i32 m0, 1024
s_nop 0
buffer_load_dwordx4 v31, s[24:27], s50 offen offset:0 lds
s_barrier
s_mul_i32 s7, s51, 6144
s_add_u32 m0, s7, 114688
s_bfe_u32 s50, s56, 0x3000c
s_mul_i32 s50, s50, 82944
s_mul_i32 s7, s51, 36864
s_add_u32 s50, s50, s7
buffer_load_dwordx4 v26, s[24:27], s50 offen offset:0 lds
s_addk_i32 m0, 1024
s_nop 0
buffer_load_dwordx4 v27, s[24:27], s50 offen offset:0 lds
s_addk_i32 m0, 1024
s_nop 0
buffer_load_dwordx4 v28, s[24:27], s50 offen offset:0 lds
s_addk_i32 m0, 1024
s_nop 0
buffer_load_dwordx4 v29, s[24:27], s50 offen offset:0 lds
s_addk_i32 m0, 1024
s_nop 0
buffer_load_dwordx4 v30, s[24:27], s50 offen offset:0 lds
s_addk_i32 m0, 1024
s_nop 0
buffer_load_dwordx4 v31, s[24:27], s50 offen offset:0 lds
s_mul_i32 s7, s51, 6144
s_add_u32 m0, s7, 0
s_bfe_u32 s50, s56, 0x30010
s_mul_i32 s50, s50, 82944
s_mul_i32 s7, s51, 36864
s_add_u32 s50, s50, s7
buffer_load_dwordx4 v26, s[24:27], s50 offen offset:0 lds
s_addk_i32 m0, 1024
s_nop 0
buffer_load_dwordx4 v27, s[24:27], s50 offen offset:0 lds
s_addk_i32 m0, 1024
s_nop 0
buffer_load_dwordx4 v28, s[24:27], s50 offen offset:0 lds
s_addk_i32 m0, 1024
s_nop 0
buffer_load_dwordx4 v29, s[24:27], s50 offen offset:0 lds
s_addk_i32 m0, 1024
s_nop 0
buffer_load_dwordx4 v30, s[24:27], s50 offen offset:0 lds
s_addk_i32 m0, 1024
s_nop 0
buffer_load_dwordx4 v31, s[24:27], s50 offen offset:0 lds
s_waitcnt vmcnt(12)
s_barrier
s_mul_i32 s7, s51, 6144
s_add_u32 m0, s7, 15360
s_bfe_u32 s50, s56, 0x30014
s_mul_i32 s50, s50, 82944
s_mul_i32 s7, s51, 36864
s_add_u32 s50, s50, s7
buffer_load_dwordx4 v26, s[24:27], s50 offen offset:0 lds
s_addk_i32 m0, 1024
s_nop 0
buffer_load_dwordx4 v27, s[24:27], s50 offen offset:0 lds
s_addk_i32 m0, 1024
s_nop 0
buffer_load_dwordx4 v28, s[24:27], s50 offen offset:0 lds
s_addk_i32 m0, 1024
s_nop 0
buffer_load_dwordx4 v29, s[24:27], s50 offen offset:0 lds
s_addk_i32 m0, 1024
s_nop 0
buffer_load_dwordx4 v30, s[24:27], s50 offen offset:0 lds
s_addk_i32 m0, 1024
s_nop 0
buffer_load_dwordx4 v31, s[24:27], s50 offen offset:0 lds
s_mul_i32 s7, s51, 6144
s_add_u32 m0, s7, 27648
s_bfe_u32 s50, s56, 0x30018
s_mul_i32 s50, s50, 82944
s_mul_i32 s7, s51, 36864
s_add_u32 s50, s50, s7
buffer_load_dwordx4 v26, s[24:27], s50 offen offset:0 lds
s_addk_i32 m0, 1024
s_nop 0
buffer_load_dwordx4 v27, s[24:27], s50 offen offset:0 lds
s_addk_i32 m0, 1024
s_nop 0
buffer_load_dwordx4 v28, s[24:27], s50 offen offset:0 lds
s_addk_i32 m0, 1024
s_nop 0
buffer_load_dwordx4 v29, s[24:27], s50 offen offset:0 lds
s_addk_i32 m0, 1024
s_nop 0
buffer_load_dwordx4 v30, s[24:27], s50 offen offset:0 lds
s_addk_i32 m0, 1024
s_nop 0
buffer_load_dwordx4 v31, s[24:27], s50 offen offset:0 lds
s_mul_i32 s7, s51, 6144
s_add_u32 m0, s7, 39936
s_bfe_u32 s50, s56, 0x3001c
s_mul_i32 s50, s50, 82944
s_mul_i32 s7, s51, 36864
s_add_u32 s50, s50, s7
buffer_load_dwordx4 v26, s[24:27], s50 offen offset:0 lds
s_addk_i32 m0, 1024
s_nop 0
buffer_load_dwordx4 v27, s[24:27], s50 offen offset:0 lds
s_addk_i32 m0, 1024
s_nop 0
buffer_load_dwordx4 v28, s[24:27], s50 offen offset:0 lds
s_addk_i32 m0, 1024
s_nop 0
buffer_load_dwordx4 v29, s[24:27], s50 offen offset:0 lds
s_addk_i32 m0, 1024
s_nop 0
buffer_load_dwordx4 v30, s[24:27], s50 offen offset:0 lds
s_addk_i32 m0, 1024
s_nop 0
buffer_load_dwordx4 v31, s[24:27], s50 offen offset:0 lds
s_waitcnt vmcnt(0)
s_barrier
s_endpgm
L_BX1:
s_mul_i32 s7, s6, 24
s_add_u32 s7, s7, 16
s_load_dwordx2 s[40:41], s[0:1], s7
s_load_dwordx4 s[44:47], s[0:1], 48
s_load_dwordx2 s[48:49], s[0:1], 64
s_mov_b32 s32, 0xffff
s_mov_b32 s33, 0
s_mov_b32 s34, -1
s_mov_b32 s35, 0
s_mov_b32 s59, 0
s_waitcnt vmcnt(8)
s_barrier
s_addk_i32 s91, 128
s_cmpk_eq_u32 s91, 1152
s_cselect_b32 s91, 0, s91
s_add_u32 m0, s42, 84128
s_nop 0
buffer_load_dwordx4 v16, s[8:11], s91 offen offset:0 lds
s_addk_i32 m0, 2048
s_nop 0
buffer_load_dwordx4 v17, s[8:11], s91 offen offset:0 lds
s_addk_i32 m0, 2048
s_nop 0
buffer_load_dwordx4 v18, s[8:11], s91 offen offset:0 lds
s_addk_i32 m0, 2048
s_nop 0
buffer_load_dwordx4 v19, s[8:11], s91 offen offset:0 lds
s_waitcnt vmcnt(8)
s_barrier
s_addk_i32 m0, 2048
s_nop 0
buffer_load_dwordx4 v20, s[8:11], s91 offen offset:0 lds
s_addk_i32 m0, 2048
s_nop 0
buffer_load_dwordx4 v21, s[8:11], s91 offen offset:0 lds
s_addk_i32 m0, 2048
s_nop 0
buffer_load_dwordx4 v22, s[8:11], s91 offen offset:0 lds
s_addk_i32 m0, 2048
s_nop 0
buffer_load_dwordx4 v23, s[8:11], s91 offen offset:0 lds
s_cmp_eq_u32 s59, 1
s_waitcnt lgkmcnt(0)
s_mov_b32 s24, s40
s_mov_b32 s25, s41
s_mov_b32 s26, 663552
s_mov_b32 s27, 0x20000
s_mov_b32 s28, s44
s_mov_b32 s29, s45
s_mov_b32 s30, 4718592
s_mov_b32 s31, 0x20000
s_mov_b32 s20, s46
s_mov_b32 s21, s47
s_mov_b32 s22, 256
s_mov_b32 s23, 0x20000
s_mov_b32 s16, s48
s_mov_b32 s17, s49
s_mov_b32 s18, 7340032
s_mov_b32 s19, 0x20000
s_lshl_b32 s7, s6, 4
s_add_u32 s7, s7, s5
s_lshl_b32 s53, s7, 8
s_add_u32 s53, s53, 5505024
s_add_u32 s92, s16, s53
s_addc_u32 s93, s17, 0
s_lshl_b32 s7, s7, 2
s_add_u32 s98, s7, 32
s_lshl_b32 s99, s4, 2
s_mul_i32 s53, s4, 8192
s_add_u32 s53, s53, 5249024
s_add_u32 s94, s16, s53
s_addc_u32 s95, s17, 0
s_add_u32 s55, s51, 2
s_mul_i32 s52, s4, 8192
s_add_u32 s52, s52, 5242880
v_and_b32 v1, 15, v0
v_lshrrev_b32 v2, 4, v0
v_lshlrev_b32 v2, 2, v2
v_cmp_gt_u32 s[44:45], 8, v1
s_cselect_b32 s59, 1, 0
s_waitcnt vmcnt(8)
s_barrier
s_addk_i32 s91, 128
s_cmpk_eq_u32 s91, 1152
s_cselect_b32 s91, 0, s91
s_add_u32 m0, s42, 51360
s_nop 0
buffer_load_dwordx4 v16, s[8:11], s91 offen offset:0 lds
s_addk_i32 m0, 2048
s_nop 0
buffer_load_dwordx4 v17, s[8:11], s91 offen offset:0 lds
s_addk_i32 m0, 2048
s_nop 0
buffer_load_dwordx4 v18, s[8:11], s91 offen offset:0 lds
s_addk_i32 m0, 2048
s_nop 0
buffer_load_dwordx4 v19, s[8:11], s91 offen offset:0 lds
s_cmp_eq_u32 s59, 1
v_lshlrev_b32 v8, 2, v0
v_add_u32 v8, 146976, v8
v_mov_b32 v9, 0x80000000
s_cmp_eq_u32 s55, 0
s_cselect_b32 s58, 4, s55
s_lshl_b32 s7, s58, 4
s_sub_u32 s53, s7, 16
s_mov_b64 s[46:47], 0
v_add_u32 v3, s53, v1
v_mul_u32_u24 v4, 57, v3
v_lshrrev_b32 v4, 10, v4
v_mul_u32_u24 v5, 18, v4
v_sub_u32 v3, v3, v5
v_cndmask_b32 v4, v4, 7, s[46:47]
v_add3_u32 v5, v2, s7, 0
v_mul_u32_u24 v6, 57, v5
v_lshrrev_b32 v6, 10, v6
v_cmp_eq_u32 vcc, v4, v6
v_mad_u32_u24 v5, v5, 19, v3
v_lshlrev_b32 v5, 2, v5
v_add_u32 v6, s52, v5
v_cndmask_b32 v80, v9, v6, vcc
v_add3_u32 v5, v2, s7, 2
v_mul_u32_u24 v6, 57, v5
v_lshrrev_b32 v6, 10, v6
v_cmp_eq_u32 vcc, v4, v6
v_mad_u32_u24 v5, v5, 19, v3
v_lshlrev_b32 v5, 2, v5
v_add_u32 v6, s52, v5
v_cndmask_b32 v81, v9, v6, vcc
s_lshl_b32 s7, s55, 4
s_mov_b32 s53, s7
v_add_u32 v3, s53, v1
v_mul_u32_u24 v4, 57, v3
v_lshrrev_b32 v4, 10, v4
v_mul_u32_u24 v5, 18, v4
v_sub_u32 v3, v3, v5
s_cselect_b32 s59, 1, 0
s_waitcnt vmcnt(8)
s_barrier
s_addk_i32 m0, 2048
s_nop 0
buffer_load_dwordx4 v20, s[8:11], s91 offen offset:0 lds
s_addk_i32 m0, 2048
s_nop 0
buffer_load_dwordx4 v21, s[8:11], s91 offen offset:0 lds
s_addk_i32 m0, 2048
s_nop 0
buffer_load_dwordx4 v22, s[8:11], s91 offen offset:0 lds
s_addk_i32 m0, 2048
s_nop 0
buffer_load_dwordx4 v23, s[8:11], s91 offen offset:0 lds
s_cmp_eq_u32 s59, 1
v_cndmask_b32 v4, v4, 7, s[46:47]
v_add3_u32 v5, v2, s7, 0
v_mul_u32_u24 v6, 57, v5
v_lshrrev_b32 v6, 10, v6
v_cmp_eq_u32 vcc, v4, v6
v_mad_u32_u24 v5, v5, 19, v3
v_lshlrev_b32 v5, 2, v5
v_add_u32 v6, s52, v5
v_cndmask_b32 v82, v9, v6, vcc
v_add3_u32 v5, v2, s7, 2
v_mul_u32_u24 v6, 57, v5
v_lshrrev_b32 v6, 10, v6
v_cmp_eq_u32 vcc, v4, v6
v_mad_u32_u24 v5, v5, 19, v3
v_lshlrev_b32 v5, 2, v5
v_add_u32 v6, s52, v5
v_cndmask_b32 v83, v9, v6, vcc
s_add_u32 s53, s7, 16
s_cmp_eq_u32 s55, 3
s_cselect_b32 s53, 56, s53
s_cselect_b64 s[46:47], s[44:45], 0
v_add_u32 v3, s53, v1
v_mul_u32_u24 v4, 57, v3
v_lshrrev_b32 v4, 10, v4
v_mul_u32_u24 v5, 18, v4
v_sub_u32 v3, v3, v5
v_cndmask_b32 v4, v4, 7, s[46:47]
v_add3_u32 v5, v2, s7, 0
v_mul_u32_u24 v6, 57, v5
v_lshrrev_b32 v6, 10, v6
v_cmp_eq_u32 vcc, v4, v6
v_mad_u32_u24 v5, v5, 19, v3
v_lshlrev_b32 v5, 2, v5
v_add_u32 v6, s52, v5
v_cndmask_b32 v84, v9, v6, vcc
v_add3_u32 v5, v2, s7, 2
v_mul_u32_u24 v6, 57, v5
s_cselect_b32 s59, 1, 0
s_waitcnt vmcnt(8)
s_barrier
s_addk_i32 s91, 128
s_cmpk_eq_u32 s91, 1152
s_cselect_b32 s91, 0, s91
s_addk_i32 m0, 2048
s_nop 0
buffer_load_dwordx4 v16, s[8:11], s91 offen offset:0 lds
s_addk_i32 m0, 2048
s_nop 0
buffer_load_dwordx4 v17, s[8:11], s91 offen offset:0 lds
s_addk_i32 m0, 2048
s_nop 0
buffer_load_dwordx4 v18, s[8:11], s91 offen offset:0 lds
s_addk_i32 m0, 2048
s_nop 0
buffer_load_dwordx4 v19, s[8:11], s91 offen offset:0 lds
s_cmp_eq_u32 s59, 1
v_lshrrev_b32 v6, 10, v6
v_cmp_eq_u32 vcc, v4, v6
v_mad_u32_u24 v5, v5, 19, v3
v_lshlrev_b32 v5, 2, v5
v_add_u32 v6, s52, v5
v_cndmask_b32 v85, v9, v6, vcc
v_and_b32 v3, 3, v0
v_add3_u32 v5, v2, s7, 0
v_mul_u32_u24 v6, 57, v5
v_lshrrev_b32 v6, 10, v6
v_cmp_eq_u32 vcc, v3, v6
v_mul_u32_u24 v5, 76, v5
v_add3_u32 v5, v5, s52, 64
v_add_u32 v5, 8, v5
v_cndmask_b32 v86, v9, v5, vcc
v_add3_u32 v5, v2, s7, 2
v_mul_u32_u24 v6, 57, v5
v_lshrrev_b32 v6, 10, v6
v_cmp_eq_u32 vcc, v3, v6
v_mul_u32_u24 v5, 76, v5
v_add3_u32 v5, v5, s52, 64
v_add_u32 v5, 8, v5
v_cndmask_b32 v87, v9, v5, vcc
s_movk_i32 s7, 64
v_and_b32 v3, 3, v0
v_add3_u32 v5, v2, s7, 0
v_mul_u32_u24 v6, 57, v5
v_lshrrev_b32 v6, 10, v6
v_cmp_eq_u32 vcc, v3, v6
v_mul_u32_u24 v5, 76, v5
v_add3_u32 v5, v5, s52, 64
v_add_u32 v5, 8, v5
v_cndmask_b32 v10, v9, v5, vcc
v_add3_u32 v5, v2, s7, 2
v_mul_u32_u24 v6, 57, v5
v_lshrrev_b32 v6, 10, v6
v_cmp_eq_u32 vcc, v3, v6
s_cselect_b32 s59, 1, 0
s_waitcnt vmcnt(8)
s_barrier
s_addk_i32 m0, 2048
s_nop 0
buffer_load_dwordx4 v20, s[8:11], s91 offen offset:0 lds
s_addk_i32 m0, 2048
s_nop 0
buffer_load_dwordx4 v21, s[8:11], s91 offen offset:0 lds
s_addk_i32 m0, 2048
s_nop 0
buffer_load_dwordx4 v22, s[8:11], s91 offen offset:0 lds
s_addk_i32 m0, 2048
s_nop 0
buffer_load_dwordx4 v23, s[8:11], s91 offen offset:0 lds
s_cmp_eq_u32 s59, 1
v_mul_u32_u24 v5, 76, v5
v_add3_u32 v5, v5, s52, 64
v_add_u32 v5, 8, v5
v_cndmask_b32 v11, v9, v5, vcc
s_cmp_eq_u32 s51, 0
s_cselect_b32 s58, 4, s51
s_lshl_b32 s7, s58, 4
s_sub_u32 s53, s7, 16
s_mov_b64 s[46:47], 0
v_add_u32 v3, s53, v1
v_mul_u32_u24 v4, 57, v3
v_lshrrev_b32 v4, 10, v4
v_mul_u32_u24 v5, 18, v4
v_sub_u32 v3, v3, v5
v_cndmask_b32 v4, v4, 7, s[46:47]
v_add3_u32 v5, v2, s7, 0
v_mul_u32_u24 v6, 57, v5
v_lshrrev_b32 v6, 10, v6
v_cmp_eq_u32 vcc, v4, v6
v_mad_u32_u24 v5, v5, 19, v3
v_lshlrev_b32 v5, 2, v5
v_add_u32 v6, 141472, v5
v_cndmask_b32 v72, v8, v6, vcc
v_add_u32 v6, s52, v5
v_cndmask_b32 v88, v9, v6, vcc
v_add3_u32 v5, v2, s7, 2
v_mul_u32_u24 v6, 57, v5
v_lshrrev_b32 v6, 10, v6
v_cmp_eq_u32 vcc, v4, v6
v_mad_u32_u24 v5, v5, 19, v3
v_lshlrev_b32 v5, 2, v5
v_add_u32 v6, 141472, v5
v_cndmask_b32 v73, v8, v6, vcc
v_add_u32 v6, s52, v5
v_cndmask_b32 v89, v9, v6, vcc
s_lshl_b32 s7, s51, 4
s_mov_b32 s53, s7
s_cselect_b32 s59, 1, 0
s_waitcnt vmcnt(8)
s_barrier
s_addk_i32 s91, 128
s_cmpk_eq_u32 s91, 1152
s_cselect_b32 s91, 0, s91
s_addk_i32 m0, 2048
s_nop 0
buffer_load_dwordx4 v16, s[8:11], s91 offen offset:0 lds
s_addk_i32 m0, 2048
s_nop 0
buffer_load_dwordx4 v17, s[8:11], s91 offen offset:0 lds
s_addk_i32 m0, 2048
s_nop 0
buffer_load_dwordx4 v18, s[8:11], s91 offen offset:0 lds
s_addk_i32 m0, 2048
s_nop 0
buffer_load_dwordx4 v19, s[8:11], s91 offen offset:0 lds
s_cmp_eq_u32 s59, 1
v_add_u32 v3, s53, v1
v_mul_u32_u24 v4, 57, v3
v_lshrrev_b32 v4, 10, v4
v_mul_u32_u24 v5, 18, v4
v_sub_u32 v3, v3, v5
v_cndmask_b32 v4, v4, 7, s[46:47]
v_add3_u32 v5, v2, s7, 0
v_mul_u32_u24 v6, 57, v5
v_lshrrev_b32 v6, 10, v6
v_cmp_eq_u32 vcc, v4, v6
v_mad_u32_u24 v5, v5, 19, v3
v_lshlrev_b32 v5, 2, v5
v_add_u32 v6, 141472, v5
v_cndmask_b32 v74, v8, v6, vcc
v_add_u32 v6, s52, v5
v_cndmask_b32 v90, v9, v6, vcc
v_add3_u32 v5, v2, s7, 2
v_mul_u32_u24 v6, 57, v5
v_lshrrev_b32 v6, 10, v6
v_cmp_eq_u32 vcc, v4, v6
v_mad_u32_u24 v5, v5, 19, v3
v_lshlrev_b32 v5, 2, v5
v_add_u32 v6, 141472, v5
v_cndmask_b32 v75, v8, v6, vcc
v_add_u32 v6, s52, v5
v_cndmask_b32 v91, v9, v6, vcc
s_add_u32 s53, s7, 16
s_cmp_eq_u32 s51, 3
s_cselect_b32 s53, 56, s53
s_cselect_b64 s[46:47], s[44:45], 0
v_add_u32 v3, s53, v1
v_mul_u32_u24 v4, 57, v3
v_lshrrev_b32 v4, 10, v4
v_mul_u32_u24 v5, 18, v4
v_sub_u32 v3, v3, v5
v_cndmask_b32 v4, v4, 7, s[46:47]
v_add3_u32 v5, v2, s7, 0
s_cselect_b32 s59, 1, 0
s_waitcnt vmcnt(8)
s_barrier
s_addk_i32 m0, 2048
s_nop 0
buffer_load_dwordx4 v20, s[8:11], s91 offen offset:0 lds
s_addk_i32 m0, 2048
s_nop 0
buffer_load_dwordx4 v21, s[8:11], s91 offen offset:0 lds
s_addk_i32 m0, 2048
s_nop 0
buffer_load_dwordx4 v22, s[8:11], s91 offen offset:0 lds
s_addk_i32 m0, 2048
s_nop 0
buffer_load_dwordx4 v23, s[8:11], s91 offen offset:0 lds
s_cmp_eq_u32 s59, 1
v_mul_u32_u24 v6, 57, v5
v_lshrrev_b32 v6, 10, v6
v_cmp_eq_u32 vcc, v4, v6
v_mad_u32_u24 v5, v5, 19, v3
v_lshlrev_b32 v5, 2, v5
v_add_u32 v6, 141472, v5
v_cndmask_b32 v76, v8, v6, vcc
v_add_u32 v6, s52, v5
v_cndmask_b32 v92, v9, v6, vcc
v_add3_u32 v5, v2, s7, 2
v_mul_u32_u24 v6, 57, v5
v_lshrrev_b32 v6, 10, v6
v_cmp_eq_u32 vcc, v4, v6
v_mad_u32_u24 v5, v5, 19, v3
v_lshlrev_b32 v5, 2, v5
v_add_u32 v6, 141472, v5
v_cndmask_b32 v77, v8, v6, vcc
v_add_u32 v6, s52, v5
v_cndmask_b32 v93, v9, v6, vcc
v_and_b32 v3, 3, v0
v_add3_u32 v5, v2, s7, 0
v_mul_u32_u24 v6, 57, v5
v_lshrrev_b32 v6, 10, v6
v_cmp_eq_u32 vcc, v3, v6
v_mul_u32_u24 v5, 76, v5
v_add3_u32 v5, v5, s52, 64
v_add_u32 v5, 8, v5
v_cndmask_b32 v94, v9, v5, vcc
v_add3_u32 v5, v2, s7, 2
v_mul_u32_u24 v6, 57, v5
v_lshrrev_b32 v6, 10, v6
v_cmp_eq_u32 vcc, v3, v6
v_mul_u32_u24 v5, 76, v5
v_add3_u32 v5, v5, s52, 64
v_add_u32 v5, 8, v5
v_cndmask_b32 v95, v9, v5, vcc
v_add_u32 v5, s7, v0
s_cselect_b32 s59, 1, 0
s_waitcnt vmcnt(8)
s_barrier
s_addk_i32 s91, 128
s_cmpk_eq_u32 s91, 1152
s_cselect_b32 s91, 0, s91
s_add_u32 m0, s42, 51360
s_nop 0
buffer_load_dwordx4 v16, s[8:11], s91 offen offset:0 lds
s_addk_i32 m0, 2048
s_nop 0
buffer_load_dwordx4 v17, s[8:11], s91 offen offset:0 lds
s_addk_i32 m0, 2048
s_nop 0
buffer_load_dwordx4 v18, s[8:11], s91 offen offset:0 lds
s_addk_i32 m0, 2048
s_nop 0
buffer_load_dwordx4 v19, s[8:11], s91 offen offset:0 lds
s_cmp_eq_u32 s59, 1
v_mul_u32_u24 v5, 76, v5
v_add_u32 v5, 141544, v5
v_cndmask_b32 v98, v8, v5, s[32:33]
v_lshlrev_b32 v101, 4, v0
v_add_u32 v101, 100512, v101
s_lshl_b32 s7, s51, 10
v_add_u32 v99, s7, v101
s_lshl_b32 s7, s58, 10
v_add_u32 v100, s7, v101
s_movk_i32 s7, 64
s_movk_i32 s53, 56
s_mov_b64 s[46:47], s[44:45]
v_add_u32 v3, s53, v1
v_mul_u32_u24 v4, 57, v3
v_lshrrev_b32 v4, 10, v4
v_mul_u32_u24 v5, 18, v4
v_sub_u32 v3, v3, v5
v_cndmask_b32 v4, v4, 7, s[46:47]
v_cmp_eq_u32 vcc, 0, v1
s_nop 1
v_cndmask_b32 v4, v4, 3, vcc
v_cndmask_b32 v3, v3, 18, vcc
v_add3_u32 v5, v2, s7, 0
v_mul_u32_u24 v6, 57, v5
v_lshrrev_b32 v6, 10, v6
v_cmp_eq_u32 vcc, v4, v6
v_mad_u32_u24 v5, v5, 19, v3
v_lshlrev_b32 v5, 2, v5
v_add_u32 v6, 141472, v5
v_cndmask_b32 v78, v8, v6, vcc
v_add_u32 v6, s52, v5
v_cndmask_b32 v96, v9, v6, vcc
v_add3_u32 v5, v2, s7, 2
v_mul_u32_u24 v6, 57, v5
v_lshrrev_b32 v6, 10, v6
v_cmp_eq_u32 vcc, v4, v6
v_mad_u32_u24 v5, v5, 19, v3
v_lshlrev_b32 v5, 2, v5
s_cselect_b32 s59, 1, 0
s_waitcnt vmcnt(8)
s_barrier
s_addk_i32 m0, 2048
s_nop 0
buffer_load_dwordx4 v20, s[8:11], s91 offen offset:0 lds
s_addk_i32 m0, 2048
s_nop 0
buffer_load_dwordx4 v21, s[8:11], s91 offen offset:0 lds
s_addk_i32 m0, 2048
s_nop 0
buffer_load_dwordx4 v22, s[8:11], s91 offen offset:0 lds
s_addk_i32 m0, 2048
s_nop 0
buffer_load_dwordx4 v23, s[8:11], s91 offen offset:0 lds
s_cmp_eq_u32 s59, 1
v_add_u32 v6, 141472, v5
v_cndmask_b32 v79, v8, v6, vcc
v_add_u32 v6, s52, v5
v_cndmask_b32 v97, v9, v6, vcc
s_cmp_eq_u32 s51, 0
s_cselect_b64 s[46:47], -1, 0
v_cndmask_b32 v78, v8, v78, s[46:47]
v_cndmask_b32 v96, v10, v96, s[46:47]
v_cndmask_b32 v79, v8, v79, s[46:47]
v_cndmask_b32 v97, v11, v97, s[46:47]
v_lshlrev_b32 v5, 3, v0
v_add_u32 v5, 132256, v5
s_lshl_b32 s53, s58, 9
s_sub_u32 s53, s53, 512
v_add_u32 v107, s53, v5
s_lshl_b32 s53, s51, 9
v_add_u32 v106, s53, v5
v_add_u32 v105, 1024, v106
s_mul_i32 s53, s51, 4608
v_add_u32 v108, s53, v5
s_mul_i32 s7, s51, 2816
v_lshl_add_u32 v102, v0, 2, s7
v_add_u32 v103, s52, v102
v_cmp_gt_u32 vcc, 2912, v102
s_nop 1
v_cndmask_b32 v104, v9, v103, vcc
v_add_u32 v102, 141472, v102
v_mov_b32 v4, 0
v_mov_b32 v10, 147360
v_mov_b32 v11, 1
ds_write_b32 v10, v4
s_waitcnt lgkmcnt(0)
s_cselect_b32 s59, 1, 0
s_waitcnt vmcnt(8)
s_barrier
s_addk_i32 s91, 128
s_cmpk_eq_u32 s91, 1152
s_cselect_b32 s91, 0, s91
s_addk_i32 m0, 2048
s_nop 0
buffer_load_dwordx4 v16, s[8:11], s91 offen offset:0 lds
s_addk_i32 m0, 2048
s_nop 0
buffer_load_dwordx4 v17, s[8:11], s91 offen offset:0 lds
s_addk_i32 m0, 2048
s_nop 0
buffer_load_dwordx4 v18, s[8:11], s91 offen offset:0 lds
s_addk_i32 m0, 2048
s_nop 0
buffer_load_dwordx4 v19, s[8:11], s91 offen offset:0 lds
s_waitcnt vmcnt(8)
s_barrier
s_addk_i32 m0, 2048
s_nop 0
buffer_load_dwordx4 v20, s[8:11], s91 offen offset:0 lds
s_addk_i32 m0, 2048
s_nop 0
buffer_load_dwordx4 v21, s[8:11], s91 offen offset:0 lds
s_addk_i32 m0, 2048
s_nop 0
buffer_load_dwordx4 v22, s[8:11], s91 offen offset:0 lds
s_addk_i32 m0, 2048
s_nop 0
buffer_load_dwordx4 v23, s[8:11], s91 offen offset:0 lds
s_waitcnt vmcnt(8)
s_barrier
s_addk_i32 s91, 128
s_cmpk_eq_u32 s91, 1152
s_cselect_b32 s91, 0, s91
s_addk_i32 m0, 2048
s_nop 0
buffer_load_dwordx4 v16, s[8:11], s91 offen offset:0 lds
s_addk_i32 m0, 2048
s_nop 0
buffer_load_dwordx4 v17, s[8:11], s91 offen offset:0 lds
s_addk_i32 m0, 2048
s_nop 0
buffer_load_dwordx4 v18, s[8:11], s91 offen offset:0 lds
s_addk_i32 m0, 2048
s_nop 0
buffer_load_dwordx4 v19, s[8:11], s91 offen offset:0 lds
s_waitcnt vmcnt(8)
s_barrier
s_addk_i32 m0, 2048
s_nop 0
buffer_load_dwordx4 v20, s[8:11], s91 offen offset:0 lds
s_addk_i32 m0, 2048
s_nop 0
buffer_load_dwordx4 v21, s[8:11], s91 offen offset:0 lds
s_addk_i32 m0, 2048
s_nop 0
buffer_load_dwordx4 v22, s[8:11], s91 offen offset:0 lds
s_addk_i32 m0, 2048
s_nop 0
buffer_load_dwordx4 v23, s[8:11], s91 offen offset:0 lds
s_waitcnt vmcnt(8)
s_barrier
s_waitcnt vmcnt(4)
s_barrier
s_waitcnt vmcnt(0)
s_barrier
s_waitcnt vmcnt(0)
s_barrier
s_barrier
s_load_dword s97, s[20:21], s99
s_mov_b32 s54, 0x20000
L_BX_fk:
s_waitcnt lgkmcnt(0)
s_cmp_lg_u32 s97, 0
s_cbranch_scc1 L_BX_fk_x
s_sub_u32 s54, s54, 1
s_cbranch_scc1 L_BX_fk_x
s_atomic_add s97, s[20:21], s99 glc
s_branch L_BX_fk
L_BX_fk_x:
s_barrier
ds_read_b128 v[112:115], v99 offset:0
ds_read_b128 v[116:119], v100 offset:0
ds_read_b128 v[120:123], v100 offset:4096
ds_read_b128 v[124:127], v99 offset:5120
ds_read_b128 v[128:131], v99 offset:6144
ds_read_b128 v[132:135], v101 offset:9216
ds_read_b128 v[136:139], v101 offset:4096
ds_read_b128 v[140:143], v99 offset:10240
ds_read_b128 v[144:147], v100 offset:10240
ds_read_b128 v[148:151], v100 offset:14336
ds_read_b128 v[152:155], v99 offset:15360
ds_read_b128 v[156:159], v99 offset:16384
ds_read_b128 v[160:163], v101 offset:19456
ds_read_b128 v[164:167], v101 offset:14336
ds_read_b128 v[168:171], v99 offset:20480
ds_read_b128 v[172:175], v100 offset:20480
ds_read_b128 v[176:179], v100 offset:24576
ds_read_b128 v[180:183], v99 offset:25600
ds_read_b128 v[184:187], v99 offset:26624
ds_read_b128 v[188:191], v101 offset:29696
ds_read_b128 v[192:195], v101 offset:24576
ds_read_b128 v[196:199], v99 offset:30720
ds_read_b128 v[200:203], v100 offset:30720
ds_read_b128 v[204:207], v100 offset:34816
ds_read_b128 v[208:211], v99 offset:35840
ds_read_b128 v[212:215], v99 offset:36864
ds_read_b128 v[216:219], v101 offset:39936
ds_read_b128 v[220:223], v101 offset:34816
s_waitcnt lgkmcnt(15)
v_mfma_f32_16x16x32_bf16 v[40:43], v[116:119], v[120:123], 0
v_mfma_f32_16x16x32_bf16 v[44:47], v[112:115], v[124:127], 0
v_mfma_f32_16x16x32_bf16 v[48:51], v[112:115], v[128:131], 0
v_mfma_f32_16x16x32_bf16 v[52:55], v[136:139], v[132:135], 0
v_mfma_f32_16x16x32_bf16 v[56:59], v[132:135], v[112:115], 0
s_waitcnt lgkmcnt(14)
v_mfma_f32_16x16x32_bf16 v[40:43], v[144:147], v[148:151], v[40:43]
v_mfma_f32_16x16x32_bf16 v[44:47], v[140:143], v[152:155], v[44:47]
v_mfma_f32_16x16x32_bf16 v[48:51], v[140:143], v[156:159], v[48:51]
v_mfma_f32_16x16x32_bf16 v[52:55], v[164:167], v[160:163], v[52:55]
v_mfma_f32_16x16x32_bf16 v[56:59], v[160:163], v[140:143], v[56:59]
s_waitcnt lgkmcnt(7)
v_mfma_f32_16x16x32_bf16 v[40:43], v[172:175], v[176:179], v[40:43]
v_mfma_f32_16x16x32_bf16 v[44:47], v[168:171], v[180:183], v[44:47]
v_mfma_f32_16x16x32_bf16 v[48:51], v[168:171], v[184:187], v[48:51]
v_mfma_f32_16x16x32_bf16 v[52:55], v[192:195], v[188:191], v[52:55]
v_mfma_f32_16x16x32_bf16 v[56:59], v[188:191], v[168:171], v[56:59]
s_waitcnt lgkmcnt(0)
v_mfma_f32_16x16x32_bf16 v[40:43], v[200:203], v[204:207], v[40:43]
v_mfma_f32_16x16x32_bf16 v[44:47], v[196:199], v[208:211], v[44:47]
v_mfma_f32_16x16x32_bf16 v[48:51], v[196:199], v[212:215], v[48:51]
v_mfma_f32_16x16x32_bf16 v[52:55], v[220:223], v[216:219], v[52:55]
v_mfma_f32_16x16x32_bf16 v[56:59], v[216:219], v[196:199], v[56:59]
s_nop 3
ds_write_b32 v72, v40 offset:0
ds_write_b32 v72, v41 offset:76
ds_write_b32 v73, v42 offset:0
ds_write_b32 v73, v43 offset:76
ds_write_b32 v74, v44 offset:0
ds_write_b32 v74, v45 offset:76
ds_write_b32 v75, v46 offset:0
ds_write_b32 v75, v47 offset:76
ds_write_b32 v76, v48 offset:0
ds_write_b32 v76, v49 offset:76
ds_write_b32 v77, v50 offset:0
ds_write_b32 v77, v51 offset:76
ds_write_b32 v78, v52 offset:0
ds_write_b32 v78, v53 offset:76
ds_write_b32 v79, v54 offset:0
ds_write_b32 v79, v55 offset:76
ds_write_b32 v98, v56
s_waitcnt lgkmcnt(0)
s_barrier
ds_read_b32 v40, v102 offset:0
ds_read_b32 v41, v102 offset:256
ds_read_b32 v42, v102 offset:512
ds_read_b32 v43, v102 offset:768
ds_read_b32 v44, v102 offset:1024
ds_read_b32 v45, v102 offset:1280
ds_read_b32 v46, v102 offset:1536
ds_read_b32 v47, v102 offset:1792
ds_read_b32 v48, v102 offset:2048
ds_read_b32 v49, v102 offset:2304
ds_read_b32 v50, v102 offset:2560
s_waitcnt lgkmcnt(10)
buffer_atomic_add_f32 v40, v103, s[16:19], 0 offen offset:0
s_waitcnt lgkmcnt(9)
buffer_atomic_add_f32 v41, v103, s[16:19], 0 offen offset:256
s_waitcnt lgkmcnt(8)
buffer_atomic_add_f32 v42, v103, s[16:19], 0 offen offset:512
s_waitcnt lgkmcnt(7)
buffer_atomic_add_f32 v43, v103, s[16:19], 0 offen offset:768
s_waitcnt lgkmcnt(6)
buffer_atomic_add_f32 v44, v103, s[16:19], 0 offen offset:1024
s_waitcnt lgkmcnt(5)
buffer_atomic_add_f32 v45, v103, s[16:19], 0 offen offset:1280
s_waitcnt lgkmcnt(4)
buffer_atomic_add_f32 v46, v103, s[16:19], 0 offen offset:1536
s_waitcnt lgkmcnt(3)
buffer_atomic_add_f32 v47, v103, s[16:19], 0 offen offset:1792
s_waitcnt lgkmcnt(2)
buffer_atomic_add_f32 v48, v103, s[16:19], 0 offen offset:2048
s_waitcnt lgkmcnt(1)
buffer_atomic_add_f32 v49, v103, s[16:19], 0 offen offset:2304
s_waitcnt lgkmcnt(0)
buffer_atomic_add_f32 v50, v104, s[16:19], 0 offen offset:2560
s_barrier
s_waitcnt vmcnt(0)
s_mov_b32 s97, 1
s_atomic_add s97, s[94:95], 0 glc
s_barrier
s_waitcnt lgkmcnt(0)
s_cmp_ge_u32 s97, 31
s_cbranch_scc1 L_BX_kc_x
s_mov_b32 s54, 0x20000
L_BX_kc:
s_mov_b32 s7, 0
s_atomic_add s7, s[94:95], 0 glc
s_waitcnt lgkmcnt(0)
s_sub_u32 s54, s54, 1
s_cbranch_scc1 L_BX_kc_x
s_cmp_ge_u32 s7, 32
s_cbranch_scc0 L_BX_kc
L_BX_kc_x:
buffer_load_dword v112, v80, s[16:19], 0 offen offset:0 sc1
buffer_load_dword v113, v80, s[16:19], 0 offen offset:76 sc1
buffer_load_dword v114, v81, s[16:19], 0 offen offset:0 sc1
buffer_load_dword v115, v81, s[16:19], 0 offen offset:76 sc1
buffer_load_dword v116, v82, s[16:19], 0 offen offset:0 sc1
buffer_load_dword v117, v82, s[16:19], 0 offen offset:76 sc1
buffer_load_dword v118, v83, s[16:19], 0 offen offset:0 sc1
buffer_load_dword v119, v83, s[16:19], 0 offen offset:76 sc1
buffer_load_dword v120, v84, s[16:19], 0 offen offset:0 sc1
buffer_load_dword v121, v84, s[16:19], 0 offen offset:76 sc1
buffer_load_dword v122, v85, s[16:19], 0 offen offset:0 sc1
buffer_load_dword v123, v85, s[16:19], 0 offen offset:76 sc1
buffer_load_dword v124, v86, s[16:19], 0 offen offset:0 sc1
buffer_load_dword v125, v86, s[16:19], 0 offen offset:76 sc1
buffer_load_dword v126, v87, s[16:19], 0 offen offset:0 sc1
buffer_load_dword v127, v87, s[16:19], 0 offen offset:76 sc1
buffer_load_dword v128, v88, s[16:19], 0 offen offset:0 sc1
buffer_load_dword v129, v88, s[16:19], 0 offen offset:76 sc1
buffer_load_dword v130, v89, s[16:19], 0 offen offset:0 sc1
buffer_load_dword v131, v89, s[16:19], 0 offen offset:76 sc1
buffer_load_dword v132, v90, s[16:19], 0 offen offset:0 sc1
buffer_load_dword v133, v90, s[16:19], 0 offen offset:76 sc1
buffer_load_dword v134, v91, s[16:19], 0 offen offset:0 sc1
buffer_load_dword v135, v91, s[16:19], 0 offen offset:76 sc1
buffer_load_dword v136, v92, s[16:19], 0 offen offset:0 sc1
buffer_load_dword v137, v92, s[16:19], 0 offen offset:76 sc1
buffer_load_dword v138, v93, s[16:19], 0 offen offset:0 sc1
buffer_load_dword v139, v93, s[16:19], 0 offen offset:76 sc1
buffer_load_dword v140, v94, s[16:19], 0 offen offset:0 sc1
buffer_load_dword v141, v94, s[16:19], 0 offen offset:76 sc1
buffer_load_dword v142, v95, s[16:19], 0 offen offset:0 sc1
buffer_load_dword v143, v95, s[16:19], 0 offen offset:76 sc1
buffer_load_dword v144, v96, s[16:19], 0 offen offset:0 sc1
buffer_load_dword v145, v96, s[16:19], 0 offen offset:76 sc1
buffer_load_dword v146, v97, s[16:19], 0 offen offset:0 sc1
buffer_load_dword v147, v97, s[16:19], 0 offen offset:76 sc1
v_subrev_u32 v11, 512, v105
s_waitcnt vmcnt(32)
v_cvt_pk_bf16_f32 v40, v112, v113
v_cvt_pk_bf16_f32 v41, v114, v115
ds_write_b64 v11, v[40:41] offset:0
s_waitcnt vmcnt(28)
v_cvt_pk_bf16_f32 v42, v116, v117
v_cvt_pk_bf16_f32 v43, v118, v119
ds_write_b64 v105, v[42:43] offset:2048
s_waitcnt vmcnt(24)
v_cvt_pk_bf16_f32 v44, v120, v121
v_cvt_pk_bf16_f32 v45, v122, v123
ds_write_b64 v105, v[44:45] offset:4608
s_waitcnt vmcnt(20)
v_cvt_pk_bf16_f32 v46, v124, v125
v_cvt_pk_bf16_f32 v47, v126, v127
ds_write_b64 v105, v[46:47] offset:6656
s_waitcnt vmcnt(16)
v_cvt_pk_bf16_f32 v48, v128, v129
v_cvt_pk_bf16_f32 v49, v130, v131
ds_write_b64 v107, v[48:49] offset:0
s_waitcnt vmcnt(12)
v_cvt_pk_bf16_f32 v50, v132, v133
v_cvt_pk_bf16_f32 v51, v134, v135
ds_write_b64 v106, v[50:51] offset:2048
s_waitcnt vmcnt(8)
v_cvt_pk_bf16_f32 v52, v136, v137
v_cvt_pk_bf16_f32 v53, v138, v139
ds_write_b64 v106, v[52:53] offset:4608
s_waitcnt vmcnt(4)
v_cvt_pk_bf16_f32 v54, v140, v141
v_cvt_pk_bf16_f32 v55, v142, v143
ds_write_b64 v106, v[54:55] offset:6656
s_waitcnt vmcnt(0)
v_cvt_pk_bf16_f32 v56, v144, v145
v_cvt_pk_bf16_f32 v57, v146, v147
ds_write_b64 v108, v[56:57] offset:4096
s_waitcnt lgkmcnt(0)
s_barrier
s_load_dword s96, s[20:21], s98
s_mov_b32 s54, 0x20000
L_BX_fo:
s_waitcnt lgkmcnt(0)
s_cmp_lg_u32 s96, 0
s_cbranch_scc1 L_BX_fo_x
s_sub_u32 s54, s54, 1
s_cbranch_scc1 L_BX_fo_x
s_atomic_add s96, s[20:21], s98 glc
s_branch L_BX_fo
L_BX_fo_x:
s_barrier
s_cmp_eq_u32 s3, 6
s_cbranch_scc0 L_BX_na
s_mov_b32 s96, 1
s_atomic_add s96, s[92:93], 0 glc
L_BX_na:
s_cmp_eq_u32 s3, 6
s_cbranch_scc0 L_BX_oc_x
s_waitcnt lgkmcnt(0)
s_cmp_ge_u32 s96, 7
s_cbranch_scc1 L_BX_oc_x
s_mov_b32 s54, 0x20000
L_BX_oc:
s_mov_b32 s7, 0
s_atomic_add s7, s[92:93], 0 glc
s_waitcnt lgkmcnt(0)
s_sub_u32 s54, s54, 1
s_cbranch_scc1 L_BX_oc_x
s_cmp_ge_u32 s7, 8
s_cbranch_scc0 L_BX_oc
L_BX_oc_x:
s_waitcnt vmcnt(0)
s_barrier
s_endpgm
L_BC:
s_mov_b32 s32, 0xffff
s_mov_b32 s33, 0
s_mov_b32 s34, -1
s_mov_b32 s35, 0
s_waitcnt lgkmcnt(0)
s_mov_b32 s24, s40
s_mov_b32 s25, s41
s_mov_b32 s26, 663552
s_mov_b32 s27, 0x20000
s_mov_b32 s28, s44
s_mov_b32 s29, s45
s_mov_b32 s30, 4718592
s_mov_b32 s31, 0x20000
s_mov_b32 s20, s46
s_mov_b32 s21, s47
s_mov_b32 s22, 256
s_mov_b32 s23, 0x20000
s_mov_b32 s16, s48
s_mov_b32 s17, s49
s_mov_b32 s18, 7340032
s_mov_b32 s19, 0x20000
s_or_b32 s7, s4, s3
s_cmp_eq_u32 s7, 0
s_cselect_b32 s55, 1, 0
v_mov_b32 v20, 0
v_mov_b32 v21, 0
v_mov_b32 v22, 0
v_mov_b32 v23, 0
s_cbranch_scc0 L_BC_i1
s_lshl_b32 s7, s6, 4
s_add_u32 s7, s7, s5
s_lshl_b32 s7, s7, 8
s_add_u32 s7, s7, 5505024
v_mov_b32 v24, s7
buffer_store_dword v20, v24, s[16:19], 0 offen sc1
L_BC_i1:
s_or_b32 s7, s5, s3
s_cmp_eq_u32 s7, 0
s_cbranch_scc0 L_BC_i2
s_or_b32 s55, s55, 2
s_mul_i32 s7, s4, 8192
s_add_u32 s7, s7, 5242880
v_lshl_add_u32 v24, v0, 4, s7
s_movk_i32 s50, 0
buffer_store_dwordx4 v[20:23], v24, s[16:19], s50 offen sc1
s_movk_i32 s50, 1024
buffer_store_dwordx4 v[20:23], v24, s[16:19], s50 offen sc1
s_movk_i32 s50, 2048
buffer_store_dwordx4 v[20:23], v24, s[16:19], s50 offen sc1
s_movk_i32 s50, 3072
buffer_store_dwordx4 v[20:23], v24, s[16:19], s50 offen sc1
s_movk_i32 s50, 4096
buffer_store_dwordx4 v[20:23], v24, s[16:19], s50 offen sc1
s_movk_i32 s50, 5120
buffer_store_dwordx4 v[20:23], v24, s[16:19], s50 offen sc1
s_movk_i32 s50, 6144
buffer_store_dwordx4 v[20:23], v24, s[16:19], s50 offen sc1
L_BC_i2:
v_lshrrev_b32 v17, 5, v0
v_lshlrev_b32 v17, 4, v17
v_bfe_u32 v18, v0, 4, 1
v_lshl_add_u32 v17, v18, 2, v17
v_bfe_u32 v18, v0, 2, 2
v_add_u32 v17, v17, v18
v_mul_u32_u24 v17, 160, v17
v_and_b32 v18, 3, v0
v_lshl_add_u32 v1, v18, 3, v17
v_bfe_u32 v18, v0, 1, 1
v_mul_u32_u24 v18, 5120, v18
v_add_u32 v18, 128, v18
v_add_u32 v2, v18, v1
v_lshrrev_b32 v6, 4, v0
v_bfe_u32 v17, v0, 1, 3
v_xor_b32 v6, v6, v17
v_and_b32 v17, 15, v0
v_lshlrev_b32 v17, 7, v17
v_lshl_add_u32 v6, v6, 4, v17
v_xor_b32 v7, 64, v6
s_lshl_b32 s7, s3, 12
s_add_u32 s7, s7, 51360
v_add_u32 v6, s7, v6
v_add_u32 v7, s7, v7
v_and_b32 v17, 15, v0
v_cmp_gt_u32 vcc, 8, v17
v_mov_b32 v18, 0x358637bd
s_mov_b64 s[42:43], vcc
s_mul_i32 s7, s3, 10240
s_add_u32 s7, s7, 100512
v_lshl_add_u32 v10, v0, 4, s7
v_mov_b32 v14, 0xb5c1a2a0
v_mov_b32 v15, v14
s_mov_b32 s56, 0x3fb8aa3b
s_mov_b32 s57, s56
v_mov_b32 v28, v18
v_cndmask_b32 v32, 0, v18, vcc
v_mov_b32 v29, v18
v_cndmask_b32 v33, 0, v18, vcc
v_mov_b32 v30, v18
v_cndmask_b32 v34, 0, v18, vcc
v_mov_b32 v31, v18
v_cndmask_b32 v35, 0, v18, vcc
s_lshl_b32 s7, s5, 3
s_lshl_b32 s53, s3, 1
s_add_u32 s7, s7, s53
s_mul_i32 s7, s7, 18432
s_mul_i32 s53, s6, 2359296
s_add_u32 s58, s7, s53
s_lshl_b32 s53, s4, 11
s_add_u32 s53, s53, s58
v_lshl_add_u32 v8, v0, 4, s53
s_lshr_b32 s53, s4, 2
s_add_u32 s53, s53, 16
s_lshl_b32 s53, s53, 10
s_add_u32 s7, s58, s53
s_and_b32 s53, s4, 3
s_lshl_b32 s53, s53, 8
s_add_u32 s7, s7, s53
v_and_b32 v9, 15, v0
v_lshlrev_b32 v9, 4, v9
v_bfe_u32 v17, v0, 4, 1
v_lshl_add_u32 v9, v17, 3, v9
v_add_u32 v9, s7, v9
v_mov_b32 v17, 0x80000000
v_cndmask_b32 v9, v9, v17, s[34:35]
s_barrier
ds_read_b128 v[52:55], v6 offset:0
ds_read_b128 v[56:59], v6 offset:2048
ds_read_b64_tr_b16 v[148:149], v1 offset:0
ds_read_b64_tr_b16 v[150:151], v1 offset:1280
ds_read_b64_tr_b16 v[152:153], v1 offset:32
ds_read_b64_tr_b16 v[154:155], v1 offset:1312
ds_read_b64_tr_b16 v[156:157], v1 offset:64
ds_read_b64_tr_b16 v[158:159], v1 offset:1344
ds_read_b64_tr_b16 v[160:161], v1 offset:96
ds_read_b64_tr_b16 v[162:163], v1 offset:1376
s_waitcnt lgkmcnt(6)
v_mfma_f32_16x16x32_bf16 v[184:187], v[52:55], v[148:151], v[28:31]
ds_read_b64_tr_b16 v[164:165], v2 offset:0
v_mfma_f32_16x16x32_bf16 v[188:191], v[56:59], v[148:151], v[28:31]
ds_read_b64_tr_b16 v[166:167], v2 offset:1280
s_waitcnt lgkmcnt(6)
v_mfma_f32_16x16x32_bf16 v[192:195], v[52:55], v[152:155], v[28:31]
ds_read_b64_tr_b16 v[168:169], v1 offset:5136
v_mfma_f32_16x16x32_bf16 v[196:199], v[56:59], v[152:155], v[28:31]
ds_read_b64_tr_b16 v[170:171], v1 offset:6416
s_waitcnt lgkmcnt(6)
v_mfma_f32_16x16x32_bf16 v[200:203], v[52:55], v[156:159], v[28:31]
ds_read_b64_tr_b16 v[172:173], v1 offset:5168
v_mfma_f32_16x16x32_bf16 v[204:207], v[56:59], v[156:159], v[28:31]
ds_read_b64_tr_b16 v[174:175], v1 offset:6448
s_waitcnt lgkmcnt(6)
v_mfma_f32_16x16x32_bf16 v[208:211], v[52:55], v[160:163], v[28:31]
ds_read_b64_tr_b16 v[176:177], v1 offset:5200
v_mfma_f32_16x16x32_bf16 v[212:215], v[56:59], v[160:163], v[28:31]
ds_read_b64_tr_b16 v[178:179], v1 offset:6480
s_waitcnt lgkmcnt(6)
v_mfma_f32_16x16x32_bf16 v[216:219], v[52:55], v[164:167], v[32:35]
ds_read_b64_tr_b16 v[180:181], v1 offset:5232
v_mfma_f32_16x16x32_bf16 v[220:223], v[56:59], v[164:167], v[32:35]
ds_read_b64_tr_b16 v[182:183], v1 offset:6512
s_waitcnt lgkmcnt(6)
v_mfma_f32_16x16x32_bf16 v[224:227], v[52:55], v[168:171], 0
s_barrier
ds_read_b128 v[60:63], v7 offset:0
v_mfma_f32_16x16x32_bf16 v[228:231], v[56:59], v[168:171], 0
ds_read_b128 v[64:67], v7 offset:2048
ds_read_b64_tr_b16 v[148:149], v1 offset:10272
s_waitcnt lgkmcnt(7)
v_mfma_f32_16x16x32_bf16 v[232:235], v[52:55], v[172:175], 0
ds_read_b64_tr_b16 v[150:151], v1 offset:11552
v_mfma_f32_16x16x32_bf16 v[236:239], v[56:59], v[172:175], 0
ds_read_b64_tr_b16 v[152:153], v1 offset:10304
s_waitcnt lgkmcnt(7)
v_mfma_f32_16x16x32_bf16 v[240:243], v[52:55], v[176:179], 0
ds_read_b64_tr_b16 v[154:155], v1 offset:11584
v_mfma_f32_16x16x32_bf16 v[244:247], v[56:59], v[176:179], 0
ds_read_b64_tr_b16 v[156:157], v1 offset:10336
s_waitcnt lgkmcnt(7)
v_mfma_f32_16x16x32_bf16 v[248:251], v[52:55], v[180:183], 0
ds_read_b64_tr_b16 v[158:159], v1 offset:11616
v_mfma_f32_16x16x32_bf16 v[252:255], v[56:59], v[180:183], 0
ds_read_b64_tr_b16 v[160:161], v1 offset:10368
s_waitcnt lgkmcnt(5)
v_mfma_f32_16x16x32_bf16 v[184:187], v[60:63], v[148:151], v[184:187]
ds_read_b64_tr_b16 v[162:163], v1 offset:11648
v_mfma_f32_16x16x32_bf16 v[188:191], v[64:67], v[148:151], v[188:191]
ds_read_b64_tr_b16 v[164:165], v2 offset:10272
s_waitcnt lgkmcnt(5)
v_mfma_f32_16x16x32_bf16 v[192:195], v[60:63], v[152:155], v[192:195]
ds_read_b64_tr_b16 v[166:167], v2 offset:11552
v_mfma_f32_16x16x32_bf16 v[196:199], v[64:67], v[152:155], v[196:199]
ds_read_b64_tr_b16 v[168:169], v1 offset:15408
s_waitcnt lgkmcnt(5)
v_mfma_f32_16x16x32_bf16 v[200:203], v[60:63], v[156:159], v[200:203]
ds_read_b64_tr_b16 v[170:171], v1 offset:16688
v_mfma_f32_16x16x32_bf16 v[204:207], v[64:67], v[156:159], v[204:207]
ds_read_b64_tr_b16 v[172:173], v1 offset:15440
s_waitcnt lgkmcnt(5)
v_mfma_f32_16x16x32_bf16 v[208:211], v[60:63], v[160:163], v[208:211]
ds_read_b64_tr_b16 v[174:175], v1 offset:16720
v_mfma_f32_16x16x32_bf16 v[212:215], v[64:67], v[160:163], v[212:215]
ds_read_b64_tr_b16 v[176:177], v1 offset:15472
s_waitcnt lgkmcnt(5)
v_mfma_f32_16x16x32_bf16 v[216:219], v[60:63], v[164:167], v[216:219]
ds_read_b64_tr_b16 v[178:179], v1 offset:16752
v_mfma_f32_16x16x32_bf16 v[220:223], v[64:67], v[164:167], v[220:223]
ds_read_b64_tr_b16 v[180:181], v1 offset:15504
s_waitcnt lgkmcnt(5)
v_mfma_f32_16x16x32_bf16 v[224:227], v[60:63], v[168:171], v[224:227]
ds_read_b64_tr_b16 v[182:183], v1 offset:16784
v_mfma_f32_16x16x32_bf16 v[228:231], v[64:67], v[168:171], v[228:231]
s_barrier
ds_read_b128 v[68:71], v6 offset:16384
ds_read_b128 v[72:75], v6 offset:18432
s_waitcnt lgkmcnt(6)
v_mfma_f32_16x16x32_bf16 v[232:235], v[60:63], v[172:175], v[232:235]
ds_read_b64_tr_b16 v[148:149], v1 offset:20544
v_mfma_f32_16x16x32_bf16 v[236:239], v[64:67], v[172:175], v[236:239]
ds_read_b64_tr_b16 v[150:151], v1 offset:21824
ds_read_b64_tr_b16 v[152:153], v1 offset:20576
s_waitcnt lgkmcnt(7)
v_mfma_f32_16x16x32_bf16 v[240:243], v[60:63], v[176:179], v[240:243]
ds_read_b64_tr_b16 v[154:155], v1 offset:21856
v_mfma_f32_16x16x32_bf16 v[244:247], v[64:67], v[176:179], v[244:247]
ds_read_b64_tr_b16 v[156:157], v1 offset:20608
s_waitcnt lgkmcnt(7)
v_mfma_f32_16x16x32_bf16 v[248:251], v[60:63], v[180:183], v[248:251]
ds_read_b64_tr_b16 v[158:159], v1 offset:21888
v_mfma_f32_16x16x32_bf16 v[252:255], v[64:67], v[180:183], v[252:255]
ds_read_b64_tr_b16 v[160:161], v1 offset:20640
s_waitcnt vmcnt(0)
s_cmp_eq_u32 s55, 0
s_cbranch_scc1 L_BC_f2
v_mov_b32 v20, 1
s_bitcmp1_b32 s55, 0
s_cbranch_scc0 L_BC_f1
s_lshl_b32 s7, s6, 4
s_add_u32 s7, s7, s5
s_lshl_b32 s7, s7, 2
s_add_u32 s7, s7, 32
v_mov_b32 v24, s7
buffer_store_dword v20, v24, s[20:23], 0 offen sc1
L_BC_f1:
s_bitcmp1_b32 s55, 1
s_cbranch_scc0 L_BC_f2
s_lshl_b32 s7, s4, 2
v_mov_b32 v25, s7
buffer_store_dword v20, v25, s[20:23], 0 offen sc1
L_BC_f2:
s_waitcnt lgkmcnt(5)
v_mfma_f32_16x16x32_bf16 v[184:187], v[68:71], v[148:151], v[184:187]
ds_read_b64_tr_b16 v[162:163], v1 offset:21920
v_mfma_f32_16x16x32_bf16 v[188:191], v[72:75], v[148:151], v[188:191]
ds_read_b64_tr_b16 v[164:165], v2 offset:20544
s_waitcnt lgkmcnt(5)
v_mfma_f32_16x16x32_bf16 v[192:195], v[68:71], v[152:155], v[192:195]
ds_read_b64_tr_b16 v[166:167], v2 offset:21824
v_mfma_f32_16x16x32_bf16 v[196:199], v[72:75], v[152:155], v[196:199]
ds_read_b64_tr_b16 v[168:169], v1 offset:25680
s_waitcnt lgkmcnt(5)
v_mfma_f32_16x16x32_bf16 v[200:203], v[68:71], v[156:159], v[200:203]
ds_read_b64_tr_b16 v[170:171], v1 offset:26960
v_mfma_f32_16x16x32_bf16 v[204:207], v[72:75], v[156:159], v[204:207]
ds_read_b64_tr_b16 v[172:173], v1 offset:25712
s_waitcnt lgkmcnt(5)
v_mfma_f32_16x16x32_bf16 v[208:211], v[68:71], v[160:163], v[208:211]
ds_read_b64_tr_b16 v[174:175], v1 offset:26992
v_mfma_f32_16x16x32_bf16 v[212:215], v[72:75], v[160:163], v[212:215]
ds_read_b64_tr_b16 v[176:177], v1 offset:25744
s_waitcnt lgkmcnt(5)
v_mfma_f32_16x16x32_bf16 v[216:219], v[68:71], v[164:167], v[216:219]
ds_read_b64_tr_b16 v[178:179], v1 offset:27024
v_mfma_f32_16x16x32_bf16 v[220:223], v[72:75], v[164:167], v[220:223]
ds_read_b64_tr_b16 v[180:181], v1 offset:25776
s_waitcnt lgkmcnt(5)
v_mfma_f32_16x16x32_bf16 v[224:227], v[68:71], v[168:171], v[224:227]
ds_read_b64_tr_b16 v[182:183], v1 offset:27056
v_mfma_f32_16x16x32_bf16 v[228:231], v[72:75], v[168:171], v[228:231]
s_barrier
ds_read_b128 v[76:79], v7 offset:16384
ds_read_b128 v[80:83], v7 offset:18432
s_waitcnt lgkmcnt(6)
v_mfma_f32_16x16x32_bf16 v[232:235], v[68:71], v[172:175], v[232:235]
ds_read_b64_tr_b16 v[148:149], v1 offset:30816
v_mfma_f32_16x16x32_bf16 v[236:239], v[72:75], v[172:175], v[236:239]
ds_read_b64_tr_b16 v[150:151], v1 offset:32096
ds_read_b64_tr_b16 v[152:153], v1 offset:30848
s_waitcnt lgkmcnt(7)
v_mfma_f32_16x16x32_bf16 v[240:243], v[68:71], v[176:179], v[240:243]
ds_read_b64_tr_b16 v[154:155], v1 offset:32128
v_mfma_f32_16x16x32_bf16 v[244:247], v[72:75], v[176:179], v[244:247]
ds_read_b64_tr_b16 v[156:157], v1 offset:30880
s_waitcnt lgkmcnt(7)
v_mfma_f32_16x16x32_bf16 v[248:251], v[68:71], v[180:183], v[248:251]
ds_read_b64_tr_b16 v[158:159], v1 offset:32160
v_mfma_f32_16x16x32_bf16 v[252:255], v[72:75], v[180:183], v[252:255]
ds_read_b64_tr_b16 v[160:161], v1 offset:30912
s_waitcnt lgkmcnt(5)
v_mfma_f32_16x16x32_bf16 v[184:187], v[76:79], v[148:151], v[184:187]
ds_read_b64_tr_b16 v[162:163], v1 offset:32192
v_mfma_f32_16x16x32_bf16 v[188:191], v[80:83], v[148:151], v[188:191]
ds_read_b64_tr_b16 v[164:165], v2 offset:30816
s_waitcnt lgkmcnt(5)
v_mfma_f32_16x16x32_bf16 v[192:195], v[76:79], v[152:155], v[192:195]
ds_read_b64_tr_b16 v[166:167], v2 offset:32096
v_mfma_f32_16x16x32_bf16 v[196:199], v[80:83], v[152:155], v[196:199]
ds_read_b64_tr_b16 v[168:169], v1 offset:35952
s_waitcnt lgkmcnt(5)
v_mfma_f32_16x16x32_bf16 v[200:203], v[76:79], v[156:159], v[200:203]
ds_read_b64_tr_b16 v[170:171], v1 offset:37232
v_mfma_f32_16x16x32_bf16 v[204:207], v[80:83], v[156:159], v[204:207]
ds_read_b64_tr_b16 v[172:173], v1 offset:35984
s_waitcnt lgkmcnt(5)
v_mfma_f32_16x16x32_bf16 v[208:211], v[76:79], v[160:163], v[208:211]
ds_read_b64_tr_b16 v[174:175], v1 offset:37264
v_mfma_f32_16x16x32_bf16 v[212:215], v[80:83], v[160:163], v[212:215]
ds_read_b64_tr_b16 v[176:177], v1 offset:36016
s_waitcnt lgkmcnt(5)
v_mfma_f32_16x16x32_bf16 v[216:219], v[76:79], v[164:167], v[216:219]
ds_read_b64_tr_b16 v[178:179], v1 offset:37296
v_mfma_f32_16x16x32_bf16 v[220:223], v[80:83], v[164:167], v[220:223]
ds_read_b64_tr_b16 v[180:181], v1 offset:36048
s_waitcnt lgkmcnt(5)
v_mfma_f32_16x16x32_bf16 v[224:227], v[76:79], v[168:171], v[224:227]
ds_read_b64_tr_b16 v[182:183], v1 offset:37328
v_mfma_f32_16x16x32_bf16 v[228:231], v[80:83], v[168:171], v[228:231]
s_barrier
ds_read_b128 v[84:87], v6 offset:32768
ds_read_b128 v[88:91], v6 offset:34816
s_waitcnt lgkmcnt(6)
v_mfma_f32_16x16x32_bf16 v[232:235], v[76:79], v[172:175], v[232:235]
ds_read_b64_tr_b16 v[148:149], v1 offset:41088
v_mfma_f32_16x16x32_bf16 v[236:239], v[80:83], v[172:175], v[236:239]
ds_read_b64_tr_b16 v[150:151], v1 offset:42368
ds_read_b64_tr_b16 v[152:153], v1 offset:41120
s_waitcnt lgkmcnt(7)
v_mfma_f32_16x16x32_bf16 v[240:243], v[76:79], v[176:179], v[240:243]
ds_read_b64_tr_b16 v[154:155], v1 offset:42400
v_mfma_f32_16x16x32_bf16 v[244:247], v[80:83], v[176:179], v[244:247]
ds_read_b64_tr_b16 v[156:157], v1 offset:41152
s_waitcnt lgkmcnt(7)
v_mfma_f32_16x16x32_bf16 v[248:251], v[76:79], v[180:183], v[248:251]
ds_read_b64_tr_b16 v[158:159], v1 offset:42432
v_mfma_f32_16x16x32_bf16 v[252:255], v[80:83], v[180:183], v[252:255]
ds_read_b64_tr_b16 v[160:161], v1 offset:41184
s_waitcnt lgkmcnt(5)
v_mfma_f32_16x16x32_bf16 v[184:187], v[84:87], v[148:151], v[184:187]
ds_read_b64_tr_b16 v[162:163], v1 offset:42464
v_mfma_f32_16x16x32_bf16 v[188:191], v[88:91], v[148:151], v[188:191]
ds_read_b64_tr_b16 v[164:165], v2 offset:41088
s_waitcnt lgkmcnt(5)
v_mfma_f32_16x16x32_bf16 v[192:195], v[84:87], v[152:155], v[192:195]
ds_read_b64_tr_b16 v[166:167], v2 offset:42368
v_mfma_f32_16x16x32_bf16 v[196:199], v[88:91], v[152:155], v[196:199]
ds_read_b64_tr_b16 v[168:169], v1 offset:46224
s_waitcnt lgkmcnt(5)
v_mfma_f32_16x16x32_bf16 v[200:203], v[84:87], v[156:159], v[200:203]
ds_read_b64_tr_b16 v[170:171], v1 offset:47504
v_mfma_f32_16x16x32_bf16 v[204:207], v[88:91], v[156:159], v[204:207]
ds_read_b64_tr_b16 v[172:173], v1 offset:46256
s_waitcnt lgkmcnt(5)
v_mfma_f32_16x16x32_bf16 v[208:211], v[84:87], v[160:163], v[208:211]
ds_read_b64_tr_b16 v[174:175], v1 offset:47536
v_mfma_f32_16x16x32_bf16 v[212:215], v[88:91], v[160:163], v[212:215]
ds_read_b64_tr_b16 v[176:177], v1 offset:46288
s_waitcnt lgkmcnt(5)
v_mfma_f32_16x16x32_bf16 v[216:219], v[84:87], v[164:167], v[216:219]
ds_read_b64_tr_b16 v[178:179], v1 offset:47568
v_mfma_f32_16x16x32_bf16 v[220:223], v[88:91], v[164:167], v[220:223]
ds_read_b64_tr_b16 v[180:181], v1 offset:46320
s_waitcnt lgkmcnt(5)
v_mfma_f32_16x16x32_bf16 v[224:227], v[84:87], v[168:171], v[224:227]
ds_read_b64_tr_b16 v[182:183], v1 offset:47600
v_mfma_f32_16x16x32_bf16 v[228:231], v[88:91], v[168:171], v[228:231]
s_barrier
ds_read_b128 v[92:95], v7 offset:32768
ds_read_b128 v[96:99], v7 offset:34816
s_waitcnt lgkmcnt(6)
v_mfma_f32_16x16x32_bf16 v[232:235], v[84:87], v[172:175], v[232:235]
ds_read_b64_tr_b16 v[148:149], v1 offset:0
v_mfma_f32_16x16x32_bf16 v[236:239], v[88:91], v[172:175], v[236:239]
ds_read_b64_tr_b16 v[150:151], v1 offset:1280
ds_read_b64_tr_b16 v[152:153], v1 offset:32
s_waitcnt lgkmcnt(7)
v_mfma_f32_16x16x32_bf16 v[240:243], v[84:87], v[176:179], v[240:243]
ds_read_b64_tr_b16 v[154:155], v1 offset:1312
v_mfma_f32_16x16x32_bf16 v[244:247], v[88:91], v[176:179], v[244:247]
ds_read_b64_tr_b16 v[156:157], v1 offset:64
s_waitcnt lgkmcnt(7)
v_mfma_f32_16x16x32_bf16 v[248:251], v[84:87], v[180:183], v[248:251]
ds_read_b64_tr_b16 v[158:159], v1 offset:1344
v_mfma_f32_16x16x32_bf16 v[252:255], v[88:91], v[180:183], v[252:255]
ds_read_b64_tr_b16 v[160:161], v1 offset:96
s_waitcnt lgkmcnt(5)
v_mfma_f32_16x16x32_bf16 v[184:187], v[92:95], v[148:151], v[184:187]
ds_read_b64_tr_b16 v[162:163], v1 offset:1376
v_mfma_f32_16x16x32_bf16 v[188:191], v[96:99], v[148:151], v[188:191]
ds_read_b64_tr_b16 v[164:165], v2 offset:0
s_waitcnt lgkmcnt(5)
v_mfma_f32_16x16x32_bf16 v[192:195], v[92:95], v[152:155], v[192:195]
ds_read_b64_tr_b16 v[166:167], v2 offset:1280
v_mfma_f32_16x16x32_bf16 v[196:199], v[96:99], v[152:155], v[196:199]
ds_read_b64_tr_b16 v[168:169], v1 offset:5136
s_waitcnt lgkmcnt(5)
v_mfma_f32_16x16x32_bf16 v[200:203], v[92:95], v[156:159], v[200:203]
ds_read_b64_tr_b16 v[170:171], v1 offset:6416
v_mfma_f32_16x16x32_bf16 v[204:207], v[96:99], v[156:159], v[204:207]
ds_read_b64_tr_b16 v[172:173], v1 offset:5168
s_waitcnt lgkmcnt(5)
v_mfma_f32_16x16x32_bf16 v[208:211], v[92:95], v[160:163], v[208:211]
ds_read_b64_tr_b16 v[174:175], v1 offset:6448
v_mfma_f32_16x16x32_bf16 v[212:215], v[96:99], v[160:163], v[212:215]
ds_read_b64_tr_b16 v[176:177], v1 offset:5200
s_waitcnt lgkmcnt(5)
v_mfma_f32_16x16x32_bf16 v[216:219], v[92:95], v[164:167], v[216:219]
ds_read_b64_tr_b16 v[178:179], v1 offset:6480
v_mfma_f32_16x16x32_bf16 v[220:223], v[96:99], v[164:167], v[220:223]
ds_read_b64_tr_b16 v[180:181], v1 offset:5232
s_waitcnt lgkmcnt(5)
v_mfma_f32_16x16x32_bf16 v[224:227], v[92:95], v[168:171], v[224:227]
ds_read_b64_tr_b16 v[182:183], v1 offset:6512
v_mfma_f32_16x16x32_bf16 v[228:231], v[96:99], v[168:171], v[228:231]
s_barrier
ds_read_b128 v[100:103], v6 offset:0
ds_read_b128 v[104:107], v6 offset:2048
s_waitcnt lgkmcnt(6)
v_mfma_f32_16x16x32_bf16 v[232:235], v[92:95], v[172:175], v[232:235]
ds_read_b64_tr_b16 v[148:149], v1 offset:10272
v_mfma_f32_16x16x32_bf16 v[236:239], v[96:99], v[172:175], v[236:239]
ds_read_b64_tr_b16 v[150:151], v1 offset:11552
ds_read_b64_tr_b16 v[152:153], v1 offset:10304
s_waitcnt lgkmcnt(7)
v_mfma_f32_16x16x32_bf16 v[240:243], v[92:95], v[176:179], v[240:243]
ds_read_b64_tr_b16 v[154:155], v1 offset:11584
v_mfma_f32_16x16x32_bf16 v[244:247], v[96:99], v[176:179], v[244:247]
ds_read_b64_tr_b16 v[156:157], v1 offset:10336
s_waitcnt lgkmcnt(7)
v_mfma_f32_16x16x32_bf16 v[248:251], v[92:95], v[180:183], v[248:251]
ds_read_b64_tr_b16 v[158:159], v1 offset:11616
v_mfma_f32_16x16x32_bf16 v[252:255], v[96:99], v[180:183], v[252:255]
ds_read_b64_tr_b16 v[160:161], v1 offset:10368
s_waitcnt lgkmcnt(5)
v_mfma_f32_16x16x32_bf16 v[184:187], v[100:103], v[148:151], v[184:187]
ds_read_b64_tr_b16 v[162:163], v1 offset:11648
v_mfma_f32_16x16x32_bf16 v[188:191], v[104:107], v[148:151], v[188:191]
ds_read_b64_tr_b16 v[164:165], v2 offset:10272
s_waitcnt lgkmcnt(5)
v_mfma_f32_16x16x32_bf16 v[192:195], v[100:103], v[152:155], v[192:195]
ds_read_b64_tr_b16 v[166:167], v2 offset:11552
v_mfma_f32_16x16x32_bf16 v[196:199], v[104:107], v[152:155], v[196:199]
ds_read_b64_tr_b16 v[168:169], v1 offset:15408
s_waitcnt lgkmcnt(5)
v_mfma_f32_16x16x32_bf16 v[200:203], v[100:103], v[156:159], v[200:203]
ds_read_b64_tr_b16 v[170:171], v1 offset:16688
v_mfma_f32_16x16x32_bf16 v[204:207], v[104:107], v[156:159], v[204:207]
ds_read_b64_tr_b16 v[172:173], v1 offset:15440
s_waitcnt lgkmcnt(5)
v_mfma_f32_16x16x32_bf16 v[208:211], v[100:103], v[160:163], v[208:211]
ds_read_b64_tr_b16 v[174:175], v1 offset:16720
v_mfma_f32_16x16x32_bf16 v[212:215], v[104:107], v[160:163], v[212:215]
ds_read_b64_tr_b16 v[176:177], v1 offset:15472
s_waitcnt lgkmcnt(5)
v_mfma_f32_16x16x32_bf16 v[216:219], v[100:103], v[164:167], v[216:219]
ds_read_b64_tr_b16 v[178:179], v1 offset:16752
v_mfma_f32_16x16x32_bf16 v[220:223], v[104:107], v[164:167], v[220:223]
ds_read_b64_tr_b16 v[180:181], v1 offset:15504
s_waitcnt lgkmcnt(5)
v_mfma_f32_16x16x32_bf16 v[224:227], v[100:103], v[168:171], v[224:227]
ds_read_b64_tr_b16 v[182:183], v1 offset:16784
v_mfma_f32_16x16x32_bf16 v[228:231], v[104:107], v[168:171], v[228:231]
s_barrier
ds_read_b128 v[108:111], v7 offset:0
ds_read_b128 v[112:115], v7 offset:2048
s_waitcnt lgkmcnt(6)
v_mfma_f32_16x16x32_bf16 v[232:235], v[100:103], v[172:175], v[232:235]
ds_read_b64_tr_b16 v[148:149], v1 offset:20544
v_mfma_f32_16x16x32_bf16 v[236:239], v[104:107], v[172:175], v[236:239]
ds_read_b64_tr_b16 v[150:151], v1 offset:21824
ds_read_b64_tr_b16 v[152:153], v1 offset:20576
s_waitcnt lgkmcnt(7)
v_mfma_f32_16x16x32_bf16 v[240:243], v[100:103], v[176:179], v[240:243]
ds_read_b64_tr_b16 v[154:155], v1 offset:21856
v_mfma_f32_16x16x32_bf16 v[244:247], v[104:107], v[176:179], v[244:247]
ds_read_b64_tr_b16 v[156:157], v1 offset:20608
s_waitcnt lgkmcnt(7)
v_mfma_f32_16x16x32_bf16 v[248:251], v[100:103], v[180:183], v[248:251]
ds_read_b64_tr_b16 v[158:159], v1 offset:21888
v_mfma_f32_16x16x32_bf16 v[252:255], v[104:107], v[180:183], v[252:255]
ds_read_b64_tr_b16 v[160:161], v1 offset:20640
s_waitcnt lgkmcnt(5)
v_mfma_f32_16x16x32_bf16 v[184:187], v[108:111], v[148:151], v[184:187]
ds_read_b64_tr_b16 v[162:163], v1 offset:21920
v_mfma_f32_16x16x32_bf16 v[188:191], v[112:115], v[148:151], v[188:191]
ds_read_b64_tr_b16 v[164:165], v2 offset:20544
s_waitcnt lgkmcnt(5)
v_mfma_f32_16x16x32_bf16 v[192:195], v[108:111], v[152:155], v[192:195]
ds_read_b64_tr_b16 v[166:167], v2 offset:21824
v_mfma_f32_16x16x32_bf16 v[196:199], v[112:115], v[152:155], v[196:199]
ds_read_b64_tr_b16 v[168:169], v1 offset:25680
s_waitcnt lgkmcnt(5)
v_mfma_f32_16x16x32_bf16 v[200:203], v[108:111], v[156:159], v[200:203]
ds_read_b64_tr_b16 v[170:171], v1 offset:26960
v_mfma_f32_16x16x32_bf16 v[204:207], v[112:115], v[156:159], v[204:207]
ds_read_b64_tr_b16 v[172:173], v1 offset:25712
s_waitcnt lgkmcnt(5)
v_mfma_f32_16x16x32_bf16 v[208:211], v[108:111], v[160:163], v[208:211]
ds_read_b64_tr_b16 v[174:175], v1 offset:26992
v_mfma_f32_16x16x32_bf16 v[212:215], v[112:115], v[160:163], v[212:215]
ds_read_b64_tr_b16 v[176:177], v1 offset:25744
s_waitcnt lgkmcnt(5)
v_mfma_f32_16x16x32_bf16 v[216:219], v[108:111], v[164:167], v[216:219]
ds_read_b64_tr_b16 v[178:179], v1 offset:27024
v_mfma_f32_16x16x32_bf16 v[220:223], v[112:115], v[164:167], v[220:223]
ds_read_b64_tr_b16 v[180:181], v1 offset:25776
s_waitcnt lgkmcnt(5)
v_mfma_f32_16x16x32_bf16 v[224:227], v[108:111], v[168:171], v[224:227]
ds_read_b64_tr_b16 v[182:183], v1 offset:27056
v_mfma_f32_16x16x32_bf16 v[228:231], v[112:115], v[168:171], v[228:231]
s_barrier
ds_read_b128 v[116:119], v6 offset:16384
ds_read_b128 v[120:123], v6 offset:18432
s_waitcnt lgkmcnt(6)
v_mfma_f32_16x16x32_bf16 v[232:235], v[108:111], v[172:175], v[232:235]
ds_read_b64_tr_b16 v[148:149], v1 offset:30816
v_mfma_f32_16x16x32_bf16 v[236:239], v[112:115], v[172:175], v[236:239]
ds_read_b64_tr_b16 v[150:151], v1 offset:32096
ds_read_b64_tr_b16 v[152:153], v1 offset:30848
s_waitcnt lgkmcnt(7)
v_mfma_f32_16x16x32_bf16 v[240:243], v[108:111], v[176:179], v[240:243]
ds_read_b64_tr_b16 v[154:155], v1 offset:32128
v_mfma_f32_16x16x32_bf16 v[244:247], v[112:115], v[176:179], v[244:247]
ds_read_b64_tr_b16 v[156:157], v1 offset:30880
s_waitcnt lgkmcnt(7)
v_mfma_f32_16x16x32_bf16 v[248:251], v[108:111], v[180:183], v[248:251]
ds_read_b64_tr_b16 v[158:159], v1 offset:32160
v_mfma_f32_16x16x32_bf16 v[252:255], v[112:115], v[180:183], v[252:255]
ds_read_b64_tr_b16 v[160:161], v1 offset:30912
s_waitcnt lgkmcnt(5)
v_mfma_f32_16x16x32_bf16 v[184:187], v[116:119], v[148:151], v[184:187]
ds_read_b64_tr_b16 v[162:163], v1 offset:32192
v_mfma_f32_16x16x32_bf16 v[188:191], v[120:123], v[148:151], v[188:191]
ds_read_b64_tr_b16 v[164:165], v2 offset:30816
s_waitcnt lgkmcnt(5)
v_mfma_f32_16x16x32_bf16 v[192:195], v[116:119], v[152:155], v[192:195]
ds_read_b64_tr_b16 v[166:167], v2 offset:32096
v_mfma_f32_16x16x32_bf16 v[196:199], v[120:123], v[152:155], v[196:199]
ds_read_b64_tr_b16 v[168:169], v1 offset:35952
s_waitcnt lgkmcnt(5)
v_mfma_f32_16x16x32_bf16 v[200:203], v[116:119], v[156:159], v[200:203]
ds_read_b64_tr_b16 v[170:171], v1 offset:37232
v_mfma_f32_16x16x32_bf16 v[204:207], v[120:123], v[156:159], v[204:207]
ds_read_b64_tr_b16 v[172:173], v1 offset:35984
s_waitcnt lgkmcnt(5)
v_mfma_f32_16x16x32_bf16 v[208:211], v[116:119], v[160:163], v[208:211]
ds_read_b64_tr_b16 v[174:175], v1 offset:37264
v_mfma_f32_16x16x32_bf16 v[212:215], v[120:123], v[160:163], v[212:215]
ds_read_b64_tr_b16 v[176:177], v1 offset:36016
s_waitcnt lgkmcnt(5)
v_mfma_f32_16x16x32_bf16 v[216:219], v[116:119], v[164:167], v[216:219]
ds_read_b64_tr_b16 v[178:179], v1 offset:37296
v_mfma_f32_16x16x32_bf16 v[220:223], v[120:123], v[164:167], v[220:223]
ds_read_b64_tr_b16 v[180:181], v1 offset:36048
s_waitcnt lgkmcnt(5)
v_mfma_f32_16x16x32_bf16 v[224:227], v[116:119], v[168:171], v[224:227]
ds_read_b64_tr_b16 v[182:183], v1 offset:37328
v_mfma_f32_16x16x32_bf16 v[228:231], v[120:123], v[168:171], v[228:231]
s_barrier
ds_read_b128 v[124:127], v7 offset:16384
ds_read_b128 v[128:131], v7 offset:18432
s_waitcnt lgkmcnt(6)
v_mfma_f32_16x16x32_bf16 v[232:235], v[116:119], v[172:175], v[232:235]
ds_read_b64_tr_b16 v[148:149], v1 offset:41088
v_mfma_f32_16x16x32_bf16 v[236:239], v[120:123], v[172:175], v[236:239]
ds_read_b64_tr_b16 v[150:151], v1 offset:42368
ds_read_b64_tr_b16 v[152:153], v1 offset:41120
s_waitcnt lgkmcnt(7)
v_mfma_f32_16x16x32_bf16 v[240:243], v[116:119], v[176:179], v[240:243]
ds_read_b64_tr_b16 v[154:155], v1 offset:42400
v_mfma_f32_16x16x32_bf16 v[244:247], v[120:123], v[176:179], v[244:247]
ds_read_b64_tr_b16 v[156:157], v1 offset:41152
s_waitcnt lgkmcnt(7)
v_mfma_f32_16x16x32_bf16 v[248:251], v[116:119], v[180:183], v[248:251]
ds_read_b64_tr_b16 v[158:159], v1 offset:42432
v_mfma_f32_16x16x32_bf16 v[252:255], v[120:123], v[180:183], v[252:255]
ds_read_b64_tr_b16 v[160:161], v1 offset:41184
s_waitcnt lgkmcnt(5)
v_mfma_f32_16x16x32_bf16 v[184:187], v[124:127], v[148:151], v[184:187]
ds_read_b64_tr_b16 v[162:163], v1 offset:42464
v_mfma_f32_16x16x32_bf16 v[188:191], v[128:131], v[148:151], v[188:191]
ds_read_b64_tr_b16 v[164:165], v2 offset:41088
s_waitcnt lgkmcnt(5)
v_mfma_f32_16x16x32_bf16 v[192:195], v[124:127], v[152:155], v[192:195]
ds_read_b64_tr_b16 v[166:167], v2 offset:42368
v_mfma_f32_16x16x32_bf16 v[196:199], v[128:131], v[152:155], v[196:199]
ds_read_b64_tr_b16 v[168:169], v1 offset:46224
s_waitcnt lgkmcnt(5)
v_mfma_f32_16x16x32_bf16 v[200:203], v[124:127], v[156:159], v[200:203]
ds_read_b64_tr_b16 v[170:171], v1 offset:47504
v_mfma_f32_16x16x32_bf16 v[204:207], v[128:131], v[156:159], v[204:207]
ds_read_b64_tr_b16 v[172:173], v1 offset:46256
s_waitcnt lgkmcnt(5)
v_mfma_f32_16x16x32_bf16 v[208:211], v[124:127], v[160:163], v[208:211]
ds_read_b64_tr_b16 v[174:175], v1 offset:47536
v_mfma_f32_16x16x32_bf16 v[212:215], v[128:131], v[160:163], v[212:215]
ds_read_b64_tr_b16 v[176:177], v1 offset:46288
s_waitcnt lgkmcnt(5)
v_mfma_f32_16x16x32_bf16 v[216:219], v[124:127], v[164:167], v[216:219]
ds_read_b64_tr_b16 v[178:179], v1 offset:47568
v_mfma_f32_16x16x32_bf16 v[220:223], v[128:131], v[164:167], v[220:223]
ds_read_b64_tr_b16 v[180:181], v1 offset:46320
s_waitcnt lgkmcnt(5)
v_mfma_f32_16x16x32_bf16 v[224:227], v[124:127], v[168:171], v[224:227]
ds_read_b64_tr_b16 v[182:183], v1 offset:47600
v_mfma_f32_16x16x32_bf16 v[228:231], v[128:131], v[168:171], v[228:231]
s_barrier
ds_read_b128 v[132:135], v6 offset:32768
ds_read_b128 v[136:139], v6 offset:34816
s_waitcnt lgkmcnt(6)
v_mfma_f32_16x16x32_bf16 v[232:235], v[124:127], v[172:175], v[232:235]
ds_read_b64_tr_b16 v[148:149], v1 offset:0
v_mfma_f32_16x16x32_bf16 v[236:239], v[128:131], v[172:175], v[236:239]
ds_read_b64_tr_b16 v[150:151], v1 offset:1280
ds_read_b64_tr_b16 v[152:153], v1 offset:32
s_waitcnt lgkmcnt(7)
v_mfma_f32_16x16x32_bf16 v[240:243], v[124:127], v[176:179], v[240:243]
ds_read_b64_tr_b16 v[154:155], v1 offset:1312
v_mfma_f32_16x16x32_bf16 v[244:247], v[128:131], v[176:179], v[244:247]
ds_read_b64_tr_b16 v[156:157], v1 offset:64
s_waitcnt lgkmcnt(7)
v_mfma_f32_16x16x32_bf16 v[248:251], v[124:127], v[180:183], v[248:251]
ds_read_b64_tr_b16 v[158:159], v1 offset:1344
v_mfma_f32_16x16x32_bf16 v[252:255], v[128:131], v[180:183], v[252:255]
ds_read_b64_tr_b16 v[160:161], v1 offset:96
s_waitcnt lgkmcnt(5)
v_mfma_f32_16x16x32_bf16 v[184:187], v[132:135], v[148:151], v[184:187]
ds_read_b64_tr_b16 v[162:163], v1 offset:1376
v_mfma_f32_16x16x32_bf16 v[188:191], v[136:139], v[148:151], v[188:191]
ds_read_b64_tr_b16 v[164:165], v2 offset:0
s_waitcnt lgkmcnt(5)
v_mfma_f32_16x16x32_bf16 v[192:195], v[132:135], v[152:155], v[192:195]
ds_read_b64_tr_b16 v[166:167], v2 offset:1280
v_mfma_f32_16x16x32_bf16 v[196:199], v[136:139], v[152:155], v[196:199]
ds_read_b64_tr_b16 v[168:169], v1 offset:5136
s_waitcnt lgkmcnt(5)
v_mfma_f32_16x16x32_bf16 v[200:203], v[132:135], v[156:159], v[200:203]
ds_read_b64_tr_b16 v[170:171], v1 offset:6416
v_mfma_f32_16x16x32_bf16 v[204:207], v[136:139], v[156:159], v[204:207]
ds_read_b64_tr_b16 v[172:173], v1 offset:5168
s_waitcnt lgkmcnt(5)
v_mfma_f32_16x16x32_bf16 v[208:211], v[132:135], v[160:163], v[208:211]
ds_read_b64_tr_b16 v[174:175], v1 offset:6448
v_mfma_f32_16x16x32_bf16 v[212:215], v[136:139], v[160:163], v[212:215]
ds_read_b64_tr_b16 v[176:177], v1 offset:5200
s_waitcnt lgkmcnt(5)
v_mfma_f32_16x16x32_bf16 v[216:219], v[132:135], v[164:167], v[216:219]
ds_read_b64_tr_b16 v[178:179], v1 offset:6480
v_mfma_f32_16x16x32_bf16 v[220:223], v[136:139], v[164:167], v[220:223]
ds_read_b64_tr_b16 v[180:181], v1 offset:5232
s_waitcnt lgkmcnt(5)
v_mfma_f32_16x16x32_bf16 v[224:227], v[132:135], v[168:171], v[224:227]
ds_read_b64_tr_b16 v[182:183], v1 offset:6512
v_mfma_f32_16x16x32_bf16 v[228:231], v[136:139], v[168:171], v[228:231]
s_barrier
ds_read_b128 v[140:143], v7 offset:32768
ds_read_b128 v[144:147], v7 offset:34816
s_waitcnt lgkmcnt(6)
v_mfma_f32_16x16x32_bf16 v[232:235], v[132:135], v[172:175], v[232:235]
ds_read_b64_tr_b16 v[148:149], v1 offset:10272
v_mfma_f32_16x16x32_bf16 v[236:239], v[136:139], v[172:175], v[236:239]
ds_read_b64_tr_b16 v[150:151], v1 offset:11552
ds_read_b64_tr_b16 v[152:153], v1 offset:10304
s_waitcnt lgkmcnt(7)
v_mfma_f32_16x16x32_bf16 v[240:243], v[132:135], v[176:179], v[240:243]
ds_read_b64_tr_b16 v[154:155], v1 offset:11584
v_mfma_f32_16x16x32_bf16 v[244:247], v[136:139], v[176:179], v[244:247]
ds_read_b64_tr_b16 v[156:157], v1 offset:10336
s_waitcnt lgkmcnt(7)
v_mfma_f32_16x16x32_bf16 v[248:251], v[132:135], v[180:183], v[248:251]
ds_read_b64_tr_b16 v[158:159], v1 offset:11616
v_mfma_f32_16x16x32_bf16 v[252:255], v[136:139], v[180:183], v[252:255]
ds_read_b64_tr_b16 v[160:161], v1 offset:10368
s_waitcnt lgkmcnt(5)
v_mfma_f32_16x16x32_bf16 v[184:187], v[140:143], v[148:151], v[184:187]
ds_read_b64_tr_b16 v[162:163], v1 offset:11648
v_mfma_f32_16x16x32_bf16 v[188:191], v[144:147], v[148:151], v[188:191]
ds_read_b64_tr_b16 v[164:165], v2 offset:10272
s_waitcnt lgkmcnt(5)
v_mfma_f32_16x16x32_bf16 v[192:195], v[140:143], v[152:155], v[192:195]
ds_read_b64_tr_b16 v[166:167], v2 offset:11552
v_mfma_f32_16x16x32_bf16 v[196:199], v[144:147], v[152:155], v[196:199]
ds_read_b64_tr_b16 v[168:169], v1 offset:15408
s_waitcnt lgkmcnt(5)
v_mfma_f32_16x16x32_bf16 v[200:203], v[140:143], v[156:159], v[200:203]
ds_read_b64_tr_b16 v[170:171], v1 offset:16688
v_mfma_f32_16x16x32_bf16 v[204:207], v[144:147], v[156:159], v[204:207]
ds_read_b64_tr_b16 v[172:173], v1 offset:15440
s_waitcnt lgkmcnt(5)
v_mfma_f32_16x16x32_bf16 v[208:211], v[140:143], v[160:163], v[208:211]
ds_read_b64_tr_b16 v[174:175], v1 offset:16720
v_mfma_f32_16x16x32_bf16 v[212:215], v[144:147], v[160:163], v[212:215]
ds_read_b64_tr_b16 v[176:177], v1 offset:15472
s_waitcnt lgkmcnt(5)
v_mfma_f32_16x16x32_bf16 v[216:219], v[140:143], v[164:167], v[216:219]
ds_read_b64_tr_b16 v[178:179], v1 offset:16752
v_mfma_f32_16x16x32_bf16 v[220:223], v[144:147], v[164:167], v[220:223]
ds_read_b64_tr_b16 v[180:181], v1 offset:15504
s_waitcnt lgkmcnt(5)
v_mfma_f32_16x16x32_bf16 v[224:227], v[140:143], v[168:171], v[224:227]
ds_read_b64_tr_b16 v[182:183], v1 offset:16784
v_mfma_f32_16x16x32_bf16 v[228:231], v[144:147], v[168:171], v[228:231]
s_barrier
ds_read_b128 v[36:39], v6 offset:0
ds_read_b128 v[40:43], v6 offset:2048
s_waitcnt lgkmcnt(6)
v_mfma_f32_16x16x32_bf16 v[232:235], v[140:143], v[172:175], v[232:235]
ds_read_b64_tr_b16 v[148:149], v1 offset:20544
v_mfma_f32_16x16x32_bf16 v[236:239], v[144:147], v[172:175], v[236:239]
ds_read_b64_tr_b16 v[150:151], v1 offset:21824
ds_read_b64_tr_b16 v[152:153], v1 offset:20576
s_waitcnt lgkmcnt(7)
v_mfma_f32_16x16x32_bf16 v[240:243], v[140:143], v[176:179], v[240:243]
ds_read_b64_tr_b16 v[154:155], v1 offset:21856
v_mfma_f32_16x16x32_bf16 v[244:247], v[144:147], v[176:179], v[244:247]
ds_read_b64_tr_b16 v[156:157], v1 offset:20608
s_waitcnt lgkmcnt(7)
v_mfma_f32_16x16x32_bf16 v[248:251], v[140:143], v[180:183], v[248:251]
ds_read_b64_tr_b16 v[158:159], v1 offset:21888
v_mfma_f32_16x16x32_bf16 v[252:255], v[144:147], v[180:183], v[252:255]
ds_read_b64_tr_b16 v[160:161], v1 offset:20640
s_waitcnt lgkmcnt(5)
v_mfma_f32_16x16x32_bf16 v[184:187], v[36:39], v[148:151], v[184:187]
ds_read_b64_tr_b16 v[162:163], v1 offset:21920
v_mfma_f32_16x16x32_bf16 v[188:191], v[40:43], v[148:151], v[188:191]
ds_read_b64_tr_b16 v[164:165], v2 offset:20544
s_waitcnt lgkmcnt(5)
v_mfma_f32_16x16x32_bf16 v[192:195], v[36:39], v[152:155], v[192:195]
ds_read_b64_tr_b16 v[166:167], v2 offset:21824
v_mfma_f32_16x16x32_bf16 v[196:199], v[40:43], v[152:155], v[196:199]
ds_read_b64_tr_b16 v[168:169], v1 offset:25680
s_waitcnt lgkmcnt(5)
v_mfma_f32_16x16x32_bf16 v[200:203], v[36:39], v[156:159], v[200:203]
ds_read_b64_tr_b16 v[170:171], v1 offset:26960
v_mfma_f32_16x16x32_bf16 v[204:207], v[40:43], v[156:159], v[204:207]
ds_read_b64_tr_b16 v[172:173], v1 offset:25712
s_waitcnt lgkmcnt(5)
v_mfma_f32_16x16x32_bf16 v[208:211], v[36:39], v[160:163], v[208:211]
ds_read_b64_tr_b16 v[174:175], v1 offset:26992
v_mfma_f32_16x16x32_bf16 v[212:215], v[40:43], v[160:163], v[212:215]
ds_read_b64_tr_b16 v[176:177], v1 offset:25744
s_waitcnt lgkmcnt(5)
v_mfma_f32_16x16x32_bf16 v[216:219], v[36:39], v[164:167], v[216:219]
ds_read_b64_tr_b16 v[178:179], v1 offset:27024
v_mfma_f32_16x16x32_bf16 v[220:223], v[40:43], v[164:167], v[220:223]
ds_read_b64_tr_b16 v[180:181], v1 offset:25776
s_waitcnt lgkmcnt(5)
v_mfma_f32_16x16x32_bf16 v[224:227], v[36:39], v[168:171], v[224:227]
ds_read_b64_tr_b16 v[182:183], v1 offset:27056
v_mfma_f32_16x16x32_bf16 v[228:231], v[40:43], v[168:171], v[228:231]
s_barrier
ds_read_b128 v[44:47], v7 offset:0
ds_read_b128 v[48:51], v7 offset:2048
s_waitcnt lgkmcnt(6)
v_mfma_f32_16x16x32_bf16 v[232:235], v[36:39], v[172:175], v[232:235]
ds_read_b64_tr_b16 v[148:149], v1 offset:30816
v_mfma_f32_16x16x32_bf16 v[236:239], v[40:43], v[172:175], v[236:239]
ds_read_b64_tr_b16 v[150:151], v1 offset:32096
ds_read_b64_tr_b16 v[152:153], v1 offset:30848
s_waitcnt lgkmcnt(7)
v_mfma_f32_16x16x32_bf16 v[240:243], v[36:39], v[176:179], v[240:243]
ds_read_b64_tr_b16 v[154:155], v1 offset:32128
v_mfma_f32_16x16x32_bf16 v[244:247], v[40:43], v[176:179], v[244:247]
ds_read_b64_tr_b16 v[156:157], v1 offset:30880
s_waitcnt lgkmcnt(7)
v_mfma_f32_16x16x32_bf16 v[248:251], v[36:39], v[180:183], v[248:251]
ds_read_b64_tr_b16 v[158:159], v1 offset:32160
v_mfma_f32_16x16x32_bf16 v[252:255], v[40:43], v[180:183], v[252:255]
ds_read_b64_tr_b16 v[160:161], v1 offset:30912
s_waitcnt lgkmcnt(5)
v_mfma_f32_16x16x32_bf16 v[184:187], v[44:47], v[148:151], v[184:187]
ds_read_b64_tr_b16 v[162:163], v1 offset:32192
v_mfma_f32_16x16x32_bf16 v[188:191], v[48:51], v[148:151], v[188:191]
ds_read_b64_tr_b16 v[164:165], v2 offset:30816
s_waitcnt lgkmcnt(5)
v_mfma_f32_16x16x32_bf16 v[192:195], v[44:47], v[152:155], v[192:195]
ds_read_b64_tr_b16 v[166:167], v2 offset:32096
v_mfma_f32_16x16x32_bf16 v[196:199], v[48:51], v[152:155], v[196:199]
ds_read_b64_tr_b16 v[168:169], v1 offset:35952
s_waitcnt lgkmcnt(5)
v_mfma_f32_16x16x32_bf16 v[200:203], v[44:47], v[156:159], v[200:203]
ds_read_b64_tr_b16 v[170:171], v1 offset:37232
v_mfma_f32_16x16x32_bf16 v[204:207], v[48:51], v[156:159], v[204:207]
ds_read_b64_tr_b16 v[172:173], v1 offset:35984
s_waitcnt lgkmcnt(5)
v_mfma_f32_16x16x32_bf16 v[208:211], v[44:47], v[160:163], v[208:211]
ds_read_b64_tr_b16 v[174:175], v1 offset:37264
v_mfma_f32_16x16x32_bf16 v[212:215], v[48:51], v[160:163], v[212:215]
ds_read_b64_tr_b16 v[176:177], v1 offset:36016
s_waitcnt lgkmcnt(5)
v_mfma_f32_16x16x32_bf16 v[216:219], v[44:47], v[164:167], v[216:219]
ds_read_b64_tr_b16 v[178:179], v1 offset:37296
v_mfma_f32_16x16x32_bf16 v[220:223], v[48:51], v[164:167], v[220:223]
ds_read_b64_tr_b16 v[180:181], v1 offset:36048
s_waitcnt lgkmcnt(5)
v_mfma_f32_16x16x32_bf16 v[224:227], v[44:47], v[168:171], v[224:227]
ds_read_b64_tr_b16 v[182:183], v1 offset:37328
v_mfma_f32_16x16x32_bf16 v[228:231], v[48:51], v[168:171], v[228:231]
s_barrier
ds_read_b128 v[36:39], v6 offset:16384
ds_read_b128 v[40:43], v6 offset:18432
s_waitcnt lgkmcnt(6)
v_mfma_f32_16x16x32_bf16 v[232:235], v[44:47], v[172:175], v[232:235]
ds_read_b64_tr_b16 v[148:149], v1 offset:41088
v_mfma_f32_16x16x32_bf16 v[236:239], v[48:51], v[172:175], v[236:239]
ds_read_b64_tr_b16 v[150:151], v1 offset:42368
ds_read_b64_tr_b16 v[152:153], v1 offset:41120
s_waitcnt lgkmcnt(7)
v_mfma_f32_16x16x32_bf16 v[240:243], v[44:47], v[176:179], v[240:243]
ds_read_b64_tr_b16 v[154:155], v1 offset:42400
v_mfma_f32_16x16x32_bf16 v[244:247], v[48:51], v[176:179], v[244:247]
ds_read_b64_tr_b16 v[156:157], v1 offset:41152
s_waitcnt lgkmcnt(7)
v_mfma_f32_16x16x32_bf16 v[248:251], v[44:47], v[180:183], v[248:251]
ds_read_b64_tr_b16 v[158:159], v1 offset:42432
v_mfma_f32_16x16x32_bf16 v[252:255], v[48:51], v[180:183], v[252:255]
ds_read_b64_tr_b16 v[160:161], v1 offset:41184
s_waitcnt lgkmcnt(5)
v_mfma_f32_16x16x32_bf16 v[184:187], v[36:39], v[148:151], v[184:187]
ds_read_b64_tr_b16 v[162:163], v1 offset:42464
v_mfma_f32_16x16x32_bf16 v[188:191], v[40:43], v[148:151], v[188:191]
ds_read_b64_tr_b16 v[164:165], v2 offset:41088
s_waitcnt lgkmcnt(5)
v_mfma_f32_16x16x32_bf16 v[192:195], v[36:39], v[152:155], v[192:195]
ds_read_b64_tr_b16 v[166:167], v2 offset:42368
v_mfma_f32_16x16x32_bf16 v[196:199], v[40:43], v[152:155], v[196:199]
ds_read_b64_tr_b16 v[168:169], v1 offset:46224
s_waitcnt lgkmcnt(5)
v_mfma_f32_16x16x32_bf16 v[200:203], v[36:39], v[156:159], v[200:203]
ds_read_b64_tr_b16 v[170:171], v1 offset:47504
v_mfma_f32_16x16x32_bf16 v[204:207], v[40:43], v[156:159], v[204:207]
ds_read_b64_tr_b16 v[172:173], v1 offset:46256
s_waitcnt lgkmcnt(5)
v_mfma_f32_16x16x32_bf16 v[208:211], v[36:39], v[160:163], v[208:211]
ds_read_b64_tr_b16 v[174:175], v1 offset:47536
v_mfma_f32_16x16x32_bf16 v[212:215], v[40:43], v[160:163], v[212:215]
ds_read_b64_tr_b16 v[176:177], v1 offset:46288
s_waitcnt lgkmcnt(5)
v_mfma_f32_16x16x32_bf16 v[216:219], v[36:39], v[164:167], v[216:219]
ds_read_b64_tr_b16 v[178:179], v1 offset:47568
v_mfma_f32_16x16x32_bf16 v[220:223], v[40:43], v[164:167], v[220:223]
ds_read_b64_tr_b16 v[180:181], v1 offset:46320
s_waitcnt lgkmcnt(5)
v_mfma_f32_16x16x32_bf16 v[224:227], v[36:39], v[168:171], v[224:227]
ds_read_b64_tr_b16 v[182:183], v1 offset:47600
v_mfma_f32_16x16x32_bf16 v[228:231], v[40:43], v[168:171], v[228:231]
s_barrier
ds_read_b128 v[44:47], v7 offset:16384
ds_read_b128 v[48:51], v7 offset:18432
s_waitcnt lgkmcnt(6)
v_mfma_f32_16x16x32_bf16 v[232:235], v[36:39], v[172:175], v[232:235]
ds_read_b64_tr_b16 v[148:149], v1 offset:0
v_mfma_f32_16x16x32_bf16 v[236:239], v[40:43], v[172:175], v[236:239]
ds_read_b64_tr_b16 v[150:151], v1 offset:1280
ds_read_b64_tr_b16 v[152:153], v1 offset:32
s_waitcnt lgkmcnt(7)
v_mfma_f32_16x16x32_bf16 v[240:243], v[36:39], v[176:179], v[240:243]
ds_read_b64_tr_b16 v[154:155], v1 offset:1312
v_mfma_f32_16x16x32_bf16 v[244:247], v[40:43], v[176:179], v[244:247]
ds_read_b64_tr_b16 v[156:157], v1 offset:64
s_waitcnt lgkmcnt(7)
v_mfma_f32_16x16x32_bf16 v[248:251], v[36:39], v[180:183], v[248:251]
ds_read_b64_tr_b16 v[158:159], v1 offset:1344
v_mfma_f32_16x16x32_bf16 v[252:255], v[40:43], v[180:183], v[252:255]
ds_read_b64_tr_b16 v[160:161], v1 offset:96
s_waitcnt lgkmcnt(5)
v_mfma_f32_16x16x32_bf16 v[184:187], v[44:47], v[148:151], v[184:187]
ds_read_b64_tr_b16 v[162:163], v1 offset:1376
v_mfma_f32_16x16x32_bf16 v[188:191], v[48:51], v[148:151], v[188:191]
ds_read_b64_tr_b16 v[164:165], v2 offset:0
s_waitcnt lgkmcnt(5)
v_mfma_f32_16x16x32_bf16 v[192:195], v[44:47], v[152:155], v[192:195]
ds_read_b64_tr_b16 v[166:167], v2 offset:1280
v_mfma_f32_16x16x32_bf16 v[196:199], v[48:51], v[152:155], v[196:199]
ds_read_b64_tr_b16 v[168:169], v1 offset:5136
s_waitcnt lgkmcnt(5)
v_mfma_f32_16x16x32_bf16 v[200:203], v[44:47], v[156:159], v[200:203]
ds_read_b64_tr_b16 v[170:171], v1 offset:6416
v_mfma_f32_16x16x32_bf16 v[204:207], v[48:51], v[156:159], v[204:207]
ds_read_b64_tr_b16 v[172:173], v1 offset:5168
s_waitcnt lgkmcnt(5)
v_mfma_f32_16x16x32_bf16 v[208:211], v[44:47], v[160:163], v[208:211]
ds_read_b64_tr_b16 v[174:175], v1 offset:6448
v_mfma_f32_16x16x32_bf16 v[212:215], v[48:51], v[160:163], v[212:215]
ds_read_b64_tr_b16 v[176:177], v1 offset:5200
s_waitcnt lgkmcnt(5)
v_mfma_f32_16x16x32_bf16 v[216:219], v[44:47], v[164:167], v[216:219]
ds_read_b64_tr_b16 v[178:179], v1 offset:6480
v_mfma_f32_16x16x32_bf16 v[220:223], v[48:51], v[164:167], v[220:223]
ds_read_b64_tr_b16 v[180:181], v1 offset:5232
s_waitcnt lgkmcnt(5)
v_mfma_f32_16x16x32_bf16 v[224:227], v[44:47], v[168:171], v[224:227]
ds_read_b64_tr_b16 v[182:183], v1 offset:6512
v_mfma_f32_16x16x32_bf16 v[228:231], v[48:51], v[168:171], v[228:231]
s_barrier
ds_read_b128 v[36:39], v6 offset:32768
ds_read_b128 v[40:43], v6 offset:34816
s_waitcnt lgkmcnt(6)
v_mfma_f32_16x16x32_bf16 v[232:235], v[44:47], v[172:175], v[232:235]
ds_read_b64_tr_b16 v[148:149], v1 offset:10272
v_mfma_f32_16x16x32_bf16 v[236:239], v[48:51], v[172:175], v[236:239]
ds_read_b64_tr_b16 v[150:151], v1 offset:11552
ds_read_b64_tr_b16 v[152:153], v1 offset:10304
s_waitcnt lgkmcnt(7)
v_mfma_f32_16x16x32_bf16 v[240:243], v[44:47], v[176:179], v[240:243]
ds_read_b64_tr_b16 v[154:155], v1 offset:11584
v_mfma_f32_16x16x32_bf16 v[244:247], v[48:51], v[176:179], v[244:247]
ds_read_b64_tr_b16 v[156:157], v1 offset:10336
s_waitcnt lgkmcnt(7)
v_mfma_f32_16x16x32_bf16 v[248:251], v[44:47], v[180:183], v[248:251]
ds_read_b64_tr_b16 v[158:159], v1 offset:11616
v_mfma_f32_16x16x32_bf16 v[252:255], v[48:51], v[180:183], v[252:255]
ds_read_b64_tr_b16 v[160:161], v1 offset:10368
s_waitcnt lgkmcnt(5)
v_mfma_f32_16x16x32_bf16 v[184:187], v[36:39], v[148:151], v[184:187]
ds_read_b64_tr_b16 v[162:163], v1 offset:11648
v_mfma_f32_16x16x32_bf16 v[188:191], v[40:43], v[148:151], v[188:191]
ds_read_b64_tr_b16 v[164:165], v2 offset:10272
s_waitcnt lgkmcnt(5)
v_mfma_f32_16x16x32_bf16 v[192:195], v[36:39], v[152:155], v[192:195]
ds_read_b64_tr_b16 v[166:167], v2 offset:11552
v_mfma_f32_16x16x32_bf16 v[196:199], v[40:43], v[152:155], v[196:199]
ds_read_b64_tr_b16 v[168:169], v1 offset:15408
s_waitcnt lgkmcnt(5)
v_mfma_f32_16x16x32_bf16 v[200:203], v[36:39], v[156:159], v[200:203]
ds_read_b64_tr_b16 v[170:171], v1 offset:16688
v_mfma_f32_16x16x32_bf16 v[204:207], v[40:43], v[156:159], v[204:207]
ds_read_b64_tr_b16 v[172:173], v1 offset:15440
s_waitcnt lgkmcnt(5)
v_mfma_f32_16x16x32_bf16 v[208:211], v[36:39], v[160:163], v[208:211]
ds_read_b64_tr_b16 v[174:175], v1 offset:16720
v_mfma_f32_16x16x32_bf16 v[212:215], v[40:43], v[160:163], v[212:215]
ds_read_b64_tr_b16 v[176:177], v1 offset:15472
s_waitcnt lgkmcnt(5)
v_mfma_f32_16x16x32_bf16 v[216:219], v[36:39], v[164:167], v[216:219]
ds_read_b64_tr_b16 v[178:179], v1 offset:16752
v_mfma_f32_16x16x32_bf16 v[220:223], v[40:43], v[164:167], v[220:223]
ds_read_b64_tr_b16 v[180:181], v1 offset:15504
s_waitcnt lgkmcnt(5)
v_mfma_f32_16x16x32_bf16 v[224:227], v[36:39], v[168:171], v[224:227]
ds_read_b64_tr_b16 v[182:183], v1 offset:16784
v_mfma_f32_16x16x32_bf16 v[228:231], v[40:43], v[168:171], v[228:231]
s_barrier
ds_read_b128 v[44:47], v7 offset:32768
ds_read_b128 v[48:51], v7 offset:34816
s_waitcnt lgkmcnt(6)
v_mfma_f32_16x16x32_bf16 v[232:235], v[36:39], v[172:175], v[232:235]
ds_read_b64_tr_b16 v[148:149], v1 offset:20544
v_mfma_f32_16x16x32_bf16 v[236:239], v[40:43], v[172:175], v[236:239]
ds_read_b64_tr_b16 v[150:151], v1 offset:21824
ds_read_b64_tr_b16 v[152:153], v1 offset:20576
s_waitcnt lgkmcnt(7)
v_mfma_f32_16x16x32_bf16 v[240:243], v[36:39], v[176:179], v[240:243]
ds_read_b64_tr_b16 v[154:155], v1 offset:21856
v_mfma_f32_16x16x32_bf16 v[244:247], v[40:43], v[176:179], v[244:247]
ds_read_b64_tr_b16 v[156:157], v1 offset:20608
s_waitcnt lgkmcnt(7)
v_mfma_f32_16x16x32_bf16 v[248:251], v[36:39], v[180:183], v[248:251]
ds_read_b64_tr_b16 v[158:159], v1 offset:21888
v_mfma_f32_16x16x32_bf16 v[252:255], v[40:43], v[180:183], v[252:255]
ds_read_b64_tr_b16 v[160:161], v1 offset:20640
s_waitcnt lgkmcnt(5)
v_mfma_f32_16x16x32_bf16 v[184:187], v[44:47], v[148:151], v[184:187]
ds_read_b64_tr_b16 v[162:163], v1 offset:21920
v_mfma_f32_16x16x32_bf16 v[188:191], v[48:51], v[148:151], v[188:191]
ds_read_b64_tr_b16 v[164:165], v2 offset:20544
ds_read_b128 v[148:151], v6 offset:0
s_waitcnt lgkmcnt(6)
v_mfma_f32_16x16x32_bf16 v[192:195], v[44:47], v[152:155], v[192:195]
ds_read_b64_tr_b16 v[166:167], v2 offset:21824
v_mfma_f32_16x16x32_bf16 v[196:199], v[48:51], v[152:155], v[196:199]
ds_read_b64_tr_b16 v[168:169], v1 offset:25680
ds_read_b128 v[152:155], v6 offset:2048
s_waitcnt lgkmcnt(7)
v_mfma_f32_16x16x32_bf16 v[200:203], v[44:47], v[156:159], v[200:203]
ds_read_b64_tr_b16 v[170:171], v1 offset:26960
v_mfma_f32_16x16x32_bf16 v[204:207], v[48:51], v[156:159], v[204:207]
ds_read_b64_tr_b16 v[172:173], v1 offset:25712
ds_read_b128 v[156:159], v7 offset:0
s_waitcnt lgkmcnt(8)
v_mfma_f32_16x16x32_bf16 v[208:211], v[44:47], v[160:163], v[208:211]
ds_read_b64_tr_b16 v[174:175], v1 offset:26992
v_mfma_f32_16x16x32_bf16 v[212:215], v[48:51], v[160:163], v[212:215]
ds_read_b64_tr_b16 v[176:177], v1 offset:25744
ds_read_b128 v[160:163], v7 offset:2048
s_waitcnt lgkmcnt(8)
v_mfma_f32_16x16x32_bf16 v[216:219], v[44:47], v[164:167], v[216:219]
ds_read_b64_tr_b16 v[178:179], v1 offset:27024
v_mfma_f32_16x16x32_bf16 v[220:223], v[48:51], v[164:167], v[220:223]
ds_read_b64_tr_b16 v[180:181], v1 offset:25776
ds_read_b128 v[164:167], v6 offset:16384
s_waitcnt lgkmcnt(8)
v_mfma_f32_16x16x32_bf16 v[224:227], v[44:47], v[168:171], v[224:227]
ds_read_b64_tr_b16 v[182:183], v1 offset:27056
v_mfma_f32_16x16x32_bf16 v[228:231], v[48:51], v[168:171], v[228:231]
ds_read_b128 v[168:171], v6 offset:18432
s_waitcnt lgkmcnt(7)
v_mfma_f32_16x16x32_bf16 v[232:235], v[44:47], v[172:175], v[232:235]
v_mfma_f32_16x16x32_bf16 v[236:239], v[48:51], v[172:175], v[236:239]
ds_read_b128 v[172:175], v7 offset:16384
s_waitcnt lgkmcnt(5)
v_mfma_f32_16x16x32_bf16 v[240:243], v[44:47], v[176:179], v[240:243]
v_mfma_f32_16x16x32_bf16 v[244:247], v[48:51], v[176:179], v[244:247]
ds_read_b128 v[176:179], v7 offset:18432
s_waitcnt lgkmcnt(3)
v_mfma_f32_16x16x32_bf16 v[248:251], v[44:47], v[180:183], v[248:251]
v_mfma_f32_16x16x32_bf16 v[252:255], v[48:51], v[180:183], v[252:255]
s_mov_b32 s53, 0x358637bd
v_mov_b32 v16, 0x3f803f80
v_cvt_pk_bf16_f32 v224, v224, v225
v_cvt_pk_bf16_f32 v225, v226, v227
v_cvt_pk_bf16_f32 v226, v228, v229
v_cvt_pk_bf16_f32 v227, v230, v231
v_cvt_pk_bf16_f32 v232, v232, v233
v_cvt_pk_bf16_f32 v233, v234, v235
v_cvt_pk_bf16_f32 v234, v236, v237
v_cvt_pk_bf16_f32 v235, v238, v239
v_cvt_pk_bf16_f32 v240, v240, v241
v_cvt_pk_bf16_f32 v241, v242, v243
v_cvt_pk_bf16_f32 v242, v244, v245
v_cvt_pk_bf16_f32 v243, v246, v247
v_cvt_pk_bf16_f32 v248, v248, v249
v_cvt_pk_bf16_f32 v249, v250, v251
v_cvt_pk_bf16_f32 v250, v252, v253
v_cvt_pk_bf16_f32 v251, v254, v255
s_waitcnt lgkmcnt(0)
s_barrier
v_cvt_pk_bf16_f32 v244, v216, v217
v_cvt_pk_bf16_f32 v245, v218, v219
v_cvt_pk_bf16_f32 v246, v220, v221
v_cvt_pk_bf16_f32 v247, v222, v223
v_cndmask_b32 v244, v244, v16, s[42:43]
v_cndmask_b32 v245, v245, v16, s[42:43]
v_cndmask_b32 v246, v246, v16, s[42:43]
v_cndmask_b32 v247, v247, v16, s[42:43]
v_pk_fma_f32 v[228:229], v[184:185], s[56:57], v[14:15]
v_pk_fma_f32 v[230:231], v[186:187], s[56:57], v[14:15]
v_pk_fma_f32 v[236:237], v[188:189], s[56:57], v[14:15]
v_pk_fma_f32 v[238:239], v[190:191], s[56:57], v[14:15]
v_exp_f32 v228, v228 clamp
v_max_f32 v184, s53, v184
v_exp_f32 v229, v229 clamp
v_max_f32 v185, s53, v185
ds_write_b128 v10, v[224:227] offset:5120
v_exp_f32 v230, v230 clamp
v_max_f32 v186, s53, v186
v_exp_f32 v231, v231 clamp
v_max_f32 v187, s53, v187
v_exp_f32 v236, v236 clamp
v_max_f32 v188, s53, v188
v_exp_f32 v237, v237 clamp
v_max_f32 v189, s53, v189
v_exp_f32 v238, v238 clamp
v_max_f32 v190, s53, v190
v_exp_f32 v239, v239 clamp
v_max_f32 v191, s53, v191
v_pk_add_f32 v[184:185], v[184:185], v[228:229]
v_pk_add_f32 v[186:187], v[186:187], v[230:231]
v_pk_add_f32 v[188:189], v[188:189], v[236:237]
v_pk_add_f32 v[190:191], v[190:191], v[238:239]
v_cvt_pk_bf16_f32 v184, v184, v185
v_cvt_pk_bf16_f32 v185, v186, v187
v_cvt_pk_bf16_f32 v186, v188, v189
v_cvt_pk_bf16_f32 v187, v190, v191
ds_write_b128 v10, v[184:187] offset:0
v_pk_fma_f32 v[228:229], v[192:193], s[56:57], v[14:15]
v_pk_fma_f32 v[230:231], v[194:195], s[56:57], v[14:15]
v_pk_fma_f32 v[236:237], v[196:197], s[56:57], v[14:15]
v_pk_fma_f32 v[238:239], v[198:199], s[56:57], v[14:15]
v_exp_f32 v228, v228 clamp
v_max_f32 v192, s53, v192
v_exp_f32 v229, v229 clamp
v_max_f32 v193, s53, v193
ds_write_b128 v10, v[232:235] offset:6144
v_exp_f32 v230, v230 clamp
v_max_f32 v194, s53, v194
v_exp_f32 v231, v231 clamp
v_max_f32 v195, s53, v195
v_exp_f32 v236, v236 clamp
v_max_f32 v196, s53, v196
v_exp_f32 v237, v237 clamp
v_max_f32 v197, s53, v197
v_exp_f32 v238, v238 clamp
v_max_f32 v198, s53, v198
v_exp_f32 v239, v239 clamp
v_max_f32 v199, s53, v199
v_pk_add_f32 v[192:193], v[192:193], v[228:229]
v_pk_add_f32 v[194:195], v[194:195], v[230:231]
v_pk_add_f32 v[196:197], v[196:197], v[236:237]
v_pk_add_f32 v[198:199], v[198:199], v[238:239]
v_cvt_pk_bf16_f32 v192, v192, v193
v_cvt_pk_bf16_f32 v193, v194, v195
v_cvt_pk_bf16_f32 v194, v196, v197
v_cvt_pk_bf16_f32 v195, v198, v199
ds_write_b128 v10, v[192:195] offset:1024
v_pk_fma_f32 v[228:229], v[200:201], s[56:57], v[14:15]
v_pk_fma_f32 v[230:231], v[202:203], s[56:57], v[14:15]
v_pk_fma_f32 v[236:237], v[204:205], s[56:57], v[14:15]
v_pk_fma_f32 v[238:239], v[206:207], s[56:57], v[14:15]
v_exp_f32 v228, v228 clamp
v_max_f32 v200, s53, v200
v_exp_f32 v229, v229 clamp
v_max_f32 v201, s53, v201
ds_write_b128 v10, v[240:243] offset:7168
v_exp_f32 v230, v230 clamp
v_max_f32 v202, s53, v202
v_exp_f32 v231, v231 clamp
v_max_f32 v203, s53, v203
v_exp_f32 v236, v236 clamp
v_max_f32 v204, s53, v204
v_exp_f32 v237, v237 clamp
v_max_f32 v205, s53, v205
v_exp_f32 v238, v238 clamp
v_max_f32 v206, s53, v206
v_exp_f32 v239, v239 clamp
v_max_f32 v207, s53, v207
v_pk_add_f32 v[200:201], v[200:201], v[228:229]
v_pk_add_f32 v[202:203], v[202:203], v[230:231]
v_pk_add_f32 v[204:205], v[204:205], v[236:237]
v_pk_add_f32 v[206:207], v[206:207], v[238:239]
v_cvt_pk_bf16_f32 v200, v200, v201
v_cvt_pk_bf16_f32 v201, v202, v203
v_cvt_pk_bf16_f32 v202, v204, v205
v_cvt_pk_bf16_f32 v203, v206, v207
ds_write_b128 v10, v[200:203] offset:2048
v_pk_fma_f32 v[228:229], v[208:209], s[56:57], v[14:15]
v_pk_fma_f32 v[230:231], v[210:211], s[56:57], v[14:15]
v_pk_fma_f32 v[236:237], v[212:213], s[56:57], v[14:15]
v_pk_fma_f32 v[238:239], v[214:215], s[56:57], v[14:15]
v_exp_f32 v228, v228 clamp
v_max_f32 v208, s53, v208
v_exp_f32 v229, v229 clamp
v_max_f32 v209, s53, v209
ds_write_b128 v10, v[248:251] offset:8192
v_exp_f32 v230, v230 clamp
v_max_f32 v210, s53, v210
v_exp_f32 v231, v231 clamp
v_max_f32 v211, s53, v211
v_exp_f32 v236, v236 clamp
v_max_f32 v212, s53, v212
v_exp_f32 v237, v237 clamp
v_max_f32 v213, s53, v213
v_exp_f32 v238, v238 clamp
v_max_f32 v214, s53, v214
v_exp_f32 v239, v239 clamp
v_max_f32 v215, s53, v215
v_pk_add_f32 v[208:209], v[208:209], v[228:229]
v_pk_add_f32 v[210:211], v[210:211], v[230:231]
v_pk_add_f32 v[212:213], v[212:213], v[236:237]
v_pk_add_f32 v[214:215], v[214:215], v[238:239]
v_cvt_pk_bf16_f32 v208, v208, v209
v_cvt_pk_bf16_f32 v209, v210, v211
v_cvt_pk_bf16_f32 v210, v212, v213
v_cvt_pk_bf16_f32 v211, v214, v215
ds_write_b128 v10, v[208:211] offset:3072
v_pk_fma_f32 v[228:229], v[216:217], s[56:57], v[14:15]
v_pk_fma_f32 v[230:231], v[218:219], s[56:57], v[14:15]
v_pk_fma_f32 v[236:237], v[220:221], s[56:57], v[14:15]
v_pk_fma_f32 v[238:239], v[222:223], s[56:57], v[14:15]
v_exp_f32 v228, v228 clamp
v_max_f32 v216, s53, v216
v_exp_f32 v229, v229 clamp
v_max_f32 v217, s53, v217
ds_write_b128 v10, v[244:247] offset:9216
v_exp_f32 v230, v230 clamp
v_max_f32 v218, s53, v218
v_exp_f32 v231, v231 clamp
v_max_f32 v219, s53, v219
v_exp_f32 v236, v236 clamp
v_max_f32 v220, s53, v220
v_exp_f32 v237, v237 clamp
v_max_f32 v221, s53, v221
v_exp_f32 v238, v238 clamp
v_max_f32 v222, s53, v222
v_exp_f32 v239, v239 clamp
v_max_f32 v223, s53, v223
v_pk_add_f32 v[216:217], v[216:217], v[228:229]
v_pk_add_f32 v[218:219], v[218:219], v[230:231]
v_pk_add_f32 v[220:221], v[220:221], v[236:237]
v_pk_add_f32 v[222:223], v[222:223], v[238:239]
v_cvt_pk_bf16_f32 v216, v216, v217
v_cvt_pk_bf16_f32 v217, v218, v219
v_cvt_pk_bf16_f32 v218, v220, v221
v_cvt_pk_bf16_f32 v219, v222, v223
ds_write_b128 v10, v[216:219] offset:4096
v_add_u32 v3, 148480, v1
v_add_u32 v4, 15360, v1
s_waitcnt lgkmcnt(0)
s_barrier
ds_read_b64_tr_b16 v[184:185], v3 offset:0
ds_read_b64_tr_b16 v[186:187], v3 offset:1280
ds_read_b64_tr_b16 v[188:189], v3 offset:32
ds_read_b64_tr_b16 v[190:191], v3 offset:1312
ds_read_b64_tr_b16 v[192:193], v3 offset:64
ds_read_b64_tr_b16 v[194:195], v3 offset:1344
ds_read_b64_tr_b16 v[196:197], v3 offset:96
ds_read_b64_tr_b16 v[198:199], v3 offset:1376
ds_read_b64_tr_b16 v[200:201], v3 offset:128
ds_read_b64_tr_b16 v[202:203], v3 offset:1408
s_barrier
s_waitcnt lgkmcnt(8)
v_mfma_f32_16x16x32_bf16 v[216:219], v[184:187], v[52:55], v[28:31]
v_mfma_f32_16x16x32_bf16 v[220:223], v[184:187], v[56:59], v[28:31]
ds_read_b64_tr_b16 v[184:185], v3 offset:5120
s_waitcnt lgkmcnt(7)
v_mfma_f32_16x16x32_bf16 v[224:227], v[188:191], v[52:55], v[28:31]
ds_read_b64_tr_b16 v[186:187], v3 offset:6400
v_mfma_f32_16x16x32_bf16 v[228:231], v[188:191], v[56:59], v[28:31]
ds_read_b64_tr_b16 v[188:189], v3 offset:5152
s_waitcnt lgkmcnt(7)
v_mfma_f32_16x16x32_bf16 v[232:235], v[192:195], v[52:55], v[28:31]
ds_read_b64_tr_b16 v[190:191], v3 offset:6432
v_mfma_f32_16x16x32_bf16 v[236:239], v[192:195], v[56:59], v[28:31]
ds_read_b64_tr_b16 v[192:193], v3 offset:5184
s_waitcnt lgkmcnt(7)
v_mfma_f32_16x16x32_bf16 v[240:243], v[196:199], v[52:55], v[28:31]
ds_read_b64_tr_b16 v[194:195], v3 offset:6464
v_mfma_f32_16x16x32_bf16 v[244:247], v[196:199], v[56:59], v[28:31]
ds_read_b64_tr_b16 v[196:197], v3 offset:5216
s_waitcnt lgkmcnt(7)
v_mfma_f32_16x16x32_bf16 v[248:251], v[200:203], v[52:55], v[28:31]
ds_read_b64_tr_b16 v[198:199], v3 offset:6496
v_mfma_f32_16x16x32_bf16 v[252:255], v[200:203], v[56:59], v[28:31]
ds_read_b64_tr_b16 v[200:201], v3 offset:5248
ds_read_b64_tr_b16 v[202:203], v3 offset:6528
s_waitcnt lgkmcnt(8)
v_mfma_f32_16x16x32_bf16 v[216:219], v[184:187], v[60:63], v[216:219]
v_mfma_f32_16x16x32_bf16 v[220:223], v[184:187], v[64:67], v[220:223]
ds_read_b64_tr_b16 v[184:185], v3 offset:10240
s_waitcnt lgkmcnt(7)
v_mfma_f32_16x16x32_bf16 v[224:227], v[188:191], v[60:63], v[224:227]
ds_read_b64_tr_b16 v[186:187], v3 offset:11520
v_mfma_f32_16x16x32_bf16 v[228:231], v[188:191], v[64:67], v[228:231]
ds_read_b64_tr_b16 v[188:189], v3 offset:10272
s_waitcnt lgkmcnt(7)
v_mfma_f32_16x16x32_bf16 v[232:235], v[192:195], v[60:63], v[232:235]
ds_read_b64_tr_b16 v[190:191], v3 offset:11552
v_mfma_f32_16x16x32_bf16 v[236:239], v[192:195], v[64:67], v[236:239]
ds_read_b64_tr_b16 v[192:193], v3 offset:10304
s_waitcnt lgkmcnt(7)
v_mfma_f32_16x16x32_bf16 v[240:243], v[196:199], v[60:63], v[240:243]
ds_read_b64_tr_b16 v[194:195], v3 offset:11584
v_mfma_f32_16x16x32_bf16 v[244:247], v[196:199], v[64:67], v[244:247]
ds_read_b64_tr_b16 v[196:197], v3 offset:10336
s_waitcnt lgkmcnt(7)
v_mfma_f32_16x16x32_bf16 v[248:251], v[200:203], v[60:63], v[248:251]
ds_read_b64_tr_b16 v[198:199], v3 offset:11616
v_mfma_f32_16x16x32_bf16 v[252:255], v[200:203], v[64:67], v[252:255]
ds_read_b64_tr_b16 v[200:201], v3 offset:10368
ds_read_b64_tr_b16 v[202:203], v3 offset:11648
s_barrier
s_waitcnt lgkmcnt(8)
v_mfma_f32_16x16x32_bf16 v[216:219], v[184:187], v[68:71], v[216:219]
v_mfma_f32_16x16x32_bf16 v[220:223], v[184:187], v[72:75], v[220:223]
ds_read_b64_tr_b16 v[184:185], v1 offset:0
s_waitcnt lgkmcnt(7)
v_mfma_f32_16x16x32_bf16 v[224:227], v[188:191], v[68:71], v[224:227]
ds_read_b64_tr_b16 v[186:187], v1 offset:1280
v_mfma_f32_16x16x32_bf16 v[228:231], v[188:191], v[72:75], v[228:231]
ds_read_b64_tr_b16 v[188:189], v1 offset:32
s_waitcnt lgkmcnt(7)
v_mfma_f32_16x16x32_bf16 v[232:235], v[192:195], v[68:71], v[232:235]
ds_read_b64_tr_b16 v[190:191], v1 offset:1312
v_mfma_f32_16x16x32_bf16 v[236:239], v[192:195], v[72:75], v[236:239]
ds_read_b64_tr_b16 v[192:193], v1 offset:64
s_waitcnt lgkmcnt(7)
v_mfma_f32_16x16x32_bf16 v[240:243], v[196:199], v[68:71], v[240:243]
ds_read_b64_tr_b16 v[194:195], v1 offset:1344
v_mfma_f32_16x16x32_bf16 v[244:247], v[196:199], v[72:75], v[244:247]
ds_read_b64_tr_b16 v[196:197], v1 offset:96
s_waitcnt lgkmcnt(7)
v_mfma_f32_16x16x32_bf16 v[248:251], v[200:203], v[68:71], v[248:251]
ds_read_b64_tr_b16 v[198:199], v1 offset:1376
v_mfma_f32_16x16x32_bf16 v[252:255], v[200:203], v[72:75], v[252:255]
ds_read_b64_tr_b16 v[200:201], v1 offset:128
ds_read_b64_tr_b16 v[202:203], v1 offset:1408
s_waitcnt lgkmcnt(8)
v_mfma_f32_16x16x32_bf16 v[216:219], v[184:187], v[76:79], v[216:219]
v_mfma_f32_16x16x32_bf16 v[220:223], v[184:187], v[80:83], v[220:223]
ds_read_b64_tr_b16 v[184:185], v1 offset:5120
s_waitcnt lgkmcnt(7)
v_mfma_f32_16x16x32_bf16 v[224:227], v[188:191], v[76:79], v[224:227]
ds_read_b64_tr_b16 v[186:187], v1 offset:6400
v_mfma_f32_16x16x32_bf16 v[228:231], v[188:191], v[80:83], v[228:231]
ds_read_b64_tr_b16 v[188:189], v1 offset:5152
s_waitcnt lgkmcnt(7)
v_mfma_f32_16x16x32_bf16 v[232:235], v[192:195], v[76:79], v[232:235]
ds_read_b64_tr_b16 v[190:191], v1 offset:6432
v_mfma_f32_16x16x32_bf16 v[236:239], v[192:195], v[80:83], v[236:239]
ds_read_b64_tr_b16 v[192:193], v1 offset:5184
s_waitcnt lgkmcnt(7)
v_mfma_f32_16x16x32_bf16 v[240:243], v[196:199], v[76:79], v[240:243]
ds_read_b64_tr_b16 v[194:195], v1 offset:6464
v_mfma_f32_16x16x32_bf16 v[244:247], v[196:199], v[80:83], v[244:247]
ds_read_b64_tr_b16 v[196:197], v1 offset:5216
s_waitcnt lgkmcnt(7)
v_mfma_f32_16x16x32_bf16 v[248:251], v[200:203], v[76:79], v[248:251]
ds_read_b64_tr_b16 v[198:199], v1 offset:6496
v_mfma_f32_16x16x32_bf16 v[252:255], v[200:203], v[80:83], v[252:255]
ds_read_b64_tr_b16 v[200:201], v1 offset:5248
ds_read_b64_tr_b16 v[202:203], v1 offset:6528
s_waitcnt lgkmcnt(8)
v_mfma_f32_16x16x32_bf16 v[216:219], v[184:187], v[84:87], v[216:219]
v_mfma_f32_16x16x32_bf16 v[220:223], v[184:187], v[88:91], v[220:223]
ds_read_b64_tr_b16 v[184:185], v1 offset:10240
s_waitcnt lgkmcnt(7)
v_mfma_f32_16x16x32_bf16 v[224:227], v[188:191], v[84:87], v[224:227]
ds_read_b64_tr_b16 v[186:187], v1 offset:11520
v_mfma_f32_16x16x32_bf16 v[228:231], v[188:191], v[88:91], v[228:231]
ds_read_b64_tr_b16 v[188:189], v1 offset:10272
s_waitcnt lgkmcnt(7)
v_mfma_f32_16x16x32_bf16 v[232:235], v[192:195], v[84:87], v[232:235]
ds_read_b64_tr_b16 v[190:191], v1 offset:11552
v_mfma_f32_16x16x32_bf16 v[236:239], v[192:195], v[88:91], v[236:239]
ds_read_b64_tr_b16 v[192:193], v1 offset:10304
s_waitcnt lgkmcnt(7)
v_mfma_f32_16x16x32_bf16 v[240:243], v[196:199], v[84:87], v[240:243]
ds_read_b64_tr_b16 v[194:195], v1 offset:11584
v_mfma_f32_16x16x32_bf16 v[244:247], v[196:199], v[88:91], v[244:247]
ds_read_b64_tr_b16 v[196:197], v1 offset:10336
s_waitcnt lgkmcnt(7)
v_mfma_f32_16x16x32_bf16 v[248:251], v[200:203], v[84:87], v[248:251]
ds_read_b64_tr_b16 v[198:199], v1 offset:11616
v_mfma_f32_16x16x32_bf16 v[252:255], v[200:203], v[88:91], v[252:255]
ds_read_b64_tr_b16 v[200:201], v1 offset:10368
ds_read_b64_tr_b16 v[202:203], v1 offset:11648
s_waitcnt lgkmcnt(8)
v_mfma_f32_16x16x32_bf16 v[216:219], v[184:187], v[92:95], v[216:219]
v_mfma_f32_16x16x32_bf16 v[220:223], v[184:187], v[96:99], v[220:223]
ds_read_b64_tr_b16 v[184:185], v4 offset:30720
s_waitcnt lgkmcnt(7)
v_mfma_f32_16x16x32_bf16 v[224:227], v[188:191], v[92:95], v[224:227]
ds_read_b64_tr_b16 v[186:187], v4 offset:32000
v_mfma_f32_16x16x32_bf16 v[228:231], v[188:191], v[96:99], v[228:231]
ds_read_b64_tr_b16 v[188:189], v4 offset:30752
s_waitcnt lgkmcnt(7)
v_mfma_f32_16x16x32_bf16 v[232:235], v[192:195], v[92:95], v[232:235]
ds_read_b64_tr_b16 v[190:191], v4 offset:32032
v_mfma_f32_16x16x32_bf16 v[236:239], v[192:195], v[96:99], v[236:239]
ds_read_b64_tr_b16 v[192:193], v4 offset:30784
s_waitcnt lgkmcnt(7)
v_mfma_f32_16x16x32_bf16 v[240:243], v[196:199], v[92:95], v[240:243]
ds_read_b64_tr_b16 v[194:195], v4 offset:32064
v_mfma_f32_16x16x32_bf16 v[244:247], v[196:199], v[96:99], v[244:247]
ds_read_b64_tr_b16 v[196:197], v4 offset:30816
s_waitcnt lgkmcnt(7)
v_mfma_f32_16x16x32_bf16 v[248:251], v[200:203], v[92:95], v[248:251]
ds_read_b64_tr_b16 v[198:199], v4 offset:32096
v_mfma_f32_16x16x32_bf16 v[252:255], v[200:203], v[96:99], v[252:255]
ds_read_b64_tr_b16 v[200:201], v4 offset:30848
ds_read_b64_tr_b16 v[202:203], v4 offset:32128
s_waitcnt lgkmcnt(8)
v_mfma_f32_16x16x32_bf16 v[216:219], v[184:187], v[100:103], v[216:219]
v_mfma_f32_16x16x32_bf16 v[220:223], v[184:187], v[104:107], v[220:223]
ds_read_b64_tr_b16 v[184:185], v4 offset:36000
s_waitcnt lgkmcnt(7)
v_mfma_f32_16x16x32_bf16 v[224:227], v[188:191], v[100:103], v[224:227]
ds_read_b64_tr_b16 v[186:187], v4 offset:37280
v_mfma_f32_16x16x32_bf16 v[228:231], v[188:191], v[104:107], v[228:231]
ds_read_b64_tr_b16 v[188:189], v4 offset:36032
s_waitcnt lgkmcnt(7)
v_mfma_f32_16x16x32_bf16 v[232:235], v[192:195], v[100:103], v[232:235]
ds_read_b64_tr_b16 v[190:191], v4 offset:37312
v_mfma_f32_16x16x32_bf16 v[236:239], v[192:195], v[104:107], v[236:239]
ds_read_b64_tr_b16 v[192:193], v4 offset:36064
s_waitcnt lgkmcnt(7)
v_mfma_f32_16x16x32_bf16 v[240:243], v[196:199], v[100:103], v[240:243]
ds_read_b64_tr_b16 v[194:195], v4 offset:37344
v_mfma_f32_16x16x32_bf16 v[244:247], v[196:199], v[104:107], v[244:247]
ds_read_b64_tr_b16 v[196:197], v4 offset:36096
s_waitcnt lgkmcnt(7)
v_mfma_f32_16x16x32_bf16 v[248:251], v[200:203], v[100:103], v[248:251]
ds_read_b64_tr_b16 v[198:199], v4 offset:37376
v_mfma_f32_16x16x32_bf16 v[252:255], v[200:203], v[104:107], v[252:255]
ds_read_b64_tr_b16 v[200:201], v4 offset:36128
ds_read_b64_tr_b16 v[202:203], v4 offset:37408
s_waitcnt lgkmcnt(8)
v_mfma_f32_16x16x32_bf16 v[216:219], v[184:187], v[108:111], v[216:219]
v_mfma_f32_16x16x32_bf16 v[220:223], v[184:187], v[112:115], v[220:223]
ds_read_b64_tr_b16 v[184:185], v4 offset:41120
s_waitcnt lgkmcnt(7)
v_mfma_f32_16x16x32_bf16 v[224:227], v[188:191], v[108:111], v[224:227]
ds_read_b64_tr_b16 v[186:187], v4 offset:42400
v_mfma_f32_16x16x32_bf16 v[228:231], v[188:191], v[112:115], v[228:231]
ds_read_b64_tr_b16 v[188:189], v4 offset:41152
s_waitcnt lgkmcnt(7)
v_mfma_f32_16x16x32_bf16 v[232:235], v[192:195], v[108:111], v[232:235]
ds_read_b64_tr_b16 v[190:191], v4 offset:42432
v_mfma_f32_16x16x32_bf16 v[236:239], v[192:195], v[112:115], v[236:239]
ds_read_b64_tr_b16 v[192:193], v4 offset:41184
s_waitcnt lgkmcnt(7)
v_mfma_f32_16x16x32_bf16 v[240:243], v[196:199], v[108:111], v[240:243]
ds_read_b64_tr_b16 v[194:195], v4 offset:42464
v_mfma_f32_16x16x32_bf16 v[244:247], v[196:199], v[112:115], v[244:247]
ds_read_b64_tr_b16 v[196:197], v4 offset:41216
s_waitcnt lgkmcnt(7)
v_mfma_f32_16x16x32_bf16 v[248:251], v[200:203], v[108:111], v[248:251]
ds_read_b64_tr_b16 v[198:199], v4 offset:42496
v_mfma_f32_16x16x32_bf16 v[252:255], v[200:203], v[112:115], v[252:255]
ds_read_b64_tr_b16 v[200:201], v4 offset:41248
ds_read_b64_tr_b16 v[202:203], v4 offset:42528
s_waitcnt lgkmcnt(8)
v_mfma_f32_16x16x32_bf16 v[216:219], v[184:187], v[116:119], v[216:219]
v_mfma_f32_16x16x32_bf16 v[220:223], v[184:187], v[120:123], v[220:223]
ds_read_b64_tr_b16 v[184:185], v4 offset:46240
s_waitcnt lgkmcnt(7)
v_mfma_f32_16x16x32_bf16 v[224:227], v[188:191], v[116:119], v[224:227]
ds_read_b64_tr_b16 v[186:187], v4 offset:47520
v_mfma_f32_16x16x32_bf16 v[228:231], v[188:191], v[120:123], v[228:231]
ds_read_b64_tr_b16 v[188:189], v4 offset:46272
s_waitcnt lgkmcnt(7)
v_mfma_f32_16x16x32_bf16 v[232:235], v[192:195], v[116:119], v[232:235]
ds_read_b64_tr_b16 v[190:191], v4 offset:47552
v_mfma_f32_16x16x32_bf16 v[236:239], v[192:195], v[120:123], v[236:239]
ds_read_b64_tr_b16 v[192:193], v4 offset:46304
s_waitcnt lgkmcnt(7)
v_mfma_f32_16x16x32_bf16 v[240:243], v[196:199], v[116:119], v[240:243]
ds_read_b64_tr_b16 v[194:195], v4 offset:47584
v_mfma_f32_16x16x32_bf16 v[244:247], v[196:199], v[120:123], v[244:247]
ds_read_b64_tr_b16 v[196:197], v4 offset:46336
s_waitcnt lgkmcnt(7)
v_mfma_f32_16x16x32_bf16 v[248:251], v[200:203], v[116:119], v[248:251]
ds_read_b64_tr_b16 v[198:199], v4 offset:47616
v_mfma_f32_16x16x32_bf16 v[252:255], v[200:203], v[120:123], v[252:255]
ds_read_b64_tr_b16 v[200:201], v4 offset:46368
ds_read_b64_tr_b16 v[202:203], v4 offset:47648
s_waitcnt lgkmcnt(8)
v_mfma_f32_16x16x32_bf16 v[216:219], v[184:187], v[124:127], v[216:219]
v_mfma_f32_16x16x32_bf16 v[220:223], v[184:187], v[128:131], v[220:223]
ds_read_b64_tr_b16 v[184:185], v4 offset:51360
s_waitcnt lgkmcnt(7)
v_mfma_f32_16x16x32_bf16 v[224:227], v[188:191], v[124:127], v[224:227]
ds_read_b64_tr_b16 v[186:187], v4 offset:52640
v_mfma_f32_16x16x32_bf16 v[228:231], v[188:191], v[128:131], v[228:231]
ds_read_b64_tr_b16 v[188:189], v4 offset:51392
s_waitcnt lgkmcnt(7)
v_mfma_f32_16x16x32_bf16 v[232:235], v[192:195], v[124:127], v[232:235]
ds_read_b64_tr_b16 v[190:191], v4 offset:52672
v_mfma_f32_16x16x32_bf16 v[236:239], v[192:195], v[128:131], v[236:239]
ds_read_b64_tr_b16 v[192:193], v4 offset:51424
s_waitcnt lgkmcnt(7)
v_mfma_f32_16x16x32_bf16 v[240:243], v[196:199], v[124:127], v[240:243]
ds_read_b64_tr_b16 v[194:195], v4 offset:52704
v_mfma_f32_16x16x32_bf16 v[244:247], v[196:199], v[128:131], v[244:247]
ds_read_b64_tr_b16 v[196:197], v4 offset:51456
s_waitcnt lgkmcnt(7)
v_mfma_f32_16x16x32_bf16 v[248:251], v[200:203], v[124:127], v[248:251]
ds_read_b64_tr_b16 v[198:199], v4 offset:52736
v_mfma_f32_16x16x32_bf16 v[252:255], v[200:203], v[128:131], v[252:255]
ds_read_b64_tr_b16 v[200:201], v4 offset:51488
ds_read_b64_tr_b16 v[202:203], v4 offset:52768
s_waitcnt lgkmcnt(8)
v_mfma_f32_16x16x32_bf16 v[216:219], v[184:187], v[132:135], v[216:219]
v_mfma_f32_16x16x32_bf16 v[220:223], v[184:187], v[136:139], v[220:223]
ds_read_b64_tr_b16 v[184:185], v4 offset:56480
s_waitcnt lgkmcnt(7)
v_mfma_f32_16x16x32_bf16 v[224:227], v[188:191], v[132:135], v[224:227]
ds_read_b64_tr_b16 v[186:187], v4 offset:57760
v_mfma_f32_16x16x32_bf16 v[228:231], v[188:191], v[136:139], v[228:231]
ds_read_b64_tr_b16 v[188:189], v4 offset:56512
s_waitcnt lgkmcnt(7)
v_mfma_f32_16x16x32_bf16 v[232:235], v[192:195], v[132:135], v[232:235]
ds_read_b64_tr_b16 v[190:191], v4 offset:57792
v_mfma_f32_16x16x32_bf16 v[236:239], v[192:195], v[136:139], v[236:239]
ds_read_b64_tr_b16 v[192:193], v4 offset:56544
s_waitcnt lgkmcnt(7)
v_mfma_f32_16x16x32_bf16 v[240:243], v[196:199], v[132:135], v[240:243]
ds_read_b64_tr_b16 v[194:195], v4 offset:57824
v_mfma_f32_16x16x32_bf16 v[244:247], v[196:199], v[136:139], v[244:247]
ds_read_b64_tr_b16 v[196:197], v4 offset:56576
s_waitcnt lgkmcnt(7)
v_mfma_f32_16x16x32_bf16 v[248:251], v[200:203], v[132:135], v[248:251]
ds_read_b64_tr_b16 v[198:199], v4 offset:57856
v_mfma_f32_16x16x32_bf16 v[252:255], v[200:203], v[136:139], v[252:255]
ds_read_b64_tr_b16 v[200:201], v4 offset:56608
ds_read_b64_tr_b16 v[202:203], v4 offset:57888
s_barrier
s_waitcnt lgkmcnt(8)
v_mfma_f32_16x16x32_bf16 v[216:219], v[184:187], v[140:143], v[216:219]
v_mfma_f32_16x16x32_bf16 v[220:223], v[184:187], v[144:147], v[220:223]
ds_read_b64_tr_b16 v[184:185], v4 offset:0
s_waitcnt lgkmcnt(7)
v_mfma_f32_16x16x32_bf16 v[224:227], v[188:191], v[140:143], v[224:227]
ds_read_b64_tr_b16 v[186:187], v4 offset:1280
v_mfma_f32_16x16x32_bf16 v[228:231], v[188:191], v[144:147], v[228:231]
ds_read_b64_tr_b16 v[188:189], v4 offset:32
s_waitcnt lgkmcnt(7)
v_mfma_f32_16x16x32_bf16 v[232:235], v[192:195], v[140:143], v[232:235]
ds_read_b64_tr_b16 v[190:191], v4 offset:1312
v_mfma_f32_16x16x32_bf16 v[236:239], v[192:195], v[144:147], v[236:239]
ds_read_b64_tr_b16 v[192:193], v4 offset:64
s_waitcnt lgkmcnt(7)
v_mfma_f32_16x16x32_bf16 v[240:243], v[196:199], v[140:143], v[240:243]
ds_read_b64_tr_b16 v[194:195], v4 offset:1344
v_mfma_f32_16x16x32_bf16 v[244:247], v[196:199], v[144:147], v[244:247]
ds_read_b64_tr_b16 v[196:197], v4 offset:96
s_waitcnt lgkmcnt(7)
v_mfma_f32_16x16x32_bf16 v[248:251], v[200:203], v[140:143], v[248:251]
ds_read_b64_tr_b16 v[198:199], v4 offset:1376
v_mfma_f32_16x16x32_bf16 v[252:255], v[200:203], v[144:147], v[252:255]
ds_read_b64_tr_b16 v[200:201], v4 offset:128
ds_read_b64_tr_b16 v[202:203], v4 offset:1408
s_waitcnt lgkmcnt(8)
v_mfma_f32_16x16x32_bf16 v[216:219], v[184:187], v[148:151], v[216:219]
v_mfma_f32_16x16x32_bf16 v[220:223], v[184:187], v[152:155], v[220:223]
ds_read_b64_tr_b16 v[184:185], v4 offset:5120
s_waitcnt lgkmcnt(7)
v_mfma_f32_16x16x32_bf16 v[224:227], v[188:191], v[148:151], v[224:227]
ds_read_b64_tr_b16 v[186:187], v4 offset:6400
v_mfma_f32_16x16x32_bf16 v[228:231], v[188:191], v[152:155], v[228:231]
ds_read_b64_tr_b16 v[188:189], v4 offset:5152
s_waitcnt lgkmcnt(7)
v_mfma_f32_16x16x32_bf16 v[232:235], v[192:195], v[148:151], v[232:235]
ds_read_b64_tr_b16 v[190:191], v4 offset:6432
v_mfma_f32_16x16x32_bf16 v[236:239], v[192:195], v[152:155], v[236:239]
ds_read_b64_tr_b16 v[192:193], v4 offset:5184
s_waitcnt lgkmcnt(7)
v_mfma_f32_16x16x32_bf16 v[240:243], v[196:199], v[148:151], v[240:243]
ds_read_b64_tr_b16 v[194:195], v4 offset:6464
v_mfma_f32_16x16x32_bf16 v[244:247], v[196:199], v[152:155], v[244:247]
ds_read_b64_tr_b16 v[196:197], v4 offset:5216
s_waitcnt lgkmcnt(7)
v_mfma_f32_16x16x32_bf16 v[248:251], v[200:203], v[148:151], v[248:251]
ds_read_b64_tr_b16 v[198:199], v4 offset:6496
v_mfma_f32_16x16x32_bf16 v[252:255], v[200:203], v[152:155], v[252:255]
ds_read_b64_tr_b16 v[200:201], v4 offset:5248
ds_read_b64_tr_b16 v[202:203], v4 offset:6528
s_waitcnt lgkmcnt(8)
v_mfma_f32_16x16x32_bf16 v[216:219], v[184:187], v[156:159], v[216:219]
v_mfma_f32_16x16x32_bf16 v[220:223], v[184:187], v[160:163], v[220:223]
ds_read_b64_tr_b16 v[184:185], v4 offset:10240
s_waitcnt lgkmcnt(7)
v_mfma_f32_16x16x32_bf16 v[224:227], v[188:191], v[156:159], v[224:227]
ds_read_b64_tr_b16 v[186:187], v4 offset:11520
v_mfma_f32_16x16x32_bf16 v[228:231], v[188:191], v[160:163], v[228:231]
ds_read_b64_tr_b16 v[188:189], v4 offset:10272
s_waitcnt lgkmcnt(7)
v_mfma_f32_16x16x32_bf16 v[232:235], v[192:195], v[156:159], v[232:235]
ds_read_b64_tr_b16 v[190:191], v4 offset:11552
v_mfma_f32_16x16x32_bf16 v[236:239], v[192:195], v[160:163], v[236:239]
ds_read_b64_tr_b16 v[192:193], v4 offset:10304
s_waitcnt lgkmcnt(7)
v_mfma_f32_16x16x32_bf16 v[240:243], v[196:199], v[156:159], v[240:243]
ds_read_b64_tr_b16 v[194:195], v4 offset:11584
v_mfma_f32_16x16x32_bf16 v[244:247], v[196:199], v[160:163], v[244:247]
ds_read_b64_tr_b16 v[196:197], v4 offset:10336
s_waitcnt lgkmcnt(7)
v_mfma_f32_16x16x32_bf16 v[248:251], v[200:203], v[156:159], v[248:251]
ds_read_b64_tr_b16 v[198:199], v4 offset:11616
v_mfma_f32_16x16x32_bf16 v[252:255], v[200:203], v[160:163], v[252:255]
ds_read_b64_tr_b16 v[200:201], v4 offset:10368
ds_read_b64_tr_b16 v[202:203], v4 offset:11648
s_waitcnt lgkmcnt(8)
v_mfma_f32_16x16x32_bf16 v[216:219], v[184:187], v[164:167], v[216:219]
v_mfma_f32_16x16x32_bf16 v[220:223], v[184:187], v[168:171], v[220:223]
ds_read_b64_tr_b16 v[184:185], v4 offset:15360
s_waitcnt lgkmcnt(7)
v_mfma_f32_16x16x32_bf16 v[224:227], v[188:191], v[164:167], v[224:227]
ds_read_b64_tr_b16 v[186:187], v4 offset:16640
v_mfma_f32_16x16x32_bf16 v[228:231], v[188:191], v[168:171], v[228:231]
ds_read_b64_tr_b16 v[188:189], v4 offset:15392
s_waitcnt lgkmcnt(7)
v_mfma_f32_16x16x32_bf16 v[232:235], v[192:195], v[164:167], v[232:235]
ds_read_b64_tr_b16 v[190:191], v4 offset:16672
v_mfma_f32_16x16x32_bf16 v[236:239], v[192:195], v[168:171], v[236:239]
ds_read_b64_tr_b16 v[192:193], v4 offset:15424
s_waitcnt lgkmcnt(7)
v_mfma_f32_16x16x32_bf16 v[240:243], v[196:199], v[164:167], v[240:243]
ds_read_b64_tr_b16 v[194:195], v4 offset:16704
v_mfma_f32_16x16x32_bf16 v[244:247], v[196:199], v[168:171], v[244:247]
ds_read_b64_tr_b16 v[196:197], v4 offset:15456
s_waitcnt lgkmcnt(7)
v_mfma_f32_16x16x32_bf16 v[248:251], v[200:203], v[164:167], v[248:251]
ds_read_b64_tr_b16 v[198:199], v4 offset:16736
v_mfma_f32_16x16x32_bf16 v[252:255], v[200:203], v[168:171], v[252:255]
ds_read_b64_tr_b16 v[200:201], v4 offset:15488
ds_read_b64_tr_b16 v[202:203], v4 offset:16768
s_waitcnt lgkmcnt(8)
v_mfma_f32_16x16x32_bf16 v[216:219], v[184:187], v[172:175], v[216:219]
v_mfma_f32_16x16x32_bf16 v[220:223], v[184:187], v[176:179], v[220:223]
ds_read_b64_tr_b16 v[184:185], v4 offset:20480
s_waitcnt lgkmcnt(7)
v_mfma_f32_16x16x32_bf16 v[224:227], v[188:191], v[172:175], v[224:227]
ds_read_b64_tr_b16 v[186:187], v4 offset:21760
v_mfma_f32_16x16x32_bf16 v[228:231], v[188:191], v[176:179], v[228:231]
ds_read_b64_tr_b16 v[188:189], v4 offset:20512
s_waitcnt lgkmcnt(7)
v_mfma_f32_16x16x32_bf16 v[232:235], v[192:195], v[172:175], v[232:235]
ds_read_b64_tr_b16 v[190:191], v4 offset:21792
v_mfma_f32_16x16x32_bf16 v[236:239], v[192:195], v[176:179], v[236:239]
ds_read_b64_tr_b16 v[192:193], v4 offset:20544
s_waitcnt lgkmcnt(7)
v_mfma_f32_16x16x32_bf16 v[240:243], v[196:199], v[172:175], v[240:243]
ds_read_b64_tr_b16 v[194:195], v4 offset:21824
v_mfma_f32_16x16x32_bf16 v[244:247], v[196:199], v[176:179], v[244:247]
ds_read_b64_tr_b16 v[196:197], v4 offset:20576
s_waitcnt lgkmcnt(7)
v_mfma_f32_16x16x32_bf16 v[248:251], v[200:203], v[172:175], v[248:251]
ds_read_b64_tr_b16 v[198:199], v4 offset:21856
v_mfma_f32_16x16x32_bf16 v[252:255], v[200:203], v[176:179], v[252:255]
ds_read_b64_tr_b16 v[200:201], v4 offset:20608
ds_read_b64_tr_b16 v[202:203], v4 offset:21888
s_waitcnt lgkmcnt(8)
v_mfma_f32_16x16x32_bf16 v[216:219], v[184:187], v[36:39], v[216:219]
v_mfma_f32_16x16x32_bf16 v[220:223], v[184:187], v[40:43], v[220:223]
ds_read_b64_tr_b16 v[184:185], v4 offset:25600
s_waitcnt lgkmcnt(7)
v_mfma_f32_16x16x32_bf16 v[224:227], v[188:191], v[36:39], v[224:227]
ds_read_b64_tr_b16 v[186:187], v4 offset:26880
v_mfma_f32_16x16x32_bf16 v[228:231], v[188:191], v[40:43], v[228:231]
ds_read_b64_tr_b16 v[188:189], v4 offset:25632
s_waitcnt lgkmcnt(7)
v_mfma_f32_16x16x32_bf16 v[232:235], v[192:195], v[36:39], v[232:235]
ds_read_b64_tr_b16 v[190:191], v4 offset:26912
v_mfma_f32_16x16x32_bf16 v[236:239], v[192:195], v[40:43], v[236:239]
ds_read_b64_tr_b16 v[192:193], v4 offset:25664
s_waitcnt lgkmcnt(7)
v_mfma_f32_16x16x32_bf16 v[240:243], v[196:199], v[36:39], v[240:243]
ds_read_b64_tr_b16 v[194:195], v4 offset:26944
v_mfma_f32_16x16x32_bf16 v[244:247], v[196:199], v[40:43], v[244:247]
ds_read_b64_tr_b16 v[196:197], v4 offset:25696
s_waitcnt lgkmcnt(7)
v_mfma_f32_16x16x32_bf16 v[248:251], v[200:203], v[36:39], v[248:251]
ds_read_b64_tr_b16 v[198:199], v4 offset:26976
v_mfma_f32_16x16x32_bf16 v[252:255], v[200:203], v[40:43], v[252:255]
ds_read_b64_tr_b16 v[200:201], v4 offset:25728
ds_read_b64_tr_b16 v[202:203], v4 offset:27008
s_waitcnt lgkmcnt(8)
v_mfma_f32_16x16x32_bf16 v[216:219], v[184:187], v[44:47], v[216:219]
v_mfma_f32_16x16x32_bf16 v[220:223], v[184:187], v[48:51], v[220:223]
s_waitcnt lgkmcnt(6)
v_mfma_f32_16x16x32_bf16 v[224:227], v[188:191], v[44:47], v[224:227]
v_mfma_f32_16x16x32_bf16 v[228:231], v[188:191], v[48:51], v[228:231]
s_waitcnt lgkmcnt(4)
v_mfma_f32_16x16x32_bf16 v[232:235], v[192:195], v[44:47], v[232:235]
v_mfma_f32_16x16x32_bf16 v[236:239], v[192:195], v[48:51], v[236:239]
s_waitcnt lgkmcnt(2)
v_mfma_f32_16x16x32_bf16 v[240:243], v[196:199], v[44:47], v[240:243]
v_mfma_f32_16x16x32_bf16 v[244:247], v[196:199], v[48:51], v[244:247]
s_waitcnt lgkmcnt(0)
v_mfma_f32_16x16x32_bf16 v[248:251], v[200:203], v[44:47], v[248:251]
v_mfma_f32_16x16x32_bf16 v[252:255], v[200:203], v[48:51], v[252:255]
v_mov_b32 v92, 0
v_mov_b32 v93, 0
v_mov_b32 v100, 0
v_mov_b32 v101, 0
v_mov_b32 v108, 0
v_mov_b32 v109, 0
v_mov_b32 v124, 0
v_mov_b32 v125, 0
v_lshlrev_b32 v16, 3, v0
v_add_u32 v16, 132256, v16
v_pk_fma_f32 v[148:149], v[216:217], s[56:57], v[14:15]
v_pk_fma_f32 v[150:151], v[218:219], s[56:57], v[14:15]
v_pk_fma_f32 v[152:153], v[220:221], s[56:57], v[14:15]
v_pk_fma_f32 v[154:155], v[222:223], s[56:57], v[14:15]
v_exp_f32 v148, v148 clamp
v_max_f32 v216, s53, v216
v_exp_f32 v149, v149 clamp
v_max_f32 v217, s53, v217
v_exp_f32 v150, v150 clamp
v_max_f32 v218, s53, v218
v_exp_f32 v151, v151 clamp
v_max_f32 v219, s53, v219
v_exp_f32 v152, v152 clamp
v_max_f32 v220, s53, v220
v_exp_f32 v153, v153 clamp
v_max_f32 v221, s53, v221
v_exp_f32 v154, v154 clamp
v_max_f32 v222, s53, v222
v_exp_f32 v155, v155 clamp
v_max_f32 v223, s53, v223
v_pk_add_f32 v[216:217], v[216:217], v[148:149]
v_pk_add_f32 v[218:219], v[218:219], v[150:151]
v_pk_add_f32 v[220:221], v[220:221], v[152:153]
v_pk_add_f32 v[222:223], v[222:223], v[154:155]
v_cvt_pk_bf16_f32 v36, v216, v217
v_cvt_pk_bf16_f32 v37, v218, v219
v_cvt_pk_bf16_f32 v46, v220, v221
v_cvt_pk_bf16_f32 v47, v222, v223
v_pk_fma_f32 v[148:149], v[224:225], s[56:57], v[14:15]
v_pk_fma_f32 v[150:151], v[226:227], s[56:57], v[14:15]
v_pk_fma_f32 v[152:153], v[228:229], s[56:57], v[14:15]
v_pk_fma_f32 v[154:155], v[230:231], s[56:57], v[14:15]
v_exp_f32 v148, v148 clamp
v_max_f32 v224, s53, v224
v_exp_f32 v149, v149 clamp
v_max_f32 v225, s53, v225
v_exp_f32 v150, v150 clamp
v_max_f32 v226, s53, v226
v_exp_f32 v151, v151 clamp
v_max_f32 v227, s53, v227
v_exp_f32 v152, v152 clamp
v_max_f32 v228, s53, v228
v_exp_f32 v153, v153 clamp
v_max_f32 v229, s53, v229
v_exp_f32 v154, v154 clamp
v_max_f32 v230, s53, v230
v_exp_f32 v155, v155 clamp
v_max_f32 v231, s53, v231
v_pk_add_f32 v[224:225], v[224:225], v[148:149]
v_pk_add_f32 v[226:227], v[226:227], v[150:151]
v_pk_add_f32 v[228:229], v[228:229], v[152:153]
v_pk_add_f32 v[230:231], v[230:231], v[154:155]
v_cvt_pk_bf16_f32 v38, v224, v225
v_cvt_pk_bf16_f32 v39, v226, v227
v_cvt_pk_bf16_f32 v48, v228, v229
v_cvt_pk_bf16_f32 v49, v230, v231
v_pk_fma_f32 v[148:149], v[232:233], s[56:57], v[14:15]
v_pk_fma_f32 v[150:151], v[234:235], s[56:57], v[14:15]
v_pk_fma_f32 v[152:153], v[236:237], s[56:57], v[14:15]
v_pk_fma_f32 v[154:155], v[238:239], s[56:57], v[14:15]
v_exp_f32 v148, v148 clamp
v_max_f32 v232, s53, v232
v_exp_f32 v149, v149 clamp
v_max_f32 v233, s53, v233
v_exp_f32 v150, v150 clamp
v_max_f32 v234, s53, v234
v_exp_f32 v151, v151 clamp
v_max_f32 v235, s53, v235
v_exp_f32 v152, v152 clamp
v_max_f32 v236, s53, v236
v_exp_f32 v153, v153 clamp
v_max_f32 v237, s53, v237
v_exp_f32 v154, v154 clamp
v_max_f32 v238, s53, v238
v_exp_f32 v155, v155 clamp
v_max_f32 v239, s53, v239
v_pk_add_f32 v[232:233], v[232:233], v[148:149]
v_pk_add_f32 v[234:235], v[234:235], v[150:151]
v_pk_add_f32 v[236:237], v[236:237], v[152:153]
v_pk_add_f32 v[238:239], v[238:239], v[154:155]
v_cvt_pk_bf16_f32 v40, v232, v233
v_cvt_pk_bf16_f32 v41, v234, v235
v_cvt_pk_bf16_f32 v50, v236, v237
v_cvt_pk_bf16_f32 v51, v238, v239
v_pk_fma_f32 v[148:149], v[240:241], s[56:57], v[14:15]
v_pk_fma_f32 v[150:151], v[242:243], s[56:57], v[14:15]
v_pk_fma_f32 v[152:153], v[244:245], s[56:57], v[14:15]
v_pk_fma_f32 v[154:155], v[246:247], s[56:57], v[14:15]
v_exp_f32 v148, v148 clamp
v_max_f32 v240, s53, v240
v_exp_f32 v149, v149 clamp
v_max_f32 v241, s53, v241
v_exp_f32 v150, v150 clamp
v_max_f32 v242, s53, v242
v_exp_f32 v151, v151 clamp
v_max_f32 v243, s53, v243
v_exp_f32 v152, v152 clamp
v_max_f32 v244, s53, v244
v_exp_f32 v153, v153 clamp
v_max_f32 v245, s53, v245
v_exp_f32 v154, v154 clamp
v_max_f32 v246, s53, v246
v_exp_f32 v155, v155 clamp
v_max_f32 v247, s53, v247
v_pk_add_f32 v[240:241], v[240:241], v[148:149]
v_pk_add_f32 v[242:243], v[242:243], v[150:151]
v_pk_add_f32 v[244:245], v[244:245], v[152:153]
v_pk_add_f32 v[246:247], v[246:247], v[154:155]
v_cvt_pk_bf16_f32 v42, v240, v241
v_cvt_pk_bf16_f32 v43, v242, v243
v_cvt_pk_bf16_f32 v52, v244, v245
v_cvt_pk_bf16_f32 v53, v246, v247
v_pk_fma_f32 v[148:149], v[248:249], s[56:57], v[14:15]
v_pk_fma_f32 v[150:151], v[250:251], s[56:57], v[14:15]
v_pk_fma_f32 v[152:153], v[252:253], s[56:57], v[14:15]
v_pk_fma_f32 v[154:155], v[254:255], s[56:57], v[14:15]
v_exp_f32 v148, v148 clamp
v_max_f32 v248, s53, v248
v_exp_f32 v149, v149 clamp
v_max_f32 v249, s53, v249
v_exp_f32 v150, v150 clamp
v_max_f32 v250, s53, v250
v_exp_f32 v151, v151 clamp
v_max_f32 v251, s53, v251
v_exp_f32 v152, v152 clamp
v_max_f32 v252, s53, v252
v_exp_f32 v153, v153 clamp
v_max_f32 v253, s53, v253
v_exp_f32 v154, v154 clamp
v_max_f32 v254, s53, v254
v_exp_f32 v155, v155 clamp
v_max_f32 v255, s53, v255
v_pk_add_f32 v[248:249], v[248:249], v[148:149]
v_pk_add_f32 v[250:251], v[250:251], v[150:151]
v_pk_add_f32 v[252:253], v[252:253], v[152:153]
v_pk_add_f32 v[254:255], v[254:255], v[154:155]
v_cvt_pk_bf16_f32 v44, v248, v249
v_cvt_pk_bf16_f32 v45, v250, v251
v_cvt_pk_bf16_f32 v54, v252, v253
v_cvt_pk_bf16_f32 v55, v254, v255
s_barrier
ds_read_b64 v[116:117], v16 offset:6656
ds_read_b64 v[118:119], v16 offset:7168
ds_read_b64 v[120:121], v16 offset:7680
ds_read_b64 v[122:123], v16 offset:8192
ds_read_b64 v[126:127], v16 offset:8704
ds_read_b64 v[84:85], v16 offset:2048
ds_read_b64 v[86:87], v16 offset:0
ds_read_b64 v[88:89], v16 offset:4608
ds_read_b64 v[90:91], v16 offset:2560
ds_read_b64 v[94:95], v16 offset:512
ds_read_b64 v[96:97], v16 offset:5120
ds_read_b64 v[98:99], v16 offset:3072
ds_read_b64 v[102:103], v16 offset:1024
ds_read_b64 v[104:105], v16 offset:5632
ds_read_b64 v[106:107], v16 offset:3584
ds_read_b64 v[110:111], v16 offset:1536
ds_read_b64 v[112:113], v16 offset:6144
ds_read_b64 v[114:115], v16 offset:4096
s_waitcnt lgkmcnt(13)
v_mfma_f32_16x16x32_bf16 v[148:151], v[116:119], v[36:39], v[28:31]
v_mfma_f32_16x16x32_bf16 v[152:155], v[116:119], v[46:49], v[28:31]
v_mfma_f32_16x16x32_bf16 v[148:151], v[120:123], v[40:43], v[148:151]
v_mfma_f32_16x16x32_bf16 v[152:155], v[120:123], v[50:53], v[152:155]
v_mfma_f32_16x16x32_bf16 v[148:151], v[124:127], v[42:45], v[148:151]
v_mfma_f32_16x16x32_bf16 v[152:155], v[124:127], v[52:55], v[152:155]
s_waitcnt lgkmcnt(0)
v_mfma_f32_16x16x32_bf16 v[188:191], v[88:91], v[36:39], 0
v_mfma_f32_16x16x32_bf16 v[192:195], v[96:99], v[38:41], 0
v_mfma_f32_16x16x32_bf16 v[196:199], v[104:107], v[40:43], 0
v_mfma_f32_16x16x32_bf16 v[184:187], v[84:87], v[36:39], 0
v_mfma_f32_16x16x32_bf16 v[200:203], v[112:115], v[42:45], 0
v_mfma_f32_16x16x32_bf16 v[188:191], v[92:95], v[38:41], v[188:191]
v_mfma_f32_16x16x32_bf16 v[192:195], v[100:103], v[40:43], v[192:195]
v_mfma_f32_16x16x32_bf16 v[196:199], v[108:111], v[42:45], v[196:199]
v_mfma_f32_16x16x32_bf16 v[208:211], v[88:91], v[46:49], 0
v_rcp_f32 v148, v148
v_mfma_f32_16x16x32_bf16 v[212:215], v[96:99], v[48:51], 0
v_rcp_f32 v149, v149
v_mfma_f32_16x16x32_bf16 v[216:219], v[104:107], v[50:53], 0
v_rcp_f32 v150, v150
v_mfma_f32_16x16x32_bf16 v[204:207], v[84:87], v[46:49], 0
v_rcp_f32 v151, v151
v_mfma_f32_16x16x32_bf16 v[220:223], v[112:115], v[52:55], 0
v_rcp_f32 v152, v152
v_mfma_f32_16x16x32_bf16 v[208:211], v[92:95], v[48:51], v[208:211]
v_rcp_f32 v153, v153
v_mfma_f32_16x16x32_bf16 v[212:215], v[100:103], v[50:53], v[212:215]
v_rcp_f32 v154, v154
v_mfma_f32_16x16x32_bf16 v[216:219], v[108:111], v[52:55], v[216:219]
v_rcp_f32 v155, v155
v_pk_mul_f32 v[184:185], v[184:185], v[148:149] op_sel:[0,0] op_sel_hi:[1,0]
v_cvt_pk_bf16_f32 v18, v184, v185
v_pk_mul_f32 v[186:187], v[186:187], v[148:149] op_sel:[0,0] op_sel_hi:[1,0]
v_cvt_pk_bf16_f32 v19, v186, v187
v_pk_mul_f32 v[200:201], v[200:201], v[150:151] op_sel:[0,1] op_sel_hi:[1,1]
v_cvt_pk_bf16_f32 v26, v200, v201
v_pk_mul_f32 v[202:203], v[202:203], v[150:151] op_sel:[0,1] op_sel_hi:[1,1]
v_cvt_pk_bf16_f32 v27, v202, v203
v_cndmask_b32 v17, v149, v148, s[32:33]
v_pk_mul_f32 v[188:189], v[188:189], v[16:17] op_sel:[0,1] op_sel_hi:[1,1]
v_cvt_pk_bf16_f32 v20, v188, v189
v_pk_mul_f32 v[190:191], v[190:191], v[148:149] op_sel:[0,1] op_sel_hi:[1,1]
v_cvt_pk_bf16_f32 v21, v190, v191
v_cndmask_b32 v17, v150, v149, s[32:33]
v_pk_mul_f32 v[192:193], v[192:193], v[16:17] op_sel:[0,1] op_sel_hi:[1,1]
v_cvt_pk_bf16_f32 v22, v192, v193
v_cndmask_b32 v17, v150, v149, s[32:33]
v_pk_mul_f32 v[194:195], v[194:195], v[16:17] op_sel:[0,1] op_sel_hi:[1,1]
v_cvt_pk_bf16_f32 v23, v194, v195
v_cndmask_b32 v17, v151, v150, s[34:35]
v_pk_mul_f32 v[196:197], v[196:197], v[16:17] op_sel:[0,1] op_sel_hi:[1,1]
v_cvt_pk_bf16_f32 v24, v196, v197
v_cndmask_b32 v17, v151, v150, s[32:33]
v_pk_mul_f32 v[198:199], v[198:199], v[16:17] op_sel:[0,1] op_sel_hi:[1,1]
v_cvt_pk_bf16_f32 v25, v198, v199
buffer_store_dwordx4 v[18:21], v8, s[16:19], 0 offen sc1
buffer_store_dwordx4 v[22:25], v8, s[16:19], 0 offen offset:1024 sc1
buffer_store_dwordx2 v[26:27], v9, s[16:19], 0 offen sc1
v_pk_mul_f32 v[204:205], v[204:205], v[152:153] op_sel:[0,0] op_sel_hi:[1,0]
v_cvt_pk_bf16_f32 v28, v204, v205
v_pk_mul_f32 v[206:207], v[206:207], v[152:153] op_sel:[0,0] op_sel_hi:[1,0]
v_cvt_pk_bf16_f32 v29, v206, v207
v_pk_mul_f32 v[220:221], v[220:221], v[154:155] op_sel:[0,1] op_sel_hi:[1,1]
v_cvt_pk_bf16_f32 v36, v220, v221
v_pk_mul_f32 v[222:223], v[222:223], v[154:155] op_sel:[0,1] op_sel_hi:[1,1]
v_cvt_pk_bf16_f32 v37, v222, v223
v_cndmask_b32 v17, v153, v152, s[32:33]
v_pk_mul_f32 v[208:209], v[208:209], v[16:17] op_sel:[0,1] op_sel_hi:[1,1]
v_cvt_pk_bf16_f32 v30, v208, v209
v_pk_mul_f32 v[210:211], v[210:211], v[152:153] op_sel:[0,1] op_sel_hi:[1,1]
v_cvt_pk_bf16_f32 v31, v210, v211
v_cndmask_b32 v17, v154, v153, s[32:33]
v_pk_mul_f32 v[212:213], v[212:213], v[16:17] op_sel:[0,1] op_sel_hi:[1,1]
v_cvt_pk_bf16_f32 v32, v212, v213
v_cndmask_b32 v17, v154, v153, s[32:33]
v_pk_mul_f32 v[214:215], v[214:215], v[16:17] op_sel:[0,1] op_sel_hi:[1,1]
v_cvt_pk_bf16_f32 v33, v214, v215
v_cndmask_b32 v17, v155, v154, s[34:35]
v_pk_mul_f32 v[216:217], v[216:217], v[16:17] op_sel:[0,1] op_sel_hi:[1,1]
v_cvt_pk_bf16_f32 v34, v216, v217
v_cndmask_b32 v17, v155, v154, s[32:33]
v_pk_mul_f32 v[218:219], v[218:219], v[16:17] op_sel:[0,1] op_sel_hi:[1,1]
v_cvt_pk_bf16_f32 v35, v218, v219
s_movk_i32 s50, 18432
buffer_store_dwordx4 v[28:31], v8, s[16:19], s50 offen sc1
buffer_store_dwordx4 v[32:35], v8, s[16:19], s50 offen offset:1024 sc1
buffer_store_dwordx2 v[36:37], v9, s[16:19], s50 offen sc1
L_P2:
s_and_b32 s7, s4, 3
s_lshl_b32 s53, s7, 3
s_lshr_b32 s57, 0x07050200, s53
s_and_b32 s57, s57, 0xff
s_lshr_b32 s53, s4, 2
s_mul_i32 s53, s53, 9
s_add_u32 s57, s57, s53
s_lshl_b32 s57, s57, 6
s_cmp_eq_u32 s7, 1
s_cselect_b32 s59, 64, 0
s_cmp_lt_u32 s7, 2
s_cselect_b32 s39, 12, 8
v_lshrrev_b32 v40, 5, v0
v_lshlrev_b32 v40, 4, v40
v_bfe_u32 v41, v0, 4, 1
v_lshl_add_u32 v40, v41, 2, v40
v_bfe_u32 v42, v0, 2, 2
v_add_u32 v40, v40, v42
v_mul_u32_u24 v40, 192, v40
v_and_b32 v42, 3, v0
v_lshl_add_u32 v40, v42, 3, v40
v_add_u32 v40, 77824, v40
v_lshl_add_u32 v42, v41, 5, v40
v_xor_b32 v41, 1, v41
v_lshl_add_u32 v15, v41, 5, v40
v_add_u32 v1, s59, v42
v_add_u32 v2, s59, v15
s_lshl_b32 s7, s59, 1
s_sub_u32 s38, 128, s7
v_add_u32 v3, s38, v42
v_add_u32 v4, s38, v15
s_mul_i32 s7, s59, 288
s_add_u32 s53, s58, s7
v_lshl_add_u32 v5, v0, 4, s53
s_sub_u32 s53, s58, s7
s_add_u32 s53, s53, 18432
v_lshl_add_u32 v6, v0, 4, s53
s_mul_i32 s40, s3, 5632
s_add_u32 s40, s40, 52224
v_and_b32 v40, 15, v0
v_lshrrev_b32 v41, 4, v0
v_lshl_add_u32 v41, v41, 3, s40
v_mul_u32_u24 v42, 208, v40
v_add_u32 v42, v42, v41
v_add_u32 v7, s59, v42
v_add_u32 v8, s38, v42
v_mul_u32_u24 v42, 144, v40
v_add_u32 v42, 3328, v42
v_add_u32 v9, v42, v41
s_lshr_b32 s7, s3, 1
s_and_b32 s53, s3, 1
s_lshl_b32 s53, s53, 5
s_lshl_b32 s54, s3, 5
s_cmp_eq_u32 s6, 0
s_cselect_b32 s42, s7, 0
s_cselect_b32 s43, s53, s54
s_cselect_b32 s55, 1, 0
s_lshl_b32 s56, s42, 3
s_lshl_b32 s7, s5, 7
s_add_u32 s42, s42, s7
s_mul_i32 s7, s6, 1152
s_add_u32 s57, s57, s7
s_lshr_b32 s7, s59, 2
s_add_u32 s41, s43, s7
s_sub_u32 s43, s43, s7
s_add_u32 s43, s43, 16
s_add_u32 s59, s59, s57
v_mov_b32 v14, 0x80000000
v_add_u32 v40, 0, v0
v_mul_u32_u24 v41, 5462, v40
v_lshrrev_b32 v41, 16, v41
v_mad_i32_i24 v40, v41, -12, v40
v_mul_u32_u24 v42, 208, v41
v_lshl_add_u32 v42, v40, 4, v42
v_add_u32 v10, s40, v42
v_cmp_gt_u32 vcc, s39, v40
v_add_u32 v41, s41, v41
v_xor_b32 v41, s56, v41
v_lshlrev_b32 v41, s55, v41
v_add_u32 v41, s42, v41
v_mul_u32_u24 v41, 2304, v41
v_lshl_add_u32 v41, v40, 4, v41
v_add_u32 v43, s57, v41
v_cndmask_b32 v43, v14, v43, vcc
v_add_u32 v40, 64, v0
v_mul_u32_u24 v41, 5462, v40
v_lshrrev_b32 v41, 16, v41
v_mad_i32_i24 v40, v41, -12, v40
v_mul_u32_u24 v42, 208, v41
v_lshl_add_u32 v42, v40, 4, v42
v_add_u32 v11, s40, v42
v_cmp_gt_u32 vcc, s39, v40
v_add_u32 v41, s41, v41
v_xor_b32 v41, s56, v41
v_lshlrev_b32 v41, s55, v41
v_add_u32 v41, s42, v41
v_mul_u32_u24 v41, 2304, v41
v_lshl_add_u32 v41, v40, 4, v41
v_add_u32 v44, s57, v41
v_cndmask_b32 v44, v14, v44, vcc
v_add_u32 v40, 128, v0
v_mul_u32_u24 v41, 5462, v40
v_lshrrev_b32 v41, 16, v41
v_mad_i32_i24 v40, v41, -12, v40
v_mul_u32_u24 v42, 208, v41
v_lshl_add_u32 v42, v40, 4, v42
v_add_u32 v12, s40, v42
v_cmp_gt_u32 vcc, s39, v40
v_add_u32 v41, s41, v41
v_xor_b32 v41, s56, v41
v_lshlrev_b32 v41, s55, v41
v_add_u32 v41, s42, v41
v_mul_u32_u24 v41, 2304, v41
v_lshl_add_u32 v41, v40, 4, v41
v_add_u32 v45, s57, v41
v_cndmask_b32 v45, v14, v45, vcc
v_and_b32 v40, 7, v0
v_lshrrev_b32 v41, 3, v0
v_mul_u32_u24 v42, 144, v41
v_lshl_add_u32 v42, v40, 4, v42
v_add_u32 v42, 3328, v42
v_add_u32 v13, s40, v42
v_add3_u32 v41, v41, s43, 0
v_xor_b32 v41, s56, v41
v_lshlrev_b32 v41, s55, v41
v_add_u32 v41, s42, v41
v_mul_u32_u24 v41, 2304, v41
v_lshl_add_u32 v41, v40, 4, v41
v_add_u32 v46, s59, v41
v_and_b32 v40, 7, v0
v_lshrrev_b32 v41, 3, v0
v_add3_u32 v41, v41, s43, 8
v_xor_b32 v41, s56, v41
v_lshlrev_b32 v41, s55, v41
v_add_u32 v41, s42, v41
v_mul_u32_u24 v41, 2304, v41
v_lshl_add_u32 v41, v40, 4, v41
v_add_u32 v47, s59, v41
s_and_b32 s7, s5, 3
s_lshl_b32 s7, s7, 3
s_lshr_b32 s7, 0x14100800, s7
s_and_b32 s7, s7, 0xff
s_lshr_b32 s37, 0x7654321, s7
s_sub_u32 s7, 28, s7
s_lshl_b32 s7, 0x7654321, s7
s_or_b32 s37, s37, s7
s_lshl_b32 s37, s37, 4
s_mul_i32 s7, s4, 0x11111111
s_add_u32 s37, s37, s7
s_and_b32 s37, s37, 0x77777777
s_movk_i32 s8, 16384
s_bfe_u32 s7, s37, 0x30004
s_lshl_b32 s10, s7, 11
s_bfe_u32 s7, s37, 0x30008
s_lshl_b32 s11, s7, 11
s_bfe_u32 s7, s37, 0x3000c
s_lshl_b32 s12, s7, 11
s_bfe_u32 s7, s37, 0x30010
s_lshl_b32 s13, s7, 11
s_bfe_u32 s7, s37, 0x30014
s_lshl_b32 s14, s7, 11
s_bfe_u32 s7, s37, 0x30018
s_lshl_b32 s15, s7, 11
s_bfe_u32 s7, s37, 0x3001c
s_lshl_b32 s36, s7, 11
s_waitcnt vmcnt(0)
s_barrier
s_cmp_eq_u32 s38, 0
s_cbranch_scc0 L_P2_ns
v_swap_b32 v18, v28
v_swap_b32 v19, v29
v_swap_b32 v20, v30
v_swap_b32 v21, v31
v_swap_b32 v22, v32
v_swap_b32 v23, v33
v_swap_b32 v24, v34
v_swap_b32 v25, v35
L_P2_ns:
ds_read_b64_tr_b16 v[48:49], v1 offset:0
ds_read_b64_tr_b16 v[50:51], v1 offset:1536
ds_read_b64_tr_b16 v[64:65], v3 offset:0
ds_read_b64_tr_b16 v[66:67], v3 offset:1536
ds_read_b64_tr_b16 v[52:53], v2 offset:0
ds_read_b64_tr_b16 v[54:55], v2 offset:1536
ds_read_b64_tr_b16 v[56:57], v1 offset:64
ds_read_b64_tr_b16 v[58:59], v1 offset:1600
ds_read_b64_tr_b16 v[68:69], v4 offset:0
ds_read_b64_tr_b16 v[70:71], v4 offset:1536
ds_read_b64_tr_b16 v[60:61], v2 offset:64
ds_read_b64_tr_b16 v[62:63], v2 offset:1600
s_waitcnt lgkmcnt(6)
v_mfma_f32_16x16x32_bf16 v[72:75], v[48:51], v[18:21], 0
v_mfma_f32_16x16x32_bf16 v[76:79], v[48:51], v[28:31], 0
ds_read_b64_tr_b16 v[48:49], v1 offset:6144
v_mfma_f32_16x16x32_bf16 v[80:83], v[64:67], v[18:21], 0
ds_read_b64_tr_b16 v[50:51], v1 offset:7680
ds_read_b64_tr_b16 v[64:65], v3 offset:6144
v_mfma_f32_16x16x32_bf16 v[84:87], v[52:55], v[18:21], 0
ds_read_b64_tr_b16 v[66:67], v3 offset:7680
v_mfma_f32_16x16x32_bf16 v[88:91], v[52:55], v[28:31], 0
ds_read_b64_tr_b16 v[52:53], v2 offset:6144
s_waitcnt lgkmcnt(5)
v_mfma_f32_16x16x32_bf16 v[92:95], v[56:59], v[18:21], 0
ds_read_b64_tr_b16 v[54:55], v2 offset:7680
v_mfma_f32_16x16x32_bf16 v[96:99], v[56:59], v[28:31], 0
ds_read_b64_tr_b16 v[56:57], v1 offset:6208
v_mfma_f32_16x16x32_bf16 v[100:103], v[68:71], v[18:21], 0
ds_read_b64_tr_b16 v[58:59], v1 offset:7744
ds_read_b64_tr_b16 v[68:69], v4 offset:6144
v_mfma_f32_16x16x32_bf16 v[104:107], v[60:63], v[18:21], 0
ds_read_b64_tr_b16 v[70:71], v4 offset:7680
v_mfma_f32_16x16x32_bf16 v[108:111], v[60:63], v[28:31], 0
ds_read_b64_tr_b16 v[60:61], v2 offset:6208
s_waitcnt lgkmcnt(5)
v_mfma_f32_16x16x32_bf16 v[72:75], v[48:51], v[22:25], v[72:75]
ds_read_b64_tr_b16 v[62:63], v2 offset:7744
v_mfma_f32_16x16x32_bf16 v[76:79], v[48:51], v[32:35], v[76:79]
v_add_u32 v1, 70656, v1
ds_read_b64_tr_b16 v[48:49], v1 offset:0
v_mfma_f32_16x16x32_bf16 v[80:83], v[64:67], v[22:25], v[80:83]
ds_read_b64_tr_b16 v[50:51], v1 offset:1536
v_add_u32 v3, 70656, v3
ds_read_b64_tr_b16 v[64:65], v3 offset:0
v_mfma_f32_16x16x32_bf16 v[84:87], v[52:55], v[22:25], v[84:87]
ds_read_b64_tr_b16 v[66:67], v3 offset:1536
v_mfma_f32_16x16x32_bf16 v[88:91], v[52:55], v[32:35], v[88:91]
v_add_u32 v2, 70656, v2
ds_read_b64_tr_b16 v[52:53], v2 offset:0
s_waitcnt lgkmcnt(5)
v_mfma_f32_16x16x32_bf16 v[92:95], v[56:59], v[22:25], v[92:95]
ds_read_b64_tr_b16 v[54:55], v2 offset:1536
v_mfma_f32_16x16x32_bf16 v[96:99], v[56:59], v[32:35], v[96:99]
ds_read_b64_tr_b16 v[56:57], v1 offset:64
v_mfma_f32_16x16x32_bf16 v[100:103], v[68:71], v[22:25], v[100:103]
ds_read_b64_tr_b16 v[58:59], v1 offset:1600
v_add_u32 v4, 70656, v4
ds_read_b64_tr_b16 v[68:69], v4 offset:0
v_mfma_f32_16x16x32_bf16 v[104:107], v[60:63], v[22:25], v[104:107]
ds_read_b64_tr_b16 v[70:71], v4 offset:1536
v_mfma_f32_16x16x32_bf16 v[108:111], v[60:63], v[32:35], v[108:111]
ds_read_b64_tr_b16 v[60:61], v2 offset:64
s_barrier
buffer_load_dwordx4 v[112:115], v5, s[16:19], s8 offen offset:0 sc1
buffer_load_dwordx4 v[116:119], v6, s[16:19], s8 offen offset:0 sc1
buffer_load_dwordx4 v[120:123], v5, s[16:19], s8 offen offset:1024 sc1
buffer_load_dwordx4 v[124:127], v6, s[16:19], s8 offen offset:1024 sc1
buffer_load_dwordx4 v[144:147], v5, s[16:19], s10 offen offset:0 sc1
buffer_load_dwordx4 v[148:151], v6, s[16:19], s10 offen offset:0 sc1
buffer_load_dwordx4 v[152:155], v5, s[16:19], s10 offen offset:1024 sc1
buffer_load_dwordx4 v[156:159], v6, s[16:19], s10 offen offset:1024 sc1
s_waitcnt vmcnt(6) lgkmcnt(5)
v_mfma_f32_16x16x32_bf16 v[72:75], v[48:51], v[112:115], v[72:75]
ds_read_b64_tr_b16 v[62:63], v2 offset:1600
buffer_load_dwordx4 v[160:163], v5, s[16:19], s11 offen offset:0 sc1
v_mfma_f32_16x16x32_bf16 v[76:79], v[48:51], v[116:119], v[76:79]
ds_read_b64_tr_b16 v[48:49], v1 offset:6144
v_mfma_f32_16x16x32_bf16 v[80:83], v[64:67], v[112:115], v[80:83]
ds_read_b64_tr_b16 v[50:51], v1 offset:7680
ds_read_b64_tr_b16 v[64:65], v3 offset:6144
v_mfma_f32_16x16x32_bf16 v[84:87], v[52:55], v[112:115], v[84:87]
ds_read_b64_tr_b16 v[66:67], v3 offset:7680
buffer_load_dwordx4 v[164:167], v6, s[16:19], s11 offen offset:0 sc1
v_mfma_f32_16x16x32_bf16 v[88:91], v[52:55], v[116:119], v[88:91]
ds_read_b64_tr_b16 v[52:53], v2 offset:6144
s_waitcnt lgkmcnt(5)
v_mfma_f32_16x16x32_bf16 v[92:95], v[56:59], v[112:115], v[92:95]
ds_read_b64_tr_b16 v[54:55], v2 offset:7680
v_mfma_f32_16x16x32_bf16 v[96:99], v[56:59], v[116:119], v[96:99]
ds_read_b64_tr_b16 v[56:57], v1 offset:6208
buffer_load_dwordx4 v[168:171], v5, s[16:19], s11 offen offset:1024 sc1
v_mfma_f32_16x16x32_bf16 v[100:103], v[68:71], v[112:115], v[100:103]
ds_read_b64_tr_b16 v[58:59], v1 offset:7744
ds_read_b64_tr_b16 v[68:69], v4 offset:6144
v_mfma_f32_16x16x32_bf16 v[104:107], v[60:63], v[112:115], v[104:107]
ds_read_b64_tr_b16 v[70:71], v4 offset:7680
v_mfma_f32_16x16x32_bf16 v[108:111], v[60:63], v[116:119], v[108:111]
ds_read_b64_tr_b16 v[60:61], v2 offset:6208
s_waitcnt vmcnt(7) lgkmcnt(5)
v_mfma_f32_16x16x32_bf16 v[72:75], v[48:51], v[120:123], v[72:75]
ds_read_b64_tr_b16 v[62:63], v2 offset:7744
buffer_load_dwordx4 v[172:175], v6, s[16:19], s11 offen offset:1024 sc1
v_mfma_f32_16x16x32_bf16 v[76:79], v[48:51], v[124:127], v[76:79]
v_add_u32 v1, 4294896640, v1
ds_read_b64_tr_b16 v[48:49], v1 offset:12288
v_mfma_f32_16x16x32_bf16 v[80:83], v[64:67], v[120:123], v[80:83]
ds_read_b64_tr_b16 v[50:51], v1 offset:13824
v_add_u32 v3, 4294896640, v3
ds_read_b64_tr_b16 v[64:65], v3 offset:12288
v_mfma_f32_16x16x32_bf16 v[84:87], v[52:55], v[120:123], v[84:87]
ds_read_b64_tr_b16 v[66:67], v3 offset:13824
buffer_load_dwordx4 v[176:179], v5, s[16:19], s12 offen offset:0 sc1
v_mfma_f32_16x16x32_bf16 v[88:91], v[52:55], v[124:127], v[88:91]
v_add_u32 v2, 4294896640, v2
ds_read_b64_tr_b16 v[52:53], v2 offset:12288
s_waitcnt lgkmcnt(5)
v_mfma_f32_16x16x32_bf16 v[92:95], v[56:59], v[120:123], v[92:95]
ds_read_b64_tr_b16 v[54:55], v2 offset:13824
v_mfma_f32_16x16x32_bf16 v[96:99], v[56:59], v[124:127], v[96:99]
ds_read_b64_tr_b16 v[56:57], v1 offset:12352
buffer_load_dwordx4 v[180:183], v6, s[16:19], s12 offen offset:0 sc1
v_mfma_f32_16x16x32_bf16 v[100:103], v[68:71], v[120:123], v[100:103]
ds_read_b64_tr_b16 v[58:59], v1 offset:13888
v_add_u32 v4, 4294896640, v4
ds_read_b64_tr_b16 v[68:69], v4 offset:12288
v_mfma_f32_16x16x32_bf16 v[104:107], v[60:63], v[120:123], v[104:107]
ds_read_b64_tr_b16 v[70:71], v4 offset:13824
v_mfma_f32_16x16x32_bf16 v[108:111], v[60:63], v[124:127], v[108:111]
ds_read_b64_tr_b16 v[60:61], v2 offset:12352
s_waitcnt vmcnt(8) lgkmcnt(5)
v_mfma_f32_16x16x32_bf16 v[72:75], v[48:51], v[144:147], v[72:75]
ds_read_b64_tr_b16 v[62:63], v2 offset:13888
buffer_load_dwordx4 v[184:187], v5, s[16:19], s12 offen offset:1024 sc1
v_mfma_f32_16x16x32_bf16 v[76:79], v[48:51], v[148:151], v[76:79]
ds_read_b64_tr_b16 v[48:49], v1 offset:18432
v_mfma_f32_16x16x32_bf16 v[80:83], v[64:67], v[144:147], v[80:83]
ds_read_b64_tr_b16 v[50:51], v1 offset:19968
ds_read_b64_tr_b16 v[64:65], v3 offset:18432
v_mfma_f32_16x16x32_bf16 v[84:87], v[52:55], v[144:147], v[84:87]
ds_read_b64_tr_b16 v[66:67], v3 offset:19968
buffer_load_dwordx4 v[188:191], v6, s[16:19], s12 offen offset:1024 sc1
v_mfma_f32_16x16x32_bf16 v[88:91], v[52:55], v[148:151], v[88:91]
ds_read_b64_tr_b16 v[52:53], v2 offset:18432
s_waitcnt lgkmcnt(5)
v_mfma_f32_16x16x32_bf16 v[92:95], v[56:59], v[144:147], v[92:95]
ds_read_b64_tr_b16 v[54:55], v2 offset:19968
v_mfma_f32_16x16x32_bf16 v[96:99], v[56:59], v[148:151], v[96:99]
ds_read_b64_tr_b16 v[56:57], v1 offset:18496
v_mfma_f32_16x16x32_bf16 v[100:103], v[68:71], v[144:147], v[100:103]
ds_read_b64_tr_b16 v[58:59], v1 offset:20032
ds_read_b64_tr_b16 v[68:69], v4 offset:18432
v_mfma_f32_16x16x32_bf16 v[104:107], v[60:63], v[144:147], v[104:107]
ds_read_b64_tr_b16 v[70:71], v4 offset:19968
v_mfma_f32_16x16x32_bf16 v[108:111], v[60:63], v[148:151], v[108:111]
ds_read_b64_tr_b16 v[60:61], v2 offset:18496
s_waitcnt vmcnt(8) lgkmcnt(5)
v_mfma_f32_16x16x32_bf16 v[72:75], v[48:51], v[152:155], v[72:75]
ds_read_b64_tr_b16 v[62:63], v2 offset:20032
buffer_load_dwordx4 v[192:195], v5, s[16:19], s13 offen offset:0 sc1
v_mfma_f32_16x16x32_bf16 v[76:79], v[48:51], v[156:159], v[76:79]
ds_read_b64_tr_b16 v[48:49], v1 offset:24576
v_mfma_f32_16x16x32_bf16 v[80:83], v[64:67], v[152:155], v[80:83]
ds_read_b64_tr_b16 v[50:51], v1 offset:26112
ds_read_b64_tr_b16 v[64:65], v3 offset:24576
v_mfma_f32_16x16x32_bf16 v[84:87], v[52:55], v[152:155], v[84:87]
ds_read_b64_tr_b16 v[66:67], v3 offset:26112
buffer_load_dwordx4 v[196:199], v6, s[16:19], s13 offen offset:0 sc1
v_mfma_f32_16x16x32_bf16 v[88:91], v[52:55], v[156:159], v[88:91]
ds_read_b64_tr_b16 v[52:53], v2 offset:24576
s_waitcnt lgkmcnt(5)
v_mfma_f32_16x16x32_bf16 v[92:95], v[56:59], v[152:155], v[92:95]
ds_read_b64_tr_b16 v[54:55], v2 offset:26112
v_mfma_f32_16x16x32_bf16 v[96:99], v[56:59], v[156:159], v[96:99]
ds_read_b64_tr_b16 v[56:57], v1 offset:24640
v_mfma_f32_16x16x32_bf16 v[100:103], v[68:71], v[152:155], v[100:103]
ds_read_b64_tr_b16 v[58:59], v1 offset:26176
ds_read_b64_tr_b16 v[68:69], v4 offset:24576
v_mfma_f32_16x16x32_bf16 v[104:107], v[60:63], v[152:155], v[104:107]
ds_read_b64_tr_b16 v[70:71], v4 offset:26112
v_mfma_f32_16x16x32_bf16 v[108:111], v[60:63], v[156:159], v[108:111]
ds_read_b64_tr_b16 v[60:61], v2 offset:24640
s_waitcnt vmcnt(8) lgkmcnt(5)
v_mfma_f32_16x16x32_bf16 v[72:75], v[48:51], v[160:163], v[72:75]
ds_read_b64_tr_b16 v[62:63], v2 offset:26176
buffer_load_dwordx4 v[200:203], v5, s[16:19], s13 offen offset:1024 sc1
v_mfma_f32_16x16x32_bf16 v[76:79], v[48:51], v[164:167], v[76:79]
ds_read_b64_tr_b16 v[48:49], v1 offset:30720
v_mfma_f32_16x16x32_bf16 v[80:83], v[64:67], v[160:163], v[80:83]
ds_read_b64_tr_b16 v[50:51], v1 offset:32256
ds_read_b64_tr_b16 v[64:65], v3 offset:30720
v_mfma_f32_16x16x32_bf16 v[84:87], v[52:55], v[160:163], v[84:87]
ds_read_b64_tr_b16 v[66:67], v3 offset:32256
buffer_load_dwordx4 v[204:207], v6, s[16:19], s13 offen offset:1024 sc1
v_mfma_f32_16x16x32_bf16 v[88:91], v[52:55], v[164:167], v[88:91]
ds_read_b64_tr_b16 v[52:53], v2 offset:30720
s_waitcnt lgkmcnt(5)
v_mfma_f32_16x16x32_bf16 v[92:95], v[56:59], v[160:163], v[92:95]
ds_read_b64_tr_b16 v[54:55], v2 offset:32256
v_mfma_f32_16x16x32_bf16 v[96:99], v[56:59], v[164:167], v[96:99]
ds_read_b64_tr_b16 v[56:57], v1 offset:30784
v_mfma_f32_16x16x32_bf16 v[100:103], v[68:71], v[160:163], v[100:103]
ds_read_b64_tr_b16 v[58:59], v1 offset:32320
ds_read_b64_tr_b16 v[68:69], v4 offset:30720
v_mfma_f32_16x16x32_bf16 v[104:107], v[60:63], v[160:163], v[104:107]
ds_read_b64_tr_b16 v[70:71], v4 offset:32256
v_mfma_f32_16x16x32_bf16 v[108:111], v[60:63], v[164:167], v[108:111]
ds_read_b64_tr_b16 v[60:61], v2 offset:30784
s_waitcnt vmcnt(8) lgkmcnt(5)
v_mfma_f32_16x16x32_bf16 v[72:75], v[48:51], v[168:171], v[72:75]
ds_read_b64_tr_b16 v[62:63], v2 offset:32320
buffer_load_dwordx4 v[208:211], v5, s[16:19], s14 offen offset:0 sc1
v_mfma_f32_16x16x32_bf16 v[76:79], v[48:51], v[172:175], v[76:79]
ds_read_b64_tr_b16 v[48:49], v1 offset:36864
v_mfma_f32_16x16x32_bf16 v[80:83], v[64:67], v[168:171], v[80:83]
ds_read_b64_tr_b16 v[50:51], v1 offset:38400
ds_read_b64_tr_b16 v[64:65], v3 offset:36864
v_mfma_f32_16x16x32_bf16 v[84:87], v[52:55], v[168:171], v[84:87]
ds_read_b64_tr_b16 v[66:67], v3 offset:38400
buffer_load_dwordx4 v[212:215], v6, s[16:19], s14 offen offset:0 sc1
v_mfma_f32_16x16x32_bf16 v[88:91], v[52:55], v[172:175], v[88:91]
ds_read_b64_tr_b16 v[52:53], v2 offset:36864
s_waitcnt lgkmcnt(5)
v_mfma_f32_16x16x32_bf16 v[92:95], v[56:59], v[168:171], v[92:95]
ds_read_b64_tr_b16 v[54:55], v2 offset:38400
v_mfma_f32_16x16x32_bf16 v[96:99], v[56:59], v[172:175], v[96:99]
ds_read_b64_tr_b16 v[56:57], v1 offset:36928
v_mfma_f32_16x16x32_bf16 v[100:103], v[68:71], v[168:171], v[100:103]
ds_read_b64_tr_b16 v[58:59], v1 offset:38464
ds_read_b64_tr_b16 v[68:69], v4 offset:36864
v_mfma_f32_16x16x32_bf16 v[104:107], v[60:63], v[168:171], v[104:107]
ds_read_b64_tr_b16 v[70:71], v4 offset:38400
v_mfma_f32_16x16x32_bf16 v[108:111], v[60:63], v[172:175], v[108:111]
ds_read_b64_tr_b16 v[60:61], v2 offset:36928
s_waitcnt vmcnt(8) lgkmcnt(5)
v_mfma_f32_16x16x32_bf16 v[72:75], v[48:51], v[176:179], v[72:75]
ds_read_b64_tr_b16 v[62:63], v2 offset:38464
buffer_load_dwordx4 v[216:219], v5, s[16:19], s14 offen offset:1024 sc1
v_mfma_f32_16x16x32_bf16 v[76:79], v[48:51], v[180:183], v[76:79]
ds_read_b64_tr_b16 v[48:49], v1 offset:43008
v_mfma_f32_16x16x32_bf16 v[80:83], v[64:67], v[176:179], v[80:83]
ds_read_b64_tr_b16 v[50:51], v1 offset:44544
ds_read_b64_tr_b16 v[64:65], v3 offset:43008
v_mfma_f32_16x16x32_bf16 v[84:87], v[52:55], v[176:179], v[84:87]
ds_read_b64_tr_b16 v[66:67], v3 offset:44544
buffer_load_dwordx4 v[220:223], v6, s[16:19], s14 offen offset:1024 sc1
v_mfma_f32_16x16x32_bf16 v[88:91], v[52:55], v[180:183], v[88:91]
ds_read_b64_tr_b16 v[52:53], v2 offset:43008
s_waitcnt lgkmcnt(5)
v_mfma_f32_16x16x32_bf16 v[92:95], v[56:59], v[176:179], v[92:95]
ds_read_b64_tr_b16 v[54:55], v2 offset:44544
v_mfma_f32_16x16x32_bf16 v[96:99], v[56:59], v[180:183], v[96:99]
ds_read_b64_tr_b16 v[56:57], v1 offset:43072
v_mfma_f32_16x16x32_bf16 v[100:103], v[68:71], v[176:179], v[100:103]
ds_read_b64_tr_b16 v[58:59], v1 offset:44608
ds_read_b64_tr_b16 v[68:69], v4 offset:43008
v_mfma_f32_16x16x32_bf16 v[104:107], v[60:63], v[176:179], v[104:107]
ds_read_b64_tr_b16 v[70:71], v4 offset:44544
v_mfma_f32_16x16x32_bf16 v[108:111], v[60:63], v[180:183], v[108:111]
ds_read_b64_tr_b16 v[60:61], v2 offset:43072
s_waitcnt vmcnt(8) lgkmcnt(5)
v_mfma_f32_16x16x32_bf16 v[72:75], v[48:51], v[184:187], v[72:75]
ds_read_b64_tr_b16 v[62:63], v2 offset:44608
buffer_load_dwordx4 v[224:227], v5, s[16:19], s15 offen offset:0 sc1
v_mfma_f32_16x16x32_bf16 v[76:79], v[48:51], v[188:191], v[76:79]
v_add_u32 v1, 4294889472, v1
ds_read_b64_tr_b16 v[48:49], v1 offset:0
v_mfma_f32_16x16x32_bf16 v[80:83], v[64:67], v[184:187], v[80:83]
ds_read_b64_tr_b16 v[50:51], v1 offset:1536
v_add_u32 v3, 4294889472, v3
ds_read_b64_tr_b16 v[64:65], v3 offset:0
v_mfma_f32_16x16x32_bf16 v[84:87], v[52:55], v[184:187], v[84:87]
ds_read_b64_tr_b16 v[66:67], v3 offset:1536
buffer_load_dwordx4 v[228:231], v6, s[16:19], s15 offen offset:0 sc1
v_mfma_f32_16x16x32_bf16 v[88:91], v[52:55], v[188:191], v[88:91]
v_add_u32 v2, 4294889472, v2
ds_read_b64_tr_b16 v[52:53], v2 offset:0
s_waitcnt lgkmcnt(5)
v_mfma_f32_16x16x32_bf16 v[92:95], v[56:59], v[184:187], v[92:95]
ds_read_b64_tr_b16 v[54:55], v2 offset:1536
v_mfma_f32_16x16x32_bf16 v[96:99], v[56:59], v[188:191], v[96:99]
ds_read_b64_tr_b16 v[56:57], v1 offset:64
v_mfma_f32_16x16x32_bf16 v[100:103], v[68:71], v[184:187], v[100:103]
ds_read_b64_tr_b16 v[58:59], v1 offset:1600
v_add_u32 v4, 4294889472, v4
ds_read_b64_tr_b16 v[68:69], v4 offset:0
v_mfma_f32_16x16x32_bf16 v[104:107], v[60:63], v[184:187], v[104:107]
ds_read_b64_tr_b16 v[70:71], v4 offset:1536
v_mfma_f32_16x16x32_bf16 v[108:111], v[60:63], v[188:191], v[108:111]
ds_read_b64_tr_b16 v[60:61], v2 offset:64
s_waitcnt vmcnt(8) lgkmcnt(5)
v_mfma_f32_16x16x32_bf16 v[72:75], v[48:51], v[192:195], v[72:75]
ds_read_b64_tr_b16 v[62:63], v2 offset:1600
buffer_load_dwordx4 v[232:235], v5, s[16:19], s15 offen offset:1024 sc1
v_mfma_f32_16x16x32_bf16 v[76:79], v[48:51], v[196:199], v[76:79]
ds_read_b64_tr_b16 v[48:49], v1 offset:6144
v_mfma_f32_16x16x32_bf16 v[80:83], v[64:67], v[192:195], v[80:83]
ds_read_b64_tr_b16 v[50:51], v1 offset:7680
ds_read_b64_tr_b16 v[64:65], v3 offset:6144
v_mfma_f32_16x16x32_bf16 v[84:87], v[52:55], v[192:195], v[84:87]
ds_read_b64_tr_b16 v[66:67], v3 offset:7680
buffer_load_dwordx4 v[236:239], v6, s[16:19], s15 offen offset:1024 sc1
v_mfma_f32_16x16x32_bf16 v[88:91], v[52:55], v[196:199], v[88:91]
ds_read_b64_tr_b16 v[52:53], v2 offset:6144
s_waitcnt lgkmcnt(5)
v_mfma_f32_16x16x32_bf16 v[92:95], v[56:59], v[192:195], v[92:95]
ds_read_b64_tr_b16 v[54:55], v2 offset:7680
v_mfma_f32_16x16x32_bf16 v[96:99], v[56:59], v[196:199], v[96:99]
ds_read_b64_tr_b16 v[56:57], v1 offset:6208
v_mfma_f32_16x16x32_bf16 v[100:103], v[68:71], v[192:195], v[100:103]
ds_read_b64_tr_b16 v[58:59], v1 offset:7744
ds_read_b64_tr_b16 v[68:69], v4 offset:6144
v_mfma_f32_16x16x32_bf16 v[104:107], v[60:63], v[192:195], v[104:107]
ds_read_b64_tr_b16 v[70:71], v4 offset:7680
v_mfma_f32_16x16x32_bf16 v[108:111], v[60:63], v[196:199], v[108:111]
ds_read_b64_tr_b16 v[60:61], v2 offset:6208
s_waitcnt vmcnt(8) lgkmcnt(5)
v_mfma_f32_16x16x32_bf16 v[72:75], v[48:51], v[200:203], v[72:75]
ds_read_b64_tr_b16 v[62:63], v2 offset:7744
buffer_load_dwordx4 v[240:243], v5, s[16:19], s36 offen offset:0 sc1
v_mfma_f32_16x16x32_bf16 v[76:79], v[48:51], v[204:207], v[76:79]
ds_read_b64_tr_b16 v[48:49], v1 offset:15360
v_mfma_f32_16x16x32_bf16 v[80:83], v[64:67], v[200:203], v[80:83]
ds_read_b64_tr_b16 v[50:51], v1 offset:16896
ds_read_b64_tr_b16 v[64:65], v3 offset:15360
v_mfma_f32_16x16x32_bf16 v[84:87], v[52:55], v[200:203], v[84:87]
ds_read_b64_tr_b16 v[66:67], v3 offset:16896
buffer_load_dwordx4 v[244:247], v6, s[16:19], s36 offen offset:0 sc1
v_mfma_f32_16x16x32_bf16 v[88:91], v[52:55], v[204:207], v[88:91]
ds_read_b64_tr_b16 v[52:53], v2 offset:15360
s_waitcnt lgkmcnt(5)
v_mfma_f32_16x16x32_bf16 v[92:95], v[56:59], v[200:203], v[92:95]
ds_read_b64_tr_b16 v[54:55], v2 offset:16896
v_mfma_f32_16x16x32_bf16 v[96:99], v[56:59], v[204:207], v[96:99]
ds_read_b64_tr_b16 v[56:57], v1 offset:15424
v_mfma_f32_16x16x32_bf16 v[100:103], v[68:71], v[200:203], v[100:103]
ds_read_b64_tr_b16 v[58:59], v1 offset:16960
ds_read_b64_tr_b16 v[68:69], v4 offset:15360
v_mfma_f32_16x16x32_bf16 v[104:107], v[60:63], v[200:203], v[104:107]
ds_read_b64_tr_b16 v[70:71], v4 offset:16896
v_mfma_f32_16x16x32_bf16 v[108:111], v[60:63], v[204:207], v[108:111]
ds_read_b64_tr_b16 v[60:61], v2 offset:15424
s_waitcnt vmcnt(8) lgkmcnt(5)
v_mfma_f32_16x16x32_bf16 v[72:75], v[48:51], v[208:211], v[72:75]
ds_read_b64_tr_b16 v[62:63], v2 offset:16960
buffer_load_dwordx4 v[248:251], v5, s[16:19], s36 offen offset:1024 sc1
v_mfma_f32_16x16x32_bf16 v[76:79], v[48:51], v[212:215], v[76:79]
ds_read_b64_tr_b16 v[48:49], v1 offset:21504
v_mfma_f32_16x16x32_bf16 v[80:83], v[64:67], v[208:211], v[80:83]
ds_read_b64_tr_b16 v[50:51], v1 offset:23040
ds_read_b64_tr_b16 v[64:65], v3 offset:21504
v_mfma_f32_16x16x32_bf16 v[84:87], v[52:55], v[208:211], v[84:87]
ds_read_b64_tr_b16 v[66:67], v3 offset:23040
buffer_load_dwordx4 v[252:255], v6, s[16:19], s36 offen offset:1024 sc1
v_mfma_f32_16x16x32_bf16 v[88:91], v[52:55], v[212:215], v[88:91]
ds_read_b64_tr_b16 v[52:53], v2 offset:21504
s_waitcnt lgkmcnt(5)
v_mfma_f32_16x16x32_bf16 v[92:95], v[56:59], v[208:211], v[92:95]
ds_read_b64_tr_b16 v[54:55], v2 offset:23040
v_mfma_f32_16x16x32_bf16 v[96:99], v[56:59], v[212:215], v[96:99]
ds_read_b64_tr_b16 v[56:57], v1 offset:21568
v_mfma_f32_16x16x32_bf16 v[100:103], v[68:71], v[208:211], v[100:103]
ds_read_b64_tr_b16 v[58:59], v1 offset:23104
ds_read_b64_tr_b16 v[68:69], v4 offset:21504
v_mfma_f32_16x16x32_bf16 v[104:107], v[60:63], v[208:211], v[104:107]
ds_read_b64_tr_b16 v[70:71], v4 offset:23040
v_mfma_f32_16x16x32_bf16 v[108:111], v[60:63], v[212:215], v[108:111]
ds_read_b64_tr_b16 v[60:61], v2 offset:21568
s_waitcnt vmcnt(8) lgkmcnt(5)
v_mfma_f32_16x16x32_bf16 v[72:75], v[48:51], v[216:219], v[72:75]
ds_read_b64_tr_b16 v[62:63], v2 offset:23104
v_mfma_f32_16x16x32_bf16 v[76:79], v[48:51], v[220:223], v[76:79]
ds_read_b64_tr_b16 v[48:49], v1 offset:27648
v_mfma_f32_16x16x32_bf16 v[80:83], v[64:67], v[216:219], v[80:83]
ds_read_b64_tr_b16 v[50:51], v1 offset:29184
ds_read_b64_tr_b16 v[64:65], v3 offset:27648
v_mfma_f32_16x16x32_bf16 v[84:87], v[52:55], v[216:219], v[84:87]
ds_read_b64_tr_b16 v[66:67], v3 offset:29184
v_mfma_f32_16x16x32_bf16 v[88:91], v[52:55], v[220:223], v[88:91]
ds_read_b64_tr_b16 v[52:53], v2 offset:27648
s_waitcnt lgkmcnt(5)
v_mfma_f32_16x16x32_bf16 v[92:95], v[56:59], v[216:219], v[92:95]
ds_read_b64_tr_b16 v[54:55], v2 offset:29184
v_mfma_f32_16x16x32_bf16 v[96:99], v[56:59], v[220:223], v[96:99]
ds_read_b64_tr_b16 v[56:57], v1 offset:27712
v_mfma_f32_16x16x32_bf16 v[100:103], v[68:71], v[216:219], v[100:103]
ds_read_b64_tr_b16 v[58:59], v1 offset:29248
ds_read_b64_tr_b16 v[68:69], v4 offset:27648
v_mfma_f32_16x16x32_bf16 v[104:107], v[60:63], v[216:219], v[104:107]
ds_read_b64_tr_b16 v[70:71], v4 offset:29184
v_mfma_f32_16x16x32_bf16 v[108:111], v[60:63], v[220:223], v[108:111]
ds_read_b64_tr_b16 v[60:61], v2 offset:27712
s_waitcnt vmcnt(6) lgkmcnt(5)
v_mfma_f32_16x16x32_bf16 v[72:75], v[48:51], v[224:227], v[72:75]
ds_read_b64_tr_b16 v[62:63], v2 offset:29248
v_mfma_f32_16x16x32_bf16 v[76:79], v[48:51], v[228:231], v[76:79]
ds_read_b64_tr_b16 v[48:49], v1 offset:33792
v_mfma_f32_16x16x32_bf16 v[80:83], v[64:67], v[224:227], v[80:83]
ds_read_b64_tr_b16 v[50:51], v1 offset:35328
ds_read_b64_tr_b16 v[64:65], v3 offset:33792
v_mfma_f32_16x16x32_bf16 v[84:87], v[52:55], v[224:227], v[84:87]
ds_read_b64_tr_b16 v[66:67], v3 offset:35328
v_mfma_f32_16x16x32_bf16 v[88:91], v[52:55], v[228:231], v[88:91]
ds_read_b64_tr_b16 v[52:53], v2 offset:33792
s_waitcnt lgkmcnt(5)
v_mfma_f32_16x16x32_bf16 v[92:95], v[56:59], v[224:227], v[92:95]
ds_read_b64_tr_b16 v[54:55], v2 offset:35328
v_mfma_f32_16x16x32_bf16 v[96:99], v[56:59], v[228:231], v[96:99]
ds_read_b64_tr_b16 v[56:57], v1 offset:33856
v_mfma_f32_16x16x32_bf16 v[100:103], v[68:71], v[224:227], v[100:103]
ds_read_b64_tr_b16 v[58:59], v1 offset:35392
ds_read_b64_tr_b16 v[68:69], v4 offset:33792
v_mfma_f32_16x16x32_bf16 v[104:107], v[60:63], v[224:227], v[104:107]
ds_read_b64_tr_b16 v[70:71], v4 offset:35328
v_mfma_f32_16x16x32_bf16 v[108:111], v[60:63], v[228:231], v[108:111]
ds_read_b64_tr_b16 v[60:61], v2 offset:33856
s_waitcnt vmcnt(4) lgkmcnt(5)
v_mfma_f32_16x16x32_bf16 v[72:75], v[48:51], v[232:235], v[72:75]
ds_read_b64_tr_b16 v[62:63], v2 offset:35392
v_mfma_f32_16x16x32_bf16 v[76:79], v[48:51], v[236:239], v[76:79]
ds_read_b64_tr_b16 v[48:49], v1 offset:39936
v_mfma_f32_16x16x32_bf16 v[80:83], v[64:67], v[232:235], v[80:83]
ds_read_b64_tr_b16 v[50:51], v1 offset:41472
ds_read_b64_tr_b16 v[64:65], v3 offset:39936
v_mfma_f32_16x16x32_bf16 v[84:87], v[52:55], v[232:235], v[84:87]
ds_read_b64_tr_b16 v[66:67], v3 offset:41472
v_mfma_f32_16x16x32_bf16 v[88:91], v[52:55], v[236:239], v[88:91]
ds_read_b64_tr_b16 v[52:53], v2 offset:39936
s_waitcnt lgkmcnt(5)
v_mfma_f32_16x16x32_bf16 v[92:95], v[56:59], v[232:235], v[92:95]
ds_read_b64_tr_b16 v[54:55], v2 offset:41472
v_mfma_f32_16x16x32_bf16 v[96:99], v[56:59], v[236:239], v[96:99]
ds_read_b64_tr_b16 v[56:57], v1 offset:40000
v_mfma_f32_16x16x32_bf16 v[100:103], v[68:71], v[232:235], v[100:103]
ds_read_b64_tr_b16 v[58:59], v1 offset:41536
ds_read_b64_tr_b16 v[68:69], v4 offset:39936
v_mfma_f32_16x16x32_bf16 v[104:107], v[60:63], v[232:235], v[104:107]
ds_read_b64_tr_b16 v[70:71], v4 offset:41472
v_mfma_f32_16x16x32_bf16 v[108:111], v[60:63], v[236:239], v[108:111]
ds_read_b64_tr_b16 v[60:61], v2 offset:40000
s_waitcnt vmcnt(2) lgkmcnt(5)
v_mfma_f32_16x16x32_bf16 v[72:75], v[48:51], v[240:243], v[72:75]
ds_read_b64_tr_b16 v[62:63], v2 offset:41536
v_mfma_f32_16x16x32_bf16 v[76:79], v[48:51], v[244:247], v[76:79]
ds_read_b64_tr_b16 v[48:49], v1 offset:46080
v_mfma_f32_16x16x32_bf16 v[80:83], v[64:67], v[240:243], v[80:83]
ds_read_b64_tr_b16 v[50:51], v1 offset:47616
ds_read_b64_tr_b16 v[64:65], v3 offset:46080
v_mfma_f32_16x16x32_bf16 v[84:87], v[52:55], v[240:243], v[84:87]
ds_read_b64_tr_b16 v[66:67], v3 offset:47616
v_mfma_f32_16x16x32_bf16 v[88:91], v[52:55], v[244:247], v[88:91]
ds_read_b64_tr_b16 v[52:53], v2 offset:46080
s_waitcnt lgkmcnt(5)
v_mfma_f32_16x16x32_bf16 v[92:95], v[56:59], v[240:243], v[92:95]
ds_read_b64_tr_b16 v[54:55], v2 offset:47616
v_mfma_f32_16x16x32_bf16 v[96:99], v[56:59], v[244:247], v[96:99]
ds_read_b64_tr_b16 v[56:57], v1 offset:46144
v_mfma_f32_16x16x32_bf16 v[100:103], v[68:71], v[240:243], v[100:103]
ds_read_b64_tr_b16 v[58:59], v1 offset:47680
ds_read_b64_tr_b16 v[68:69], v4 offset:46080
v_mfma_f32_16x16x32_bf16 v[104:107], v[60:63], v[240:243], v[104:107]
ds_read_b64_tr_b16 v[70:71], v4 offset:47616
v_mfma_f32_16x16x32_bf16 v[108:111], v[60:63], v[244:247], v[108:111]
ds_read_b64_tr_b16 v[60:61], v2 offset:46144
s_waitcnt vmcnt(0) lgkmcnt(5)
v_mfma_f32_16x16x32_bf16 v[72:75], v[48:51], v[248:251], v[72:75]
ds_read_b64_tr_b16 v[62:63], v2 offset:47680
v_mfma_f32_16x16x32_bf16 v[76:79], v[48:51], v[252:255], v[76:79]
v_mfma_f32_16x16x32_bf16 v[80:83], v[64:67], v[248:251], v[80:83]
v_mfma_f32_16x16x32_bf16 v[84:87], v[52:55], v[248:251], v[84:87]
v_mfma_f32_16x16x32_bf16 v[88:91], v[52:55], v[252:255], v[88:91]
s_waitcnt lgkmcnt(0)
v_mfma_f32_16x16x32_bf16 v[92:95], v[56:59], v[248:251], v[92:95]
s_nop 0
v_cvt_pk_bf16_f32 v20, v72, v73
v_cvt_pk_bf16_f32 v21, v74, v75
v_mfma_f32_16x16x32_bf16 v[96:99], v[56:59], v[252:255], v[96:99]
ds_write_b64 v7, v[20:21] offset:0
v_cvt_pk_bf16_f32 v22, v76, v77
v_mfma_f32_16x16x32_bf16 v[100:103], v[68:71], v[248:251], v[100:103]
v_cvt_pk_bf16_f32 v23, v78, v79
ds_write_b64 v9, v[22:23] offset:0
v_mfma_f32_16x16x32_bf16 v[104:107], v[60:63], v[248:251], v[104:107]
v_cvt_pk_bf16_f32 v24, v80, v81
v_cvt_pk_bf16_f32 v25, v82, v83
v_mfma_f32_16x16x32_bf16 v[108:111], v[60:63], v[252:255], v[108:111]
ds_write_b64 v8, v[24:25] offset:0
v_cvt_pk_bf16_f32 v26, v84, v85
v_cvt_pk_bf16_f32 v27, v86, v87
ds_write_b64 v7, v[26:27] offset:32
v_cvt_pk_bf16_f32 v28, v88, v89
v_cvt_pk_bf16_f32 v29, v90, v91
ds_write_b64 v9, v[28:29] offset:32
v_cvt_pk_bf16_f32 v30, v92, v93
v_cvt_pk_bf16_f32 v31, v94, v95
ds_write_b64 v7, v[30:31] offset:64
v_cvt_pk_bf16_f32 v32, v96, v97
v_cvt_pk_bf16_f32 v33, v98, v99
ds_write_b64 v9, v[32:33] offset:64
v_cvt_pk_bf16_f32 v34, v100, v101
v_cvt_pk_bf16_f32 v35, v102, v103
ds_write_b64 v8, v[34:35] offset:32
v_cvt_pk_bf16_f32 v36, v104, v105
v_cvt_pk_bf16_f32 v37, v106, v107
ds_write_b64 v7, v[36:37] offset:96
v_cvt_pk_bf16_f32 v38, v108, v109
v_cvt_pk_bf16_f32 v39, v110, v111
ds_write_b64 v9, v[38:39] offset:96
s_waitcnt lgkmcnt(0)
ds_read_b128 v[112:115], v10 offset:0
ds_read_b128 v[116:119], v11 offset:0
ds_read_b128 v[120:123], v12 offset:0
ds_read_b128 v[124:127], v13 offset:0
ds_read_b128 v[128:131], v13 offset:1152
s_waitcnt lgkmcnt(4)
buffer_store_dwordx4 v[112:115], v43, s[28:31], 0 offen sc1
s_waitcnt lgkmcnt(3)
buffer_store_dwordx4 v[116:119], v44, s[28:31], 0 offen sc1
s_waitcnt lgkmcnt(2)
buffer_store_dwordx4 v[120:123], v45, s[28:31], 0 offen sc1
s_waitcnt lgkmcnt(1)
buffer_store_dwordx4 v[124:127], v46, s[28:31], 0 offen sc1
s_waitcnt lgkmcnt(0)
buffer_store_dwordx4 v[128:131], v47, s[28:31], 0 offen sc1
s_endpgm
L_last:
s_endpgm
.section .rodata,"a"
.p2align 6
.amdhsa_kernel concat_heads__sliding_local_dilated__linear_attn_block__prompt_kernel
  .amdhsa_next_free_vgpr 256
  .amdhsa_next_free_sgpr 100
  .amdhsa_accum_offset 256
  .amdhsa_group_segment_fixed_size 0
  .amdhsa_kernarg_size 72
  .amdhsa_user_sgpr_count 2
  .amdhsa_user_sgpr_kernarg_segment_ptr 1
  .amdhsa_system_sgpr_workgroup_id_x 1
.end_amdhsa_kernel
```
